```python
import torch

def _softmax(x, axis=-1):
    return torch.softmax(x, dim=axis)
def _gelu(x):
    return torch.nn.functional.gelu(x, approximate="tanh")
def _silu(x):
    return torch.nn.functional.silu(x)
def _sigmoid(x):
    return torch.sigmoid(x)
def _layernorm(x, axis=-1, eps=1e-5):
    m = x.mean(dim=axis, keepdim=True)
    v = x.var(dim=axis, keepdim=True, unbiased=False)
    return (x - m) / torch.sqrt(v + eps)
def _scatter_add(tgt, idx, src, axis=0):
    return tgt.clone().index_add_(axis, idx, src)
def _segment_sum(src, seg, n):
    out = torch.zeros((n,) + src.shape[1:], dtype=src.dtype)
    return out.index_add_(0, seg, src)
def _pad(x, pw):
    flat = tuple(v for pair in reversed(pw) for v in pair)
    return torch.nn.functional.pad(x, flat)

kernel_name = 'gated_mix__softmax_full_mha__glu_gated_bilinear__prompt'

def setup_inputs():

    _w = (lambda a: (lambda t: t.to(torch.bfloat16) if t.is_floating_point() else t)(torch.as_tensor(a)))
    def _A_setup():
        B, S, D = 1, 2048, 1024
        return {
            "x": _w((lambda *s: torch.randn(*s, dtype=torch.bfloat16) * 0.05)(B, S, D)),
            "wqkv": _w((lambda *s: torch.randn(*s, dtype=torch.bfloat16) * 0.8)(D, 3 * D)),
            "wo": _w((lambda *s: torch.randn(*s, dtype=torch.bfloat16) * 0.05)(D, D)),
        }
    _A_in = _A_setup()

    def _B_setup():
        B, S, D, F = 1, 2048, 1024, 3584
        return {
            "x": _w((lambda *s: torch.randn(*s, dtype=torch.bfloat16) * 0.05)(B, S, D)),
            "w_gate": _w((lambda *s: torch.randn(*s, dtype=torch.bfloat16) * 3.2)(D, F) * (D ** -0.5)),
            "w_up": _w((lambda *s: torch.randn(*s, dtype=torch.bfloat16) * 3.2)(D, F) * (D ** -0.5)),
            "w_down": _w((lambda *s: torch.randn(*s, dtype=torch.bfloat16) * 3.2)(F, D) * (F ** -0.5)),
        }
    _B_in = _B_setup()

    return {
        "A_x": _A_in["x"],
        "A_wqkv": _A_in["wqkv"],
        "A_wo": _A_in["wo"],
        "B_x": _B_in["x"],
        "B_w_gate": _B_in["w_gate"],
        "B_w_up": _B_in["w_up"],
        "B_w_down": _B_in["w_down"],
        "gate_w": _w((lambda *s: torch.randn(*s, dtype=torch.bfloat16) * 0.05)(1024) * 16.0),
    }

def reference(A_x, A_wqkv, A_wo, B_x, B_w_gate, B_w_up, B_w_down, gate_w):
    def _A_ref(x, wqkv, wo):
        B, S, D = x.shape
        H = 32; Dh = D // H
        qkv = (lambda x, *d: x.permute(*d))((x @ wqkv).reshape(B, S, 3, H, Dh), 2, 0, 3, 1, 4)
        q, k, v = qkv[0], qkv[1], qkv[2]
        scale = Dh ** -0.5
        scores = torch.einsum("bhqd,bhkd->bhqk", q, k) * scale
        p = _softmax(scores, axis=-1)
        o = torch.einsum("bhqk,bhkd->bhqd", p, v)
        return (lambda x, *d: x.permute(*d))(o, 0, 2, 1, 3).reshape(B, S, D) @ wo

    def _B_ref(x, w_gate, w_up, w_down):
        g = torch.einsum("bsd,df->bsf", x, w_gate)
        u = torch.einsum("bsd,df->bsf", x, w_up)
        h = g * u
        return torch.einsum("bsf,fd->bsd", h, w_down)

    x = A_x
    g = _sigmoid((x * gate_w).sum(-1, keepdims=True))
    a = _A_ref(x, A_wqkv, A_wo)
    b = _B_ref(x, B_w_gate, B_w_up, B_w_down)
    return g * a + (1 - g) * b
```

```asm
; @launch grid=(256,1,1) block=(256,1,1) lds=163840
.amdgcn_target "amdgcn-amd-amdhsa--gfx950"
.text
.globl gated_mix__softmax_full_mha__glu_gated_bilinear__prompt_kernel
.p2align 8
.type gated_mix__softmax_full_mha__glu_gated_bilinear__prompt_kernel,@function
gated_mix__softmax_full_mha__glu_gated_bilinear__prompt_kernel:
    s_cmp_ge_u32 s2, 256
    s_cbranch_scc1 gated_mix__softmax_full_mha__glu_gated_bilinear__prompt_kernel_end
    s_load_dwordx16 s[4:19], s[0:1], 0
    s_load_dwordx4 s[20:23], s[0:1], 64
    s_load_dwordx2 s[24:25], s[0:1], 80
    v_lshrrev_b32 v29, 6, v0
    v_and_b32 v1, 63, v0
    s_lshr_b32 s46, s2, 3
    v_readfirstlane_b32 s42, v29
    s_and_b32 s40, s46, 7
    s_and_b32 s45, s2, 7
    s_lshr_b32 s46, s46, 3
    s_lshl_b32 s41, s45, 2
    s_add_u32 s41, s41, s46
    s_lshr_b32 s43, s42, 1
    s_and_b32 s44, s42, 1
    s_getpc_b64 s[26:27]
gated_mix__softmax_full_mha__glu_gated_bilinear__prompt_kernel_pcs:
    s_lshr_b32 s45, s2, 3
    s_lshl_b32 s45, s45, 2
    s_add_u32 s45, s45, s42
    s_lshl_b32 s45, s45, 7
    v_and_b32 v29, 1, v1
    v_lshl_add_u32 v29, v29, 14, s45
    v_min_u32 v29, gated_mix__softmax_full_mha__glu_gated_bilinear__prompt_kernel_join-gated_mix__softmax_full_mha__glu_gated_bilinear__prompt_kernel_pcs, v29
    v_mov_b32 v61, s27
    v_add_co_u32 v60, vcc, s26, v29
    s_nop 1
    v_addc_co_u32 v61, vcc, 0, v61, vcc
    global_load_dword v2, v[60:61], off
    v_and_b32 v29, 7, v1
    v_lshrrev_b32 v30, 3, v1
    v_mul_u32_u24 v31, 86, v30
    v_lshrrev_b32 v31, 8, v31
    v_mad_i32_i24 v30, v31, -3, v30
    v_lshl_add_u32 v29, v31, 6, v29
    s_lshl_b32 s45, s40, 3
    v_add_u32 v29, s45, v29
    s_cmp_eq_u32 s42, 3
    s_movk_i32 s80, 7168
    s_cmov_b32 s80, 6144
    s_movk_i32 s81, 108
    s_cmov_b32 s81, 2048
    v_mul_u32_u24 v29, s80, v29
    v_mad_u32_u24 v36, v30, s81, v29
    v_cmp_gt_u32 vcc, 48, v1
    s_lshl_b32 s45, s46, 17
    v_lshl_add_u32 v29, v1, 11, s45
    v_cndmask_b32 v36, 2.0, v36, vcc
    s_cmp_eq_u32 s42, 0
    s_cselect_b64 vcc, -1, 0
    v_cndmask_b32 v36, v36, v29, vcc
    s_lshl_b32 s45, s40, 19
    s_lshl_b32 s46, s41, 6
    s_mul_i32 s47, s41, 224
    s_mov_b32 s59, 0x00020000
    s_mov_b32 s63, 0x00020000
    s_mov_b32 s67, 0x00020000
    s_mov_b32 s71, 0x00020000
    s_sub_u32 s58, 4194304, s45
    s_sub_u32 s62, 6291456, s46
    s_sub_u32 s66, 7340032, s47
    s_waitcnt lgkmcnt(0)
    s_add_u32 s56, s4, s45
    s_addc_u32 s57, s5, 0
    s_add_u32 s60, s6, s46
    s_addc_u32 s61, s7, 0
    s_cmp_ge_u32 s42, 2
    s_cselect_b64 s[64:65], s[14:15], s[12:13]
    s_add_u32 s64, s64, s47
    s_addc_u32 s65, s65, 0
    s_cmp_eq_u32 s42, 3
    s_cselect_b64 s[68:69], s[60:61], s[64:65]
    s_cselect_b32 s70, s62, s66
    s_cmp_eq_u32 s42, 0
    s_cselect_b64 s[68:69], s[56:57], s[68:69]
    s_cselect_b32 s70, s58, s70
    buffer_load_dword v2, v36, s[68:71], 0 offen
    v_lshrrev_b32 v29, 3, v1
    v_and_b32 v30, 7, v1
    v_lshrrev_b32 v31, 4, v1
    v_xor_b32 v30, v30, v31
    v_lshlrev_b32 v32, 11, v29
    s_lshl_b32 s80, s42, 17
    v_add_u32 v32, s80, v32
    v_lshl_add_u32 v6, v30, 4, v32
    v_xor_b32 v30, 4, v30
    v_lshl_add_u32 v7, v30, 4, v32
    v_add_u32 v7, 15360, v7
    s_lshl_b32 s90, s42, 13
    s_mov_b32 s82, 0
    v_add_u32 v8, 30720, v6
    v_add_u32 v9, 30720, v7
    v_add_u32 v10, 65536, v6
    v_add_u32 v11, 65536, v7
    v_add_u32 v12, 96256, v6
    v_add_u32 v13, 96256, v7
    s_add_u32 m0, s90, 0
    s_nop 0
    buffer_load_dwordx4 v6, s[56:59], s82 offen offset:0 lds
    buffer_load_dwordx4 v7, s[56:59], s82 offen offset:1024 lds
    buffer_load_dwordx4 v8, s[56:59], s82 offen offset:2048 lds
    buffer_load_dwordx4 v9, s[56:59], s82 offen offset:3072 lds
    s_add_u32 m0, s90, 4096
    s_nop 0
    buffer_load_dwordx4 v10, s[56:59], s82 offen offset:0 lds
    buffer_load_dwordx4 v11, s[56:59], s82 offen offset:1024 lds
    buffer_load_dwordx4 v12, s[56:59], s82 offen offset:2048 lds
    buffer_load_dwordx4 v13, s[56:59], s82 offen offset:3072 lds
    v_lshrrev_b32 v29, 2, v1
    v_and_b32 v31, 2, v31
    v_and_b32 v30, 3, v1
    v_xor_b32 v30, v30, v31
    s_lshl_b32 s80, s42, 4
    v_add_u32 v29, s80, v29
    v_mul_u32_u24 v29, 6144, v29
    v_lshl_add_u32 v15, v30, 4, v29
    v_add_u32 v14, 1024, v15
    s_mul_i32 s91, s42, 10240
    s_mov_b32 s83, 0
    s_mov_b32 s84, 0
    s_add_u32 m0, s91, 69632
    s_nop 0
    buffer_load_dwordx4 v14, s[60:63], s83 offen offset:3072 lds
    s_add_u32 m0, s91, 73728
    s_nop 0
    buffer_load_dwordx4 v15, s[60:63], s83 offen offset:0 lds
    buffer_load_dwordx4 v14, s[60:63], s83 offen offset:1024 lds
    s_mul_i32 s45, s44, 229376
    s_movk_i32 s80, 6944
    s_movk_i32 s81, 28672
    v_mul_u32_u24 v32, 4682, v1
    v_lshl_add_u32 v38, v1, 4, s45
    v_bfe_u32 v30, v32, 18, 1
    v_bfe_u32 v31, v32, 19, 1
    v_lshrrev_b32 v29, 16, v32
    v_sub_u32 v30, v30, v31
    v_mad_u32_u24 v16, v29, s80, v38
    v_mad_i32_i24 v16, v30, s81, v16
    s_add_u32 m0, s91, 65536
    s_nop 0
    buffer_load_dwordx4 v16, s[64:67], s84 offen offset:0 lds
    v_add_u32 v29, 299648, v32
    v_bfe_u32 v30, v29, 18, 1
    v_bfe_u32 v31, v29, 19, 1
    v_lshrrev_b32 v29, 16, v29
    v_sub_u32 v30, v30, v31
    v_mad_u32_u24 v17, v29, s80, v38
    v_mad_i32_i24 v17, v30, s81, v17
    buffer_load_dwordx4 v17, s[64:67], s84 offen offset:1024 lds
    v_add_u32 v29, 599296, v32
    v_bfe_u32 v30, v29, 18, 1
    v_bfe_u32 v31, v29, 19, 1
    v_lshrrev_b32 v29, 16, v29
    v_sub_u32 v30, v30, v31
    v_mad_u32_u24 v18, v29, s80, v38
    v_mad_i32_i24 v18, v30, s81, v18
    buffer_load_dwordx4 v18, s[64:67], s84 offen offset:2048 lds
    v_add_u32 v29, 898944, v32
    v_bfe_u32 v30, v29, 18, 1
    v_bfe_u32 v31, v29, 19, 1
    v_lshrrev_b32 v29, 16, v29
    v_sub_u32 v30, v30, v31
    v_mad_u32_u24 v19, v29, s80, v38
    v_mad_i32_i24 v19, v30, s81, v19
    v_add_u32 v38, 4096, v38
    buffer_load_dwordx4 v19, s[64:67], s84 offen offset:3072 lds
    v_add_u32 v29, 1198592, v32
    v_bfe_u32 v30, v29, 18, 1
    v_bfe_u32 v31, v29, 19, 1
    v_lshrrev_b32 v29, 16, v29
    v_sub_u32 v30, v30, v31
    v_mad_u32_u24 v20, v29, s80, v38
    v_mad_i32_i24 v20, v30, s81, v20
    s_add_u32 m0, s91, 69632
    s_nop 0
    buffer_load_dwordx4 v20, s[64:67], s84 offen offset:0 lds
    v_add_u32 v29, 1498240, v32
    v_bfe_u32 v30, v29, 18, 1
    v_bfe_u32 v31, v29, 19, 1
    v_lshrrev_b32 v29, 16, v29
    v_sub_u32 v30, v30, v31
    v_mad_u32_u24 v21, v29, s80, v38
    v_mad_i32_i24 v21, v30, s81, v21
    buffer_load_dwordx4 v21, s[64:67], s84 offen offset:1024 lds
    v_add_u32 v29, 1797888, v32
    v_bfe_u32 v30, v29, 18, 1
    v_bfe_u32 v31, v29, 19, 1
    v_lshrrev_b32 v29, 16, v29
    v_sub_u32 v30, v30, v31
    v_mad_u32_u24 v22, v29, s80, v38
    v_mad_i32_i24 v22, v30, s81, v22
    buffer_load_dwordx4 v22, s[64:67], s84 offen offset:2048 lds
    s_add_u32 s83, s83, 393216
    s_add_u32 s84, s84, 458752
    s_add_u32 s82, s82, 128
    s_add_u32 m0, s91, 106496
    s_nop 0
    buffer_load_dwordx4 v16, s[64:67], s84 offen offset:0 lds
    buffer_load_dwordx4 v17, s[64:67], s84 offen offset:1024 lds
    buffer_load_dwordx4 v18, s[64:67], s84 offen offset:2048 lds
    buffer_load_dwordx4 v19, s[64:67], s84 offen offset:3072 lds
    s_add_u32 m0, s91, 110592
    s_nop 0
    buffer_load_dwordx4 v20, s[64:67], s84 offen offset:0 lds
    buffer_load_dwordx4 v21, s[64:67], s84 offen offset:1024 lds
    buffer_load_dwordx4 v22, s[64:67], s84 offen offset:2048 lds
    buffer_load_dwordx4 v14, s[60:63], s83 offen offset:3072 lds
    s_add_u32 m0, s91, 114688
    s_nop 0
    buffer_load_dwordx4 v15, s[60:63], s83 offen offset:0 lds
    buffer_load_dwordx4 v14, s[60:63], s83 offen offset:1024 lds
    s_cmp_eq_u32 s42, 3
    s_mov_b32 s86, 458752
    s_cmov_b32 s86, 393216
    v_cmp_gt_u32 vcc, 24, v1
    s_lshl_b32 s46, s2, 14
    v_and_b32 v30, 7, v1
    v_cndmask_b32 v33, 2.0, v36, vcc
    v_lshl_add_u32 v29, v30, 11, s46
    v_lshrrev_b32 v30, 3, v1
    v_lshl_add_u32 v37, v30, 7, v29
    v_cmp_gt_u32 vcc, 8, v1
    v_cmp_gt_u32 s[26:27], 16, v1
    s_nop 0
    v_cndmask_b32 v29, 2.0, v29, vcc
    v_cndmask_b32 v37, 2.0, v37, s[26:27]
    s_cmp_eq_u32 s42, 0
    s_cselect_b64 vcc, -1, 0
    s_cselect_b32 s86, 0x80, s86
    s_cselect_b64 s[68:69], s[4:5], s[68:69]
    s_cselect_b32 s70, 4194304, s70
    s_cselect_b32 s45, 1, 2
    v_cndmask_b32 v33, v33, v29, vcc
    v_cndmask_b32 v37, v33, v37, vcc
    s_mul_i32 s45, s45, s86
    s_mul_i32 s85, s86, 3
    buffer_load_dword v2, v37, s[68:71], s45 offen
    v_and_b32 v29, 15, v1
    v_lshrrev_b32 v30, 4, v1
    v_lshrrev_b32 v31, 1, v29
    v_xor_b32 v31, v30, v31
    s_lshl_b32 s45, s43, 14
    v_lshl_add_u32 v32, v29, 7, s45
    v_lshl_add_u32 v23, v31, 4, v32
    v_xor_b32 v24, 64, v23
    v_and_b32 v32, 3, v29
    v_lshlrev_b32 v32, 3, v32
    v_lshrrev_b32 v29, 2, v29
    v_lshrrev_b32 v31, 1, v30
    v_and_b32 v30, 1, v30
    v_mul_u32_u24 v25, 10240, v31
    v_mul_u32_u24 v26, 544, v30
    v_add3_u32 v25, v25, v26, v32
    v_lshl_add_u32 v25, v29, 6, v25
    s_lshl_b32 s45, s44, 10
    s_sub_u32 s45, 73728, s45
    v_add_u32 v25, s45, v25
    v_xor_b32 v26, 32, v25
    v_lshl_add_u32 v29, v30, 2, v29
    v_lshl_add_u32 v29, v31, 4, v29
    v_mul_u32_u24 v29, 224, v29
    s_mul_i32 s45, s44, 96
    s_add_u32 s45, s45, 65536
    v_add3_u32 v27, v29, v32, s45
    v_add_u32 v28, 20480, v27
    s_waitcnt vmcnt(11)
    s_barrier
    ds_read_b128 a[0:3], v23 offset:0
    ds_read_b128 a[4:7], v24 offset:0
    ds_read_b128 a[8:11], v23 offset:2048
    ds_read_b128 a[12:15], v24 offset:2048
    s_cmp_eq_u32 s44, 1
    s_cbranch_scc1 gated_mix__softmax_full_mha__glu_gated_bilinear__prompt_kernel_c1
    ds_read_b64_tr_b16 a[96:97], v25 offset:1024
    ds_read_b64_tr_b16 a[98:99], v25 offset:1280
    ds_read_b64_tr_b16 a[100:101], v25 offset:21504
    ds_read_b64_tr_b16 a[102:103], v25 offset:21760
    ds_read_b128 a[16:19], v23 offset:4096
    ds_read_b128 a[20:23], v24 offset:4096
    ds_read_b128 a[24:27], v23 offset:6144
    ds_read_b128 a[28:31], v24 offset:6144
    ds_read_b128 a[64:67], v23 offset:8192
    ds_read_b128 a[68:71], v24 offset:8192
    ds_read_b128 a[72:75], v23 offset:10240
    ds_read_b128 a[76:79], v24 offset:10240
    ds_read_b128 a[80:83], v23 offset:12288
    ds_read_b128 a[84:87], v24 offset:12288
    ds_read_b128 a[88:91], v23 offset:14336
    ds_read_b128 a[92:95], v24 offset:14336
    ds_read_b64_tr_b16 a[104:105], v26 offset:1024
    ds_read_b64_tr_b16 a[106:107], v26 offset:1280
    ds_read_b64_tr_b16 a[108:109], v26 offset:21504
    ds_read_b64_tr_b16 a[110:111], v26 offset:21760
    ds_read_b64_tr_b16 a[112:113], v25 offset:0
    ds_read_b64_tr_b16 a[114:115], v25 offset:256
    ds_read_b64_tr_b16 a[116:117], v25 offset:20480
    ds_read_b64_tr_b16 a[118:119], v25 offset:20736
    s_waitcnt lgkmcnt(15)
    v_mfma_f32_16x16x32_bf16 v[64:67], a[96:99], a[0:3], 0
    ds_read_b64_tr_b16 a[120:121], v26 offset:0
    s_add_u32 m0, s90, 32768
    v_mfma_f32_16x16x32_bf16 v[64:67], a[100:103], a[4:7], v[64:67]
    buffer_load_dwordx4 v6, s[56:59], s82 offen offset:0 lds
    s_add_u32 s32, s24, 34603008
    s_addc_u32 s33, s25, 0
    v_mfma_f32_16x16x32_bf16 v[68:71], a[96:99], a[8:11], 0
    ds_read_b64_tr_b16 a[122:123], v26 offset:256
    s_movk_i32 s34, 8192
    v_mfma_f32_16x16x32_bf16 v[68:71], a[100:103], a[12:15], v[68:71]
    s_mov_b32 s35, 0x00020000
    s_mov_b32 s28, s24
    v_mfma_f32_16x16x32_bf16 v[72:75], a[96:99], a[16:19], 0
    ds_read_b64_tr_b16 a[124:125], v26 offset:20480
    s_mov_b32 s29, s25
    v_mfma_f32_16x16x32_bf16 v[72:75], a[100:103], a[20:23], v[72:75]
    buffer_load_dwordx4 v7, s[56:59], s82 offen offset:1024 lds
    s_mov_b32 s30, 268435456
    v_mfma_f32_16x16x32_bf16 v[76:79], a[96:99], a[24:27], 0
    ds_read_b64_tr_b16 a[126:127], v26 offset:20736
    s_mov_b32 s31, 0x00020000
    v_mfma_f32_16x16x32_bf16 v[76:79], a[100:103], a[28:31], v[76:79]
    s_mov_b32 s75, 0x00020000
    s_lshl_b32 s45, s40, 5
    v_mfma_f32_16x16x32_bf16 v[80:83], a[96:99], a[64:67], 0
    s_add_u32 s45, s45, s41
    s_lshl_b32 s87, s45, 7
    s_waitcnt lgkmcnt(15)
    v_mfma_f32_16x16x32_bf16 v[80:83], a[100:103], a[68:71], v[80:83]
    buffer_load_dwordx4 v8, s[56:59], s82 offen offset:2048 lds
    s_lshl_b32 s45, s45, 2
    v_mfma_f32_16x16x32_bf16 v[84:87], a[96:99], a[72:75], 0
    s_add_u32 s45, s45, s42
    s_lshl_b32 s45, s45, 2
    v_mfma_f32_16x16x32_bf16 v[84:87], a[100:103], a[76:79], v[84:87]
    v_mov_b32 v29, s45
    v_cmp_eq_u32 vcc, 0, v1
    v_mfma_f32_16x16x32_bf16 v[88:91], a[96:99], a[80:83], 0
    v_mov_b32 v32, 0
    v_cndmask_b32 v3, 2.0, v29, vcc
    s_waitcnt lgkmcnt(14)
    v_mfma_f32_16x16x32_bf16 v[88:91], a[100:103], a[84:87], v[88:91]
    buffer_load_dwordx4 v9, s[56:59], s82 offen offset:3072 lds
    s_lshl_b32 s45, s41, 3
    s_waitcnt lgkmcnt(13)
    v_mfma_f32_16x16x32_bf16 v[92:95], a[96:99], a[88:91], 0
    s_add_u32 s45, s45, s40
    s_lshl_b32 s45, s45, 2
    s_waitcnt lgkmcnt(12)
    v_mfma_f32_16x16x32_bf16 v[92:95], a[100:103], a[92:95], v[92:95]
    s_add_u32 s45, s45, s42
    s_lshl_b32 s45, s45, 2
    s_waitcnt lgkmcnt(10)
    v_mfma_f32_16x16x32_bf16 v[124:127], a[104:107], a[88:91], 0
    ds_read_b64_tr_b16 a[96:97], v27 offset:0
    s_add_u32 m0, s90, 36864
    s_waitcnt lgkmcnt(9)
    v_mfma_f32_16x16x32_bf16 v[124:127], a[108:111], a[92:95], v[124:127]
    buffer_load_dwordx4 v10, s[56:59], s82 offen offset:0 lds
    s_add_u32 s45, s45, 4096
    v_mfma_f32_16x16x32_bf16 v[120:123], a[104:107], a[80:83], 0
    ds_read_b64_tr_b16 a[98:99], v27 offset:1792
    v_mov_b32 v29, s45
    v_mfma_f32_16x16x32_bf16 v[120:123], a[108:111], a[84:87], v[120:123]
    buffer_store_dword v32, v3, s[32:35], 0 offen sc1
    v_cndmask_b32 v5, 2.0, v29, vcc
    v_mfma_f32_16x16x32_bf16 v[116:119], a[104:107], a[72:75], 0
    ds_read_b64_tr_b16 a[100:101], v27 offset:10240
    s_lshl_b32 s46, s42, 3
    v_mfma_f32_16x16x32_bf16 v[116:119], a[108:111], a[76:79], v[116:119]
    buffer_load_dwordx4 v11, s[56:59], s82 offen offset:1024 lds
    buffer_store_dword v32, v5, s[32:35], 0 offen sc1
    v_mfma_f32_16x16x32_bf16 v[112:115], a[104:107], a[64:67], 0
    ds_read_b64_tr_b16 a[102:103], v27 offset:12032
    s_add_u32 s87, s87, s46
    v_mfma_f32_16x16x32_bf16 v[112:115], a[108:111], a[68:71], v[112:115]
    s_add_u32 s87, s87, 33554432
    s_lshl_b32 s45, s41, 3
    v_mfma_f32_16x16x32_bf16 v[108:111], a[104:107], a[24:27], 0
    s_lshl_b32 s46, s42, 1
    s_add_u32 s45, s45, s46
    v_mfma_f32_16x16x32_bf16 v[108:111], a[108:111], a[28:31], v[108:111]
    buffer_load_dwordx4 v12, s[56:59], s82 offen offset:2048 lds
    s_lshl_b32 s47, s45, 11
    v_mfma_f32_16x16x32_bf16 v[104:107], a[104:107], a[16:19], 0
    s_mov_b32 s92, 0xffff0000
    v_lshlrev_b32 v29, 5, v1
    v_mfma_f32_16x16x32_bf16 v[104:107], a[108:111], a[20:23], v[104:107]
    s_mov_b32 s36, s22
    s_mov_b32 s37, s23
    v_mfma_f32_16x16x32_bf16 v[100:103], a[104:107], a[8:11], 0
    s_movk_i32 s38, 256
    s_mov_b32 s39, 0x00020000
    v_mfma_f32_16x16x32_bf16 v[100:103], a[108:111], a[12:15], v[100:103]
    buffer_load_dwordx4 v13, s[56:59], s82 offen offset:3072 lds
    s_and_b32 s89, s2, 7
    v_mfma_f32_16x16x32_bf16 v[96:99], a[104:107], a[0:3], 0
    s_lshl_b32 s89, s89, 2
    s_and_b32 s88, s40, 3
    v_mfma_f32_16x16x32_bf16 v[96:99], a[108:111], a[4:7], v[96:99]
    s_add_u32 s83, s83, 393216
    s_add_u32 s88, s88, 3
    s_waitcnt lgkmcnt(10)
    v_mfma_f32_16x16x32_bf16 a[128:131], a[112:115], a[0:3], 0
    ds_read_b64_tr_b16 a[104:105], v28 offset:0
    s_add_u32 s84, s84, 458752
    s_waitcnt lgkmcnt(9)
    v_mfma_f32_16x16x32_bf16 a[128:131], a[116:119], a[4:7], a[128:131]
    s_add_u32 s82, s82, 128
    v_mov_b32 v31, 1
    v_mfma_f32_16x16x32_bf16 a[132:135], a[112:115], a[8:11], 0
    ds_read_b64_tr_b16 a[106:107], v28 offset:1792
    buffer_load_dword v2, v33, s[68:71], s85 offen
    v_mfma_f32_16x16x32_bf16 a[132:135], a[116:119], a[12:15], a[132:135]
    s_add_u32 s85, s85, s86
    v_cmp_eq_u32 s[26:27], 0, v0
    v_mfma_f32_16x16x32_bf16 a[136:139], a[112:115], a[16:19], 0
    ds_read_b64_tr_b16 a[108:109], v28 offset:10240
    v_cndmask_b32 v30, 2.0, 0, s[26:27]
    v_mfma_f32_16x16x32_bf16 a[136:139], a[116:119], a[20:23], a[136:139]
    s_getpc_b64 s[26:27]
gated_mix__softmax_full_mha__glu_gated_bilinear__prompt_kernel_pc0:
    s_lshr_b32 s45, s2, 3
    v_mfma_f32_16x16x32_bf16 a[140:143], a[112:115], a[24:27], 0
    ds_read_b64_tr_b16 a[110:111], v28 offset:12032
    s_lshl_b32 s46, s45, 9
    v_mfma_f32_16x16x32_bf16 a[140:143], a[116:119], a[28:31], a[140:143]
    s_add_u32 s46, s46, gated_mix__softmax_full_mha__glu_gated_bilinear__prompt_kernel_c0out-gated_mix__softmax_full_mha__glu_gated_bilinear__prompt_kernel_pc0
    v_and_b32 v37, 3, v1
    v_mfma_f32_16x16x32_bf16 a[144:147], a[112:115], a[64:67], 0
    v_lshl_add_u32 v37, v37, 7, s46
    s_lshl_b32 s45, s45, 2
    v_mfma_f32_16x16x32_bf16 a[144:147], a[116:119], a[68:71], a[144:147]
    s_add_u32 s45, s45, s42
    s_lshl_b32 s45, s45, 8
    v_mfma_f32_16x16x32_bf16 a[148:151], a[112:115], a[72:75], 0
    s_add_u32 s45, s45, gated_mix__softmax_full_mha__glu_gated_bilinear__prompt_kernel_join-gated_mix__softmax_full_mha__glu_gated_bilinear__prompt_kernel_pc0
    v_and_b32 v36, 1, v1
    v_mfma_f32_16x16x32_bf16 a[148:151], a[116:119], a[76:79], a[148:151]
    v_lshl_add_u32 v36, v36, 7, s45
    v_and_b32 v38, 4, v1
    v_mfma_f32_16x16x32_bf16 a[152:155], a[112:115], a[80:83], 0
    v_cmp_eq_u32 vcc, 0, v38
    s_nop 1
    v_cndmask_b32 v34, v36, v37, vcc
    v_mfma_f32_16x16x32_bf16 a[152:155], a[116:119], a[84:87], a[152:155]
    v_min_u32 v34, gated_mix__softmax_full_mha__glu_gated_bilinear__prompt_kernel_end-gated_mix__softmax_full_mha__glu_gated_bilinear__prompt_kernel_pc0, v34
    v_mov_b32 v61, s27
    v_mfma_f32_16x16x32_bf16 a[156:159], a[112:115], a[88:91], 0
    v_add_co_u32 v60, vcc, s26, v34
    s_nop 1
    v_addc_co_u32 v61, vcc, 0, v61, vcc
    s_mov_b32 s76, s18
    v_mfma_f32_16x16x32_bf16 a[156:159], a[116:119], a[92:95], a[156:159]
    s_mov_b32 s77, s19
    s_movk_i32 s78, 2048
    s_waitcnt lgkmcnt(10)
    v_mfma_f32_16x16x32_bf16 a[188:191], a[120:123], a[88:91], 0
    ds_read_b64_tr_b16 a[112:113], v27 offset:32
    s_mov_b32 s79, 0x00020000
    s_waitcnt lgkmcnt(9)
    v_mfma_f32_16x16x32_bf16 a[188:191], a[124:127], a[92:95], a[188:191]
    v_lshlrev_b32 v35, 7, v1
    buffer_load_dword v2, v35, s[76:79], 0 offen
    v_mfma_f32_16x16x32_bf16 a[184:187], a[120:123], a[80:83], 0
    ds_read_b64_tr_b16 a[114:115], v27 offset:1824
    s_lshl_b32 s45, s2, 2
    v_mfma_f32_16x16x32_bf16 a[184:187], a[124:127], a[84:87], a[184:187]
    s_add_u32 s45, s45, s42
    s_lshl_b32 s46, s45, 11
    v_mfma_f32_16x16x32_bf16 a[180:183], a[120:123], a[72:75], 0
    ds_read_b64_tr_b16 a[116:117], v27 offset:10272
    v_lshl_add_u32 v35, v1, 7, s46
    v_mfma_f32_16x16x32_bf16 a[180:183], a[124:127], a[76:79], a[180:183]
    v_cmp_gt_u32 s[26:27], 16, v1
    s_mov_b32 s76, s8
    v_mfma_f32_16x16x32_bf16 a[176:179], a[120:123], a[64:67], 0
    ds_read_b64_tr_b16 a[118:119], v27 offset:12064
    s_mov_b32 s77, s9
    v_mfma_f32_16x16x32_bf16 a[176:179], a[124:127], a[68:71], a[176:179]
    s_mov_b32 s78, 2097152
    v_cndmask_b32 v35, 2.0, v35, s[26:27]
    v_mfma_f32_16x16x32_bf16 a[172:175], a[120:123], a[24:27], 0
    s_lshl_b32 s45, s2, 2
    s_add_u32 s45, s45, s42
    v_mfma_f32_16x16x32_bf16 a[172:175], a[124:127], a[28:31], a[172:175]
    s_mul_i32 s46, s45, 768
    v_lshl_add_u32 v32, v1, 7, s46
    v_mfma_f32_16x16x32_bf16 a[168:171], a[120:123], a[16:19], 0
    v_cmp_gt_u32 vcc, 6, v1
    s_mov_b32 s72, s16
    v_mfma_f32_16x16x32_bf16 a[168:171], a[124:127], a[20:23], a[168:171]
    s_mov_b32 s73, s17
    s_mov_b32 s74, 7340032
    v_mfma_f32_16x16x32_bf16 a[164:167], a[120:123], a[8:11], 0
    v_cndmask_b32 v32, 2.0, v32, vcc
    s_mov_b32 s81, 0
    v_mfma_f32_16x16x32_bf16 a[164:167], a[124:127], a[12:15], a[164:167]
    v_mfma_f32_16x16x32_bf16 a[160:163], a[120:123], a[0:3], 0
    v_mfma_f32_16x16x32_bf16 a[160:163], a[124:127], a[4:7], a[160:163]
    s_waitcnt lgkmcnt(10)
    v_mfma_f32_16x16x32_bf16 a[192:195], a[96:99], a[0:3], 0
    ds_read_b64_tr_b16 a[120:121], v28 offset:32
    s_waitcnt lgkmcnt(9)
    v_mfma_f32_16x16x32_bf16 a[192:195], a[100:103], a[4:7], a[192:195]
    v_mfma_f32_16x16x32_bf16 a[196:199], a[96:99], a[8:11], 0
    ds_read_b64_tr_b16 a[122:123], v28 offset:1824
    v_mfma_f32_16x16x32_bf16 a[196:199], a[100:103], a[12:15], a[196:199]
    v_mfma_f32_16x16x32_bf16 a[200:203], a[96:99], a[16:19], 0
    ds_read_b64_tr_b16 a[124:125], v28 offset:10272
    v_mfma_f32_16x16x32_bf16 a[200:203], a[100:103], a[20:23], a[200:203]
    v_mfma_f32_16x16x32_bf16 a[204:207], a[96:99], a[24:27], 0
    ds_read_b64_tr_b16 a[126:127], v28 offset:12064
    v_mfma_f32_16x16x32_bf16 a[204:207], a[100:103], a[28:31], a[204:207]
    v_mfma_f32_16x16x32_bf16 a[208:211], a[96:99], a[64:67], 0
    v_mfma_f32_16x16x32_bf16 a[208:211], a[100:103], a[68:71], a[208:211]
    v_mfma_f32_16x16x32_bf16 a[212:215], a[96:99], a[72:75], 0
    v_mfma_f32_16x16x32_bf16 a[212:215], a[100:103], a[76:79], a[212:215]
    v_mfma_f32_16x16x32_bf16 a[216:219], a[96:99], a[80:83], 0
    v_mfma_f32_16x16x32_bf16 a[216:219], a[100:103], a[84:87], a[216:219]
    v_mfma_f32_16x16x32_bf16 a[220:223], a[96:99], a[88:91], 0
    v_mfma_f32_16x16x32_bf16 a[220:223], a[100:103], a[92:95], a[220:223]
    s_waitcnt lgkmcnt(10)
    v_mfma_f32_16x16x32_bf16 a[252:255], a[104:107], a[88:91], 0
    ds_read_b64_tr_b16 a[96:97], v27 offset:64
    s_waitcnt lgkmcnt(9)
    v_mfma_f32_16x16x32_bf16 a[252:255], a[108:111], a[92:95], a[252:255]
    v_mfma_f32_16x16x32_bf16 a[248:251], a[104:107], a[80:83], 0
    ds_read_b64_tr_b16 a[98:99], v27 offset:1856
    v_mfma_f32_16x16x32_bf16 a[248:251], a[108:111], a[84:87], a[248:251]
    v_mfma_f32_16x16x32_bf16 a[244:247], a[104:107], a[72:75], 0
    ds_read_b64_tr_b16 a[100:101], v27 offset:10304
    v_mfma_f32_16x16x32_bf16 a[244:247], a[108:111], a[76:79], a[244:247]
    v_mfma_f32_16x16x32_bf16 a[240:243], a[104:107], a[64:67], 0
    ds_read_b64_tr_b16 a[102:103], v27 offset:12096
    v_mfma_f32_16x16x32_bf16 a[240:243], a[108:111], a[68:71], a[240:243]
    v_mfma_f32_16x16x32_bf16 a[236:239], a[104:107], a[24:27], 0
    v_mfma_f32_16x16x32_bf16 a[236:239], a[108:111], a[28:31], a[236:239]
    v_mfma_f32_16x16x32_bf16 a[232:235], a[104:107], a[16:19], 0
    v_mfma_f32_16x16x32_bf16 a[232:235], a[108:111], a[20:23], a[232:235]
    v_mfma_f32_16x16x32_bf16 a[228:231], a[104:107], a[8:11], 0
    v_mfma_f32_16x16x32_bf16 a[228:231], a[108:111], a[12:15], a[228:231]
    v_mfma_f32_16x16x32_bf16 a[224:227], a[104:107], a[0:3], 0
    v_mfma_f32_16x16x32_bf16 a[224:227], a[108:111], a[4:7], a[224:227]
    s_waitcnt lgkmcnt(10)
    v_mfma_f32_16x16x32_bf16 v[128:131], a[112:115], a[0:3], 0
    ds_read_b64_tr_b16 a[104:105], v28 offset:64
    s_waitcnt lgkmcnt(9)
    v_mfma_f32_16x16x32_bf16 v[128:131], a[116:119], a[4:7], v[128:131]
    v_mfma_f32_16x16x32_bf16 v[132:135], a[112:115], a[8:11], 0
    ds_read_b64_tr_b16 a[106:107], v28 offset:1856
    v_mfma_f32_16x16x32_bf16 v[132:135], a[116:119], a[12:15], v[132:135]
    v_mfma_f32_16x16x32_bf16 v[136:139], a[112:115], a[16:19], 0
    ds_read_b64_tr_b16 a[108:109], v28 offset:10304
    v_mfma_f32_16x16x32_bf16 v[136:139], a[116:119], a[20:23], v[136:139]
    v_mfma_f32_16x16x32_bf16 v[140:143], a[112:115], a[24:27], 0
    ds_read_b64_tr_b16 a[110:111], v28 offset:12096
    v_mfma_f32_16x16x32_bf16 v[140:143], a[116:119], a[28:31], v[140:143]
    v_mfma_f32_16x16x32_bf16 v[144:147], a[112:115], a[64:67], 0
    v_mfma_f32_16x16x32_bf16 v[144:147], a[116:119], a[68:71], v[144:147]
    v_mfma_f32_16x16x32_bf16 v[148:151], a[112:115], a[72:75], 0
    v_mfma_f32_16x16x32_bf16 v[148:151], a[116:119], a[76:79], v[148:151]
    v_mfma_f32_16x16x32_bf16 v[152:155], a[112:115], a[80:83], 0
    v_mfma_f32_16x16x32_bf16 v[152:155], a[116:119], a[84:87], v[152:155]
    v_mfma_f32_16x16x32_bf16 v[156:159], a[112:115], a[88:91], 0
    v_mfma_f32_16x16x32_bf16 v[156:159], a[116:119], a[92:95], v[156:159]
    s_waitcnt vmcnt(2) lgkmcnt(0)
    s_barrier
    v_mfma_f32_16x16x32_bf16 v[188:191], a[120:123], a[88:91], 0
    ds_read_b64_tr_b16 a[112:113], v25 offset:41984
    s_add_u32 m0, s91, 65536
    v_mfma_f32_16x16x32_bf16 v[188:191], a[124:127], a[92:95], v[188:191]
    buffer_load_dwordx4 v16, s[64:67], s84 offen offset:0 lds
    v_mfma_f32_16x16x32_bf16 v[184:187], a[120:123], a[80:83], 0
    ds_read_b64_tr_b16 a[114:115], v25 offset:42240
    v_mfma_f32_16x16x32_bf16 v[184:187], a[124:127], a[84:87], v[184:187]
    v_mfma_f32_16x16x32_bf16 v[180:183], a[120:123], a[72:75], 0
    ds_read_b64_tr_b16 a[116:117], v25 offset:62464
    v_mfma_f32_16x16x32_bf16 v[180:183], a[124:127], a[76:79], v[180:183]
    v_mfma_f32_16x16x32_bf16 v[176:179], a[120:123], a[64:67], 0
    ds_read_b64_tr_b16 a[118:119], v25 offset:62720
    v_mfma_f32_16x16x32_bf16 v[176:179], a[124:127], a[68:71], v[176:179]
    buffer_load_dwordx4 v17, s[64:67], s84 offen offset:1024 lds
    v_mfma_f32_16x16x32_bf16 v[172:175], a[120:123], a[24:27], 0
    ds_read_b128 a[32:35], v23 offset:32768
    v_mfma_f32_16x16x32_bf16 v[172:175], a[124:127], a[28:31], v[172:175]
    v_mfma_f32_16x16x32_bf16 v[168:171], a[120:123], a[16:19], 0
    ds_read_b128 a[36:39], v24 offset:32768
    v_mfma_f32_16x16x32_bf16 v[168:171], a[124:127], a[20:23], v[168:171]
    v_mfma_f32_16x16x32_bf16 v[164:167], a[120:123], a[8:11], 0
    ds_read_b128 a[40:43], v23 offset:34816
    v_mfma_f32_16x16x32_bf16 v[164:167], a[124:127], a[12:15], v[164:167]
    v_mfma_f32_16x16x32_bf16 v[160:163], a[120:123], a[0:3], 0
    ds_read_b128 a[44:47], v24 offset:34816
    buffer_load_dwordx4 v18, s[64:67], s84 offen offset:2048 lds
    v_mfma_f32_16x16x32_bf16 v[160:163], a[124:127], a[4:7], v[160:163]
    v_mfma_f32_16x16x32_bf16 v[192:195], a[96:99], a[0:3], 0
    ds_read_b64_tr_b16 a[120:121], v26 offset:41984
    v_mfma_f32_16x16x32_bf16 v[192:195], a[100:103], a[4:7], v[192:195]
    v_mfma_f32_16x16x32_bf16 v[196:199], a[96:99], a[8:11], 0
    ds_read_b64_tr_b16 a[122:123], v26 offset:42240
    v_mfma_f32_16x16x32_bf16 v[196:199], a[100:103], a[12:15], v[196:199]
    v_mfma_f32_16x16x32_bf16 v[200:203], a[96:99], a[16:19], 0
    ds_read_b64_tr_b16 a[124:125], v26 offset:62464
    buffer_load_dwordx4 v19, s[64:67], s84 offen offset:3072 lds
    v_mfma_f32_16x16x32_bf16 v[200:203], a[100:103], a[20:23], v[200:203]
    v_mfma_f32_16x16x32_bf16 v[204:207], a[96:99], a[24:27], 0
    ds_read_b64_tr_b16 a[126:127], v26 offset:62720
    v_mfma_f32_16x16x32_bf16 v[204:207], a[100:103], a[28:31], v[204:207]
    v_mfma_f32_16x16x32_bf16 v[208:211], a[96:99], a[64:67], 0
    ds_read_b128 a[48:51], v23 offset:36864
    v_mfma_f32_16x16x32_bf16 v[208:211], a[100:103], a[68:71], v[208:211]
    v_mfma_f32_16x16x32_bf16 v[212:215], a[96:99], a[72:75], 0
    ds_read_b128 a[52:55], v24 offset:36864
    s_add_u32 m0, s91, 69632
    v_mfma_f32_16x16x32_bf16 v[212:215], a[100:103], a[76:79], v[212:215]
    buffer_load_dwordx4 v20, s[64:67], s84 offen offset:0 lds
    v_mfma_f32_16x16x32_bf16 v[216:219], a[96:99], a[80:83], 0
    ds_read_b128 a[56:59], v23 offset:38912
    v_mfma_f32_16x16x32_bf16 v[216:219], a[100:103], a[84:87], v[216:219]
    v_mfma_f32_16x16x32_bf16 v[220:223], a[96:99], a[88:91], 0
    ds_read_b128 a[60:63], v24 offset:38912
    v_mfma_f32_16x16x32_bf16 v[220:223], a[100:103], a[92:95], v[220:223]
    v_mfma_f32_16x16x32_bf16 v[252:255], a[104:107], a[88:91], 0
    ds_read_b64_tr_b16 a[96:97], v25 offset:40960
    v_mfma_f32_16x16x32_bf16 v[252:255], a[108:111], a[92:95], v[252:255]
    buffer_load_dwordx4 v21, s[64:67], s84 offen offset:1024 lds
    v_mfma_f32_16x16x32_bf16 v[248:251], a[104:107], a[80:83], 0
    ds_read_b128 a[88:91], v23 offset:47104
    v_mfma_f32_16x16x32_bf16 v[248:251], a[108:111], a[84:87], v[248:251]
    ds_read_b128 a[92:95], v24 offset:47104
    v_mfma_f32_16x16x32_bf16 v[244:247], a[104:107], a[72:75], 0
    ds_read_b128 a[80:83], v23 offset:45056
    v_mfma_f32_16x16x32_bf16 v[244:247], a[108:111], a[76:79], v[244:247]
    ds_read_b128 a[84:87], v24 offset:45056
    v_mfma_f32_16x16x32_bf16 v[240:243], a[104:107], a[64:67], 0
    v_mfma_f32_16x16x32_bf16 v[240:243], a[108:111], a[68:71], v[240:243]
    ds_read_b128 a[72:75], v23 offset:43008
    v_mfma_f32_16x16x32_bf16 v[236:239], a[104:107], a[24:27], 0
    ds_read_b128 a[76:79], v24 offset:43008
    buffer_load_dwordx4 v22, s[64:67], s84 offen offset:2048 lds
    v_mfma_f32_16x16x32_bf16 v[236:239], a[108:111], a[28:31], v[236:239]
    ds_read_b128 a[64:67], v23 offset:40960
    v_mfma_f32_16x16x32_bf16 v[232:235], a[104:107], a[16:19], 0
    ds_read_b128 a[68:71], v24 offset:40960
    v_mfma_f32_16x16x32_bf16 v[232:235], a[108:111], a[20:23], v[232:235]
    ds_read_b64_tr_b16 a[98:99], v25 offset:41216
    v_mfma_f32_16x16x32_bf16 v[228:231], a[104:107], a[8:11], 0
    v_mfma_f32_16x16x32_bf16 v[228:231], a[108:111], a[12:15], v[228:231]
    ds_read_b64_tr_b16 a[100:101], v25 offset:61440
    v_mfma_f32_16x16x32_bf16 v[224:227], a[104:107], a[0:3], 0
    buffer_load_dwordx4 v14, s[60:63], s83 offen offset:3072 lds
    v_mfma_f32_16x16x32_bf16 v[224:227], a[108:111], a[4:7], v[224:227]
    ds_read_b64_tr_b16 a[102:103], v25 offset:61696
    s_mov_b32 s48, 6
gated_mix__softmax_full_mha__glu_gated_bilinear__prompt_kernel_c0loop:
    s_waitcnt lgkmcnt(15)
    v_mfma_f32_16x16x32_bf16 v[64:67], a[112:115], a[32:35], v[64:67]
    ds_read_b64_tr_b16 a[104:105], v26 offset:40960
    v_mfma_f32_16x16x32_bf16 v[64:67], a[116:119], a[36:39], v[64:67]
    v_mfma_f32_16x16x32_bf16 v[68:71], a[112:115], a[40:43], v[68:71]
    ds_read_b64_tr_b16 a[106:107], v26 offset:41216
    v_mfma_f32_16x16x32_bf16 v[68:71], a[116:119], a[44:47], v[68:71]
    v_mfma_f32_16x16x32_bf16 v[72:75], a[112:115], a[48:51], v[72:75]
    ds_read_b64_tr_b16 a[108:109], v26 offset:61440
    s_waitcnt lgkmcnt(15)
    v_mfma_f32_16x16x32_bf16 v[72:75], a[116:119], a[52:55], v[72:75]
    s_add_u32 m0, s91, 73728
    v_mfma_f32_16x16x32_bf16 v[76:79], a[112:115], a[56:59], v[76:79]
    ds_read_b64_tr_b16 a[110:111], v26 offset:61696
    buffer_load_dwordx4 v15, s[60:63], s83 offen offset:0 lds
    v_mfma_f32_16x16x32_bf16 v[76:79], a[116:119], a[60:63], v[76:79]
    s_waitcnt lgkmcnt(8)
    v_mfma_f32_16x16x32_bf16 v[80:83], a[112:115], a[64:67], v[80:83]
    s_waitcnt lgkmcnt(7)
    v_mfma_f32_16x16x32_bf16 v[80:83], a[116:119], a[68:71], v[80:83]
    v_mfma_f32_16x16x32_bf16 v[84:87], a[112:115], a[72:75], v[84:87]
    v_mfma_f32_16x16x32_bf16 v[84:87], a[116:119], a[76:79], v[84:87]
    v_mfma_f32_16x16x32_bf16 v[88:91], a[112:115], a[80:83], v[88:91]
    v_mfma_f32_16x16x32_bf16 v[88:91], a[116:119], a[84:87], v[88:91]
    v_mfma_f32_16x16x32_bf16 v[92:95], a[112:115], a[88:91], v[92:95]
    buffer_load_dwordx4 v14, s[60:63], s83 offen offset:1024 lds
    v_mfma_f32_16x16x32_bf16 v[92:95], a[116:119], a[92:95], v[92:95]
    v_mfma_f32_16x16x32_bf16 v[124:127], a[120:123], a[88:91], v[124:127]
    ds_read_b64_tr_b16 a[112:113], v27 offset:40960
    v_mfma_f32_16x16x32_bf16 v[124:127], a[124:127], a[92:95], v[124:127]
    v_mfma_f32_16x16x32_bf16 v[120:123], a[120:123], a[80:83], v[120:123]
    ds_read_b64_tr_b16 a[114:115], v27 offset:42752
    v_mfma_f32_16x16x32_bf16 v[120:123], a[124:127], a[84:87], v[120:123]
    v_mfma_f32_16x16x32_bf16 v[116:119], a[120:123], a[72:75], v[116:119]
    ds_read_b64_tr_b16 a[116:117], v27 offset:51200
    v_mfma_f32_16x16x32_bf16 v[116:119], a[124:127], a[76:79], v[116:119]
    s_add_u32 m0, s90, 0
    v_mfma_f32_16x16x32_bf16 v[112:115], a[120:123], a[64:67], v[112:115]
    ds_read_b64_tr_b16 a[118:119], v27 offset:52992
    buffer_load_dwordx4 v6, s[56:59], s82 offen offset:0 lds
    v_mfma_f32_16x16x32_bf16 v[112:115], a[124:127], a[68:71], v[112:115]
    v_mfma_f32_16x16x32_bf16 v[108:111], a[120:123], a[56:59], v[108:111]
    v_mfma_f32_16x16x32_bf16 v[108:111], a[124:127], a[60:63], v[108:111]
    v_mfma_f32_16x16x32_bf16 v[104:107], a[120:123], a[48:51], v[104:107]
    buffer_load_dwordx4 v7, s[56:59], s82 offen offset:1024 lds
    v_mfma_f32_16x16x32_bf16 v[104:107], a[124:127], a[52:55], v[104:107]
    v_mfma_f32_16x16x32_bf16 v[100:103], a[120:123], a[40:43], v[100:103]
    v_mfma_f32_16x16x32_bf16 v[100:103], a[124:127], a[44:47], v[100:103]
    v_mfma_f32_16x16x32_bf16 v[96:99], a[120:123], a[32:35], v[96:99]
    buffer_load_dwordx4 v8, s[56:59], s82 offen offset:2048 lds
    v_mfma_f32_16x16x32_bf16 v[96:99], a[124:127], a[36:39], v[96:99]
    s_waitcnt lgkmcnt(10)
    v_mfma_f32_16x16x32_bf16 a[128:131], a[96:99], a[32:35], a[128:131]
    ds_read_b64_tr_b16 a[120:121], v28 offset:40960
    s_waitcnt lgkmcnt(9)
    v_mfma_f32_16x16x32_bf16 a[128:131], a[100:103], a[36:39], a[128:131]
    v_mfma_f32_16x16x32_bf16 a[132:135], a[96:99], a[40:43], a[132:135]
    ds_read_b64_tr_b16 a[122:123], v28 offset:42752
    buffer_load_dwordx4 v9, s[56:59], s82 offen offset:3072 lds
    v_mfma_f32_16x16x32_bf16 a[132:135], a[100:103], a[44:47], a[132:135]
    v_mfma_f32_16x16x32_bf16 a[136:139], a[96:99], a[48:51], a[136:139]
    ds_read_b64_tr_b16 a[124:125], v28 offset:51200
    v_mfma_f32_16x16x32_bf16 a[136:139], a[100:103], a[52:55], a[136:139]
    s_add_u32 m0, s90, 4096
    v_mfma_f32_16x16x32_bf16 a[140:143], a[96:99], a[56:59], a[140:143]
    ds_read_b64_tr_b16 a[126:127], v28 offset:52992
    buffer_load_dwordx4 v10, s[56:59], s82 offen offset:0 lds
    v_mfma_f32_16x16x32_bf16 a[140:143], a[100:103], a[60:63], a[140:143]
    v_mfma_f32_16x16x32_bf16 a[144:147], a[96:99], a[64:67], a[144:147]
    v_mfma_f32_16x16x32_bf16 a[144:147], a[100:103], a[68:71], a[144:147]
    v_mfma_f32_16x16x32_bf16 a[148:151], a[96:99], a[72:75], a[148:151]
    buffer_load_dwordx4 v11, s[56:59], s82 offen offset:1024 lds
    v_mfma_f32_16x16x32_bf16 a[148:151], a[100:103], a[76:79], a[148:151]
    v_mfma_f32_16x16x32_bf16 a[152:155], a[96:99], a[80:83], a[152:155]
    v_mfma_f32_16x16x32_bf16 a[152:155], a[100:103], a[84:87], a[152:155]
    v_mfma_f32_16x16x32_bf16 a[156:159], a[96:99], a[88:91], a[156:159]
    buffer_load_dwordx4 v12, s[56:59], s82 offen offset:2048 lds
    v_mfma_f32_16x16x32_bf16 a[156:159], a[100:103], a[92:95], a[156:159]
    s_waitcnt lgkmcnt(10)
    v_mfma_f32_16x16x32_bf16 a[188:191], a[104:107], a[88:91], a[188:191]
    ds_read_b64_tr_b16 a[96:97], v27 offset:40992
    s_waitcnt lgkmcnt(9)
    v_mfma_f32_16x16x32_bf16 a[188:191], a[108:111], a[92:95], a[188:191]
    v_mfma_f32_16x16x32_bf16 a[184:187], a[104:107], a[80:83], a[184:187]
    ds_read_b64_tr_b16 a[98:99], v27 offset:42784
    buffer_load_dwordx4 v13, s[56:59], s82 offen offset:3072 lds
    v_mfma_f32_16x16x32_bf16 a[184:187], a[108:111], a[84:87], a[184:187]
    v_mfma_f32_16x16x32_bf16 a[180:183], a[104:107], a[72:75], a[180:183]
    ds_read_b64_tr_b16 a[100:101], v27 offset:51232
    s_add_u32 s83, s83, 393216
    v_mfma_f32_16x16x32_bf16 a[180:183], a[108:111], a[76:79], a[180:183]
    s_add_u32 s84, s84, 458752
    v_mfma_f32_16x16x32_bf16 a[176:179], a[104:107], a[64:67], a[176:179]
    ds_read_b64_tr_b16 a[102:103], v27 offset:53024
    s_add_u32 s82, s82, 128
    v_mfma_f32_16x16x32_bf16 a[176:179], a[108:111], a[68:71], a[176:179]
    buffer_load_dword v2, v33, s[68:71], s85 offen
    v_mfma_f32_16x16x32_bf16 a[172:175], a[104:107], a[56:59], a[172:175]
    s_add_u32 s85, s85, s86
    v_mfma_f32_16x16x32_bf16 a[172:175], a[108:111], a[60:63], a[172:175]
    buffer_load_dword v2, v32, s[72:75], s81 offen
    v_mfma_f32_16x16x32_bf16 a[168:171], a[104:107], a[48:51], a[168:171]
    s_add_u32 s81, s81, 786432
    v_mfma_f32_16x16x32_bf16 a[168:171], a[108:111], a[52:55], a[168:171]
    v_mfma_f32_16x16x32_bf16 a[164:167], a[104:107], a[40:43], a[164:167]
    v_mfma_f32_16x16x32_bf16 a[164:167], a[108:111], a[44:47], a[164:167]
    v_mfma_f32_16x16x32_bf16 a[160:163], a[104:107], a[32:35], a[160:163]
    v_mfma_f32_16x16x32_bf16 a[160:163], a[108:111], a[36:39], a[160:163]
    s_waitcnt lgkmcnt(10)
    v_mfma_f32_16x16x32_bf16 a[192:195], a[112:115], a[32:35], a[192:195]
    ds_read_b64_tr_b16 a[104:105], v28 offset:40992
    s_waitcnt lgkmcnt(9)
    v_mfma_f32_16x16x32_bf16 a[192:195], a[116:119], a[36:39], a[192:195]
    v_mfma_f32_16x16x32_bf16 a[196:199], a[112:115], a[40:43], a[196:199]
    ds_read_b64_tr_b16 a[106:107], v28 offset:42784
    v_mfma_f32_16x16x32_bf16 a[196:199], a[116:119], a[44:47], a[196:199]
    v_mfma_f32_16x16x32_bf16 a[200:203], a[112:115], a[48:51], a[200:203]
    ds_read_b64_tr_b16 a[108:109], v28 offset:51232
    v_mfma_f32_16x16x32_bf16 a[200:203], a[116:119], a[52:55], a[200:203]
    v_mfma_f32_16x16x32_bf16 a[204:207], a[112:115], a[56:59], a[204:207]
    ds_read_b64_tr_b16 a[110:111], v28 offset:53024
    v_mfma_f32_16x16x32_bf16 a[204:207], a[116:119], a[60:63], a[204:207]
    v_mfma_f32_16x16x32_bf16 a[208:211], a[112:115], a[64:67], a[208:211]
    v_mfma_f32_16x16x32_bf16 a[208:211], a[116:119], a[68:71], a[208:211]
    v_mfma_f32_16x16x32_bf16 a[212:215], a[112:115], a[72:75], a[212:215]
    v_mfma_f32_16x16x32_bf16 a[212:215], a[116:119], a[76:79], a[212:215]
    v_mfma_f32_16x16x32_bf16 a[216:219], a[112:115], a[80:83], a[216:219]
    v_mfma_f32_16x16x32_bf16 a[216:219], a[116:119], a[84:87], a[216:219]
    v_mfma_f32_16x16x32_bf16 a[220:223], a[112:115], a[88:91], a[220:223]
    v_mfma_f32_16x16x32_bf16 a[220:223], a[116:119], a[92:95], a[220:223]
    s_waitcnt lgkmcnt(10)
    v_mfma_f32_16x16x32_bf16 a[252:255], a[120:123], a[88:91], a[252:255]
    ds_read_b64_tr_b16 a[112:113], v27 offset:41024
    s_waitcnt lgkmcnt(9)
    v_mfma_f32_16x16x32_bf16 a[252:255], a[124:127], a[92:95], a[252:255]
    v_mfma_f32_16x16x32_bf16 a[248:251], a[120:123], a[80:83], a[248:251]
    ds_read_b64_tr_b16 a[114:115], v27 offset:42816
    v_mfma_f32_16x16x32_bf16 a[248:251], a[124:127], a[84:87], a[248:251]
    v_mfma_f32_16x16x32_bf16 a[244:247], a[120:123], a[72:75], a[244:247]
    ds_read_b64_tr_b16 a[116:117], v27 offset:51264
    v_mfma_f32_16x16x32_bf16 a[244:247], a[124:127], a[76:79], a[244:247]
    v_mfma_f32_16x16x32_bf16 a[240:243], a[120:123], a[64:67], a[240:243]
    ds_read_b64_tr_b16 a[118:119], v27 offset:53056
    v_mfma_f32_16x16x32_bf16 a[240:243], a[124:127], a[68:71], a[240:243]
    v_mfma_f32_16x16x32_bf16 a[236:239], a[120:123], a[56:59], a[236:239]
    v_mfma_f32_16x16x32_bf16 a[236:239], a[124:127], a[60:63], a[236:239]
    v_mfma_f32_16x16x32_bf16 a[232:235], a[120:123], a[48:51], a[232:235]
    v_mfma_f32_16x16x32_bf16 a[232:235], a[124:127], a[52:55], a[232:235]
    v_mfma_f32_16x16x32_bf16 a[228:231], a[120:123], a[40:43], a[228:231]
    v_mfma_f32_16x16x32_bf16 a[228:231], a[124:127], a[44:47], a[228:231]
    v_mfma_f32_16x16x32_bf16 a[224:227], a[120:123], a[32:35], a[224:227]
    v_mfma_f32_16x16x32_bf16 a[224:227], a[124:127], a[36:39], a[224:227]
    s_waitcnt lgkmcnt(10)
    v_mfma_f32_16x16x32_bf16 v[128:131], a[96:99], a[32:35], v[128:131]
    ds_read_b64_tr_b16 a[120:121], v28 offset:41024
    s_waitcnt lgkmcnt(9)
    v_mfma_f32_16x16x32_bf16 v[128:131], a[100:103], a[36:39], v[128:131]
    v_mfma_f32_16x16x32_bf16 v[132:135], a[96:99], a[40:43], v[132:135]
    ds_read_b64_tr_b16 a[122:123], v28 offset:42816
    v_mfma_f32_16x16x32_bf16 v[132:135], a[100:103], a[44:47], v[132:135]
    v_mfma_f32_16x16x32_bf16 v[136:139], a[96:99], a[48:51], v[136:139]
    ds_read_b64_tr_b16 a[124:125], v28 offset:51264
    v_mfma_f32_16x16x32_bf16 v[136:139], a[100:103], a[52:55], v[136:139]
    v_mfma_f32_16x16x32_bf16 v[140:143], a[96:99], a[56:59], v[140:143]
    ds_read_b64_tr_b16 a[126:127], v28 offset:53056
    v_mfma_f32_16x16x32_bf16 v[140:143], a[100:103], a[60:63], v[140:143]
    v_mfma_f32_16x16x32_bf16 v[144:147], a[96:99], a[64:67], v[144:147]
    v_mfma_f32_16x16x32_bf16 v[144:147], a[100:103], a[68:71], v[144:147]
    v_mfma_f32_16x16x32_bf16 v[148:151], a[96:99], a[72:75], v[148:151]
    v_mfma_f32_16x16x32_bf16 v[148:151], a[100:103], a[76:79], v[148:151]
    v_mfma_f32_16x16x32_bf16 v[152:155], a[96:99], a[80:83], v[152:155]
    v_mfma_f32_16x16x32_bf16 v[152:155], a[100:103], a[84:87], v[152:155]
    v_mfma_f32_16x16x32_bf16 v[156:159], a[96:99], a[88:91], v[156:159]
    v_mfma_f32_16x16x32_bf16 v[156:159], a[100:103], a[92:95], v[156:159]
    s_waitcnt vmcnt(2) lgkmcnt(0)
    s_barrier
    v_mfma_f32_16x16x32_bf16 v[188:191], a[104:107], a[88:91], v[188:191]
    ds_read_b64_tr_b16 a[96:97], v25 offset:1024
    s_add_u32 m0, s91, 106496
    v_mfma_f32_16x16x32_bf16 v[188:191], a[108:111], a[92:95], v[188:191]
    buffer_load_dwordx4 v16, s[64:67], s84 offen offset:0 lds
    v_mfma_f32_16x16x32_bf16 v[184:187], a[104:107], a[80:83], v[184:187]
    ds_read_b64_tr_b16 a[98:99], v25 offset:1280
    v_mfma_f32_16x16x32_bf16 v[184:187], a[108:111], a[84:87], v[184:187]
    v_mfma_f32_16x16x32_bf16 v[180:183], a[104:107], a[72:75], v[180:183]
    ds_read_b64_tr_b16 a[100:101], v25 offset:21504
    v_mfma_f32_16x16x32_bf16 v[180:183], a[108:111], a[76:79], v[180:183]
    v_mfma_f32_16x16x32_bf16 v[176:179], a[104:107], a[64:67], v[176:179]
    ds_read_b64_tr_b16 a[102:103], v25 offset:21760
    v_mfma_f32_16x16x32_bf16 v[176:179], a[108:111], a[68:71], v[176:179]
    buffer_load_dwordx4 v17, s[64:67], s84 offen offset:1024 lds
    v_mfma_f32_16x16x32_bf16 v[172:175], a[104:107], a[56:59], v[172:175]
    ds_read_b128 a[0:3], v23 offset:0
    v_mfma_f32_16x16x32_bf16 v[172:175], a[108:111], a[60:63], v[172:175]
    v_mfma_f32_16x16x32_bf16 v[168:171], a[104:107], a[48:51], v[168:171]
    ds_read_b128 a[4:7], v24 offset:0
    v_mfma_f32_16x16x32_bf16 v[168:171], a[108:111], a[52:55], v[168:171]
    v_mfma_f32_16x16x32_bf16 v[164:167], a[104:107], a[40:43], v[164:167]
    ds_read_b128 a[8:11], v23 offset:2048
    v_mfma_f32_16x16x32_bf16 v[164:167], a[108:111], a[44:47], v[164:167]
    v_mfma_f32_16x16x32_bf16 v[160:163], a[104:107], a[32:35], v[160:163]
    ds_read_b128 a[12:15], v24 offset:2048
    buffer_load_dwordx4 v18, s[64:67], s84 offen offset:2048 lds
    v_mfma_f32_16x16x32_bf16 v[160:163], a[108:111], a[36:39], v[160:163]
    v_mfma_f32_16x16x32_bf16 v[192:195], a[112:115], a[32:35], v[192:195]
    ds_read_b64_tr_b16 a[104:105], v26 offset:1024
    v_mfma_f32_16x16x32_bf16 v[192:195], a[116:119], a[36:39], v[192:195]
    v_mfma_f32_16x16x32_bf16 v[196:199], a[112:115], a[40:43], v[196:199]
    ds_read_b64_tr_b16 a[106:107], v26 offset:1280
    v_mfma_f32_16x16x32_bf16 v[196:199], a[116:119], a[44:47], v[196:199]
    v_mfma_f32_16x16x32_bf16 v[200:203], a[112:115], a[48:51], v[200:203]
    ds_read_b64_tr_b16 a[108:109], v26 offset:21504
    buffer_load_dwordx4 v19, s[64:67], s84 offen offset:3072 lds
    v_mfma_f32_16x16x32_bf16 v[200:203], a[116:119], a[52:55], v[200:203]
    v_mfma_f32_16x16x32_bf16 v[204:207], a[112:115], a[56:59], v[204:207]
    ds_read_b64_tr_b16 a[110:111], v26 offset:21760
    v_mfma_f32_16x16x32_bf16 v[204:207], a[116:119], a[60:63], v[204:207]
    v_mfma_f32_16x16x32_bf16 v[208:211], a[112:115], a[64:67], v[208:211]
    ds_read_b128 a[16:19], v23 offset:4096
    v_mfma_f32_16x16x32_bf16 v[208:211], a[116:119], a[68:71], v[208:211]
    v_mfma_f32_16x16x32_bf16 v[212:215], a[112:115], a[72:75], v[212:215]
    ds_read_b128 a[20:23], v24 offset:4096
    s_add_u32 m0, s91, 110592
    v_mfma_f32_16x16x32_bf16 v[212:215], a[116:119], a[76:79], v[212:215]
    buffer_load_dwordx4 v20, s[64:67], s84 offen offset:0 lds
    v_mfma_f32_16x16x32_bf16 v[216:219], a[112:115], a[80:83], v[216:219]
    ds_read_b128 a[24:27], v23 offset:6144
    v_mfma_f32_16x16x32_bf16 v[216:219], a[116:119], a[84:87], v[216:219]
    v_mfma_f32_16x16x32_bf16 v[220:223], a[112:115], a[88:91], v[220:223]
    ds_read_b128 a[28:31], v24 offset:6144
    v_mfma_f32_16x16x32_bf16 v[220:223], a[116:119], a[92:95], v[220:223]
    v_mfma_f32_16x16x32_bf16 v[252:255], a[120:123], a[88:91], v[252:255]
    ds_read_b64_tr_b16 a[112:113], v25 offset:0
    v_mfma_f32_16x16x32_bf16 v[252:255], a[124:127], a[92:95], v[252:255]
    buffer_load_dwordx4 v21, s[64:67], s84 offen offset:1024 lds
    v_mfma_f32_16x16x32_bf16 v[248:251], a[120:123], a[80:83], v[248:251]
    ds_read_b128 a[88:91], v23 offset:14336
    v_mfma_f32_16x16x32_bf16 v[248:251], a[124:127], a[84:87], v[248:251]
    ds_read_b128 a[92:95], v24 offset:14336
    v_mfma_f32_16x16x32_bf16 v[244:247], a[120:123], a[72:75], v[244:247]
    ds_read_b128 a[80:83], v23 offset:12288
    v_mfma_f32_16x16x32_bf16 v[244:247], a[124:127], a[76:79], v[244:247]
    ds_read_b128 a[84:87], v24 offset:12288
    v_mfma_f32_16x16x32_bf16 v[240:243], a[120:123], a[64:67], v[240:243]
    v_mfma_f32_16x16x32_bf16 v[240:243], a[124:127], a[68:71], v[240:243]
    ds_read_b128 a[72:75], v23 offset:10240
    v_mfma_f32_16x16x32_bf16 v[236:239], a[120:123], a[56:59], v[236:239]
    ds_read_b128 a[76:79], v24 offset:10240
    buffer_load_dwordx4 v22, s[64:67], s84 offen offset:2048 lds
    v_mfma_f32_16x16x32_bf16 v[236:239], a[124:127], a[60:63], v[236:239]
    ds_read_b128 a[64:67], v23 offset:8192
    v_mfma_f32_16x16x32_bf16 v[232:235], a[120:123], a[48:51], v[232:235]
    ds_read_b128 a[68:71], v24 offset:8192
    v_mfma_f32_16x16x32_bf16 v[232:235], a[124:127], a[52:55], v[232:235]
    ds_read_b64_tr_b16 a[114:115], v25 offset:256
    v_mfma_f32_16x16x32_bf16 v[228:231], a[120:123], a[40:43], v[228:231]
    v_mfma_f32_16x16x32_bf16 v[228:231], a[124:127], a[44:47], v[228:231]
    ds_read_b64_tr_b16 a[116:117], v25 offset:20480
    v_mfma_f32_16x16x32_bf16 v[224:227], a[120:123], a[32:35], v[224:227]
    buffer_load_dwordx4 v14, s[60:63], s83 offen offset:3072 lds
    v_mfma_f32_16x16x32_bf16 v[224:227], a[124:127], a[36:39], v[224:227]
    ds_read_b64_tr_b16 a[118:119], v25 offset:20736
    s_waitcnt lgkmcnt(15)
    v_mfma_f32_16x16x32_bf16 v[64:67], a[96:99], a[0:3], v[64:67]
    ds_read_b64_tr_b16 a[120:121], v26 offset:0
    v_mfma_f32_16x16x32_bf16 v[64:67], a[100:103], a[4:7], v[64:67]
    v_mfma_f32_16x16x32_bf16 v[68:71], a[96:99], a[8:11], v[68:71]
    ds_read_b64_tr_b16 a[122:123], v26 offset:256
    v_mfma_f32_16x16x32_bf16 v[68:71], a[100:103], a[12:15], v[68:71]
    v_mfma_f32_16x16x32_bf16 v[72:75], a[96:99], a[16:19], v[72:75]
    ds_read_b64_tr_b16 a[124:125], v26 offset:20480
    s_waitcnt lgkmcnt(15)
    v_mfma_f32_16x16x32_bf16 v[72:75], a[100:103], a[20:23], v[72:75]
    s_add_u32 m0, s91, 114688
    v_mfma_f32_16x16x32_bf16 v[76:79], a[96:99], a[24:27], v[76:79]
    ds_read_b64_tr_b16 a[126:127], v26 offset:20736
    buffer_load_dwordx4 v15, s[60:63], s83 offen offset:0 lds
    v_mfma_f32_16x16x32_bf16 v[76:79], a[100:103], a[28:31], v[76:79]
    s_waitcnt lgkmcnt(8)
    v_mfma_f32_16x16x32_bf16 v[80:83], a[96:99], a[64:67], v[80:83]
    s_waitcnt lgkmcnt(7)
    v_mfma_f32_16x16x32_bf16 v[80:83], a[100:103], a[68:71], v[80:83]
    v_mfma_f32_16x16x32_bf16 v[84:87], a[96:99], a[72:75], v[84:87]
    v_mfma_f32_16x16x32_bf16 v[84:87], a[100:103], a[76:79], v[84:87]
    v_mfma_f32_16x16x32_bf16 v[88:91], a[96:99], a[80:83], v[88:91]
    v_mfma_f32_16x16x32_bf16 v[88:91], a[100:103], a[84:87], v[88:91]
    v_mfma_f32_16x16x32_bf16 v[92:95], a[96:99], a[88:91], v[92:95]
    buffer_load_dwordx4 v14, s[60:63], s83 offen offset:1024 lds
    v_mfma_f32_16x16x32_bf16 v[92:95], a[100:103], a[92:95], v[92:95]
    v_mfma_f32_16x16x32_bf16 v[124:127], a[104:107], a[88:91], v[124:127]
    ds_read_b64_tr_b16 a[96:97], v27 offset:0
    v_mfma_f32_16x16x32_bf16 v[124:127], a[108:111], a[92:95], v[124:127]
    v_mfma_f32_16x16x32_bf16 v[120:123], a[104:107], a[80:83], v[120:123]
    ds_read_b64_tr_b16 a[98:99], v27 offset:1792
    v_mfma_f32_16x16x32_bf16 v[120:123], a[108:111], a[84:87], v[120:123]
    v_mfma_f32_16x16x32_bf16 v[116:119], a[104:107], a[72:75], v[116:119]
    ds_read_b64_tr_b16 a[100:101], v27 offset:10240
    v_mfma_f32_16x16x32_bf16 v[116:119], a[108:111], a[76:79], v[116:119]
    s_add_u32 m0, s90, 32768
    v_mfma_f32_16x16x32_bf16 v[112:115], a[104:107], a[64:67], v[112:115]
    ds_read_b64_tr_b16 a[102:103], v27 offset:12032
    buffer_load_dwordx4 v6, s[56:59], s82 offen offset:0 lds
    v_mfma_f32_16x16x32_bf16 v[112:115], a[108:111], a[68:71], v[112:115]
    v_mfma_f32_16x16x32_bf16 v[108:111], a[104:107], a[24:27], v[108:111]
    v_mfma_f32_16x16x32_bf16 v[108:111], a[108:111], a[28:31], v[108:111]
    v_mfma_f32_16x16x32_bf16 v[104:107], a[104:107], a[16:19], v[104:107]
    buffer_load_dwordx4 v7, s[56:59], s82 offen offset:1024 lds
    v_mfma_f32_16x16x32_bf16 v[104:107], a[108:111], a[20:23], v[104:107]
    v_mfma_f32_16x16x32_bf16 v[100:103], a[104:107], a[8:11], v[100:103]
    v_mfma_f32_16x16x32_bf16 v[100:103], a[108:111], a[12:15], v[100:103]
    v_mfma_f32_16x16x32_bf16 v[96:99], a[104:107], a[0:3], v[96:99]
    buffer_load_dwordx4 v8, s[56:59], s82 offen offset:2048 lds
    v_mfma_f32_16x16x32_bf16 v[96:99], a[108:111], a[4:7], v[96:99]
    s_waitcnt lgkmcnt(10)
    v_mfma_f32_16x16x32_bf16 a[128:131], a[112:115], a[0:3], a[128:131]
    ds_read_b64_tr_b16 a[104:105], v28 offset:0
    s_waitcnt lgkmcnt(9)
    v_mfma_f32_16x16x32_bf16 a[128:131], a[116:119], a[4:7], a[128:131]
    v_mfma_f32_16x16x32_bf16 a[132:135], a[112:115], a[8:11], a[132:135]
    ds_read_b64_tr_b16 a[106:107], v28 offset:1792
    buffer_load_dwordx4 v9, s[56:59], s82 offen offset:3072 lds
    v_mfma_f32_16x16x32_bf16 a[132:135], a[116:119], a[12:15], a[132:135]
    v_mfma_f32_16x16x32_bf16 a[136:139], a[112:115], a[16:19], a[136:139]
    ds_read_b64_tr_b16 a[108:109], v28 offset:10240
    v_mfma_f32_16x16x32_bf16 a[136:139], a[116:119], a[20:23], a[136:139]
    s_add_u32 m0, s90, 36864
    v_mfma_f32_16x16x32_bf16 a[140:143], a[112:115], a[24:27], a[140:143]
    ds_read_b64_tr_b16 a[110:111], v28 offset:12032
    buffer_load_dwordx4 v10, s[56:59], s82 offen offset:0 lds
    v_mfma_f32_16x16x32_bf16 a[140:143], a[116:119], a[28:31], a[140:143]
    v_mfma_f32_16x16x32_bf16 a[144:147], a[112:115], a[64:67], a[144:147]
    v_mfma_f32_16x16x32_bf16 a[144:147], a[116:119], a[68:71], a[144:147]
    v_mfma_f32_16x16x32_bf16 a[148:151], a[112:115], a[72:75], a[148:151]
    buffer_load_dwordx4 v11, s[56:59], s82 offen offset:1024 lds
    v_mfma_f32_16x16x32_bf16 a[148:151], a[116:119], a[76:79], a[148:151]
    v_mfma_f32_16x16x32_bf16 a[152:155], a[112:115], a[80:83], a[152:155]
    v_mfma_f32_16x16x32_bf16 a[152:155], a[116:119], a[84:87], a[152:155]
    v_mfma_f32_16x16x32_bf16 a[156:159], a[112:115], a[88:91], a[156:159]
    buffer_load_dwordx4 v12, s[56:59], s82 offen offset:2048 lds
    v_mfma_f32_16x16x32_bf16 a[156:159], a[116:119], a[92:95], a[156:159]
    s_waitcnt lgkmcnt(10)
    v_mfma_f32_16x16x32_bf16 a[188:191], a[120:123], a[88:91], a[188:191]
    ds_read_b64_tr_b16 a[112:113], v27 offset:32
    s_waitcnt lgkmcnt(9)
    v_mfma_f32_16x16x32_bf16 a[188:191], a[124:127], a[92:95], a[188:191]
    v_mfma_f32_16x16x32_bf16 a[184:187], a[120:123], a[80:83], a[184:187]
    ds_read_b64_tr_b16 a[114:115], v27 offset:1824
    buffer_load_dwordx4 v13, s[56:59], s82 offen offset:3072 lds
    v_mfma_f32_16x16x32_bf16 a[184:187], a[124:127], a[84:87], a[184:187]
    v_mfma_f32_16x16x32_bf16 a[180:183], a[120:123], a[72:75], a[180:183]
    ds_read_b64_tr_b16 a[116:117], v27 offset:10272
    s_add_u32 s83, s83, 393216
    v_mfma_f32_16x16x32_bf16 a[180:183], a[124:127], a[76:79], a[180:183]
    s_add_u32 s84, s84, 458752
    v_mfma_f32_16x16x32_bf16 a[176:179], a[120:123], a[64:67], a[176:179]
    ds_read_b64_tr_b16 a[118:119], v27 offset:12064
    s_add_u32 s82, s82, 128
    v_mfma_f32_16x16x32_bf16 a[176:179], a[124:127], a[68:71], a[176:179]
    buffer_load_dword v2, v33, s[68:71], s85 offen
    v_mfma_f32_16x16x32_bf16 a[172:175], a[120:123], a[24:27], a[172:175]
    s_add_u32 s85, s85, s86
    v_mfma_f32_16x16x32_bf16 a[172:175], a[124:127], a[28:31], a[172:175]
    buffer_load_dword v2, v32, s[72:75], s81 offen
    v_mfma_f32_16x16x32_bf16 a[168:171], a[120:123], a[16:19], a[168:171]
    s_add_u32 s81, s81, 786432
    v_mfma_f32_16x16x32_bf16 a[168:171], a[124:127], a[20:23], a[168:171]
    v_mfma_f32_16x16x32_bf16 a[164:167], a[120:123], a[8:11], a[164:167]
    v_mfma_f32_16x16x32_bf16 a[164:167], a[124:127], a[12:15], a[164:167]
    s_cmp_eq_u32 s48, s88
    v_mfma_f32_16x16x32_bf16 a[160:163], a[120:123], a[0:3], a[160:163]
    v_mfma_f32_16x16x32_bf16 a[160:163], a[124:127], a[4:7], a[160:163]
    s_cselect_b32 s45, s89, 2.0
    s_waitcnt lgkmcnt(10)
    v_mfma_f32_16x16x32_bf16 a[192:195], a[96:99], a[0:3], a[192:195]
    ds_read_b64_tr_b16 a[120:121], v28 offset:32
    s_waitcnt lgkmcnt(9)
    v_mfma_f32_16x16x32_bf16 a[192:195], a[100:103], a[4:7], a[192:195]
    buffer_atomic_add v31, v30, s[36:39], s45 offen offset:64 sc1
    v_mfma_f32_16x16x32_bf16 a[196:199], a[96:99], a[8:11], a[196:199]
    ds_read_b64_tr_b16 a[122:123], v28 offset:1824
    v_mfma_f32_16x16x32_bf16 a[196:199], a[100:103], a[12:15], a[196:199]
    v_mfma_f32_16x16x32_bf16 a[200:203], a[96:99], a[16:19], a[200:203]
    ds_read_b64_tr_b16 a[124:125], v28 offset:10272
    s_cmp_eq_u32 s48, 2
    v_mfma_f32_16x16x32_bf16 a[200:203], a[100:103], a[20:23], a[200:203]
    v_mfma_f32_16x16x32_bf16 a[204:207], a[96:99], a[24:27], a[204:207]
    ds_read_b64_tr_b16 a[126:127], v28 offset:12064
    s_cselect_b32 s45, 0, 2.0
    v_mfma_f32_16x16x32_bf16 a[204:207], a[100:103], a[28:31], a[204:207]
    v_mfma_f32_16x16x32_bf16 a[208:211], a[96:99], a[64:67], a[208:211]
    buffer_load_dword v2, v35, s[76:79], s45 offen
    v_mfma_f32_16x16x32_bf16 a[208:211], a[100:103], a[68:71], a[208:211]
    v_mfma_f32_16x16x32_bf16 a[212:215], a[96:99], a[72:75], a[212:215]
    v_mfma_f32_16x16x32_bf16 a[212:215], a[100:103], a[76:79], a[212:215]
    global_load_dword v2, v[60:61], off
    v_mfma_f32_16x16x32_bf16 a[216:219], a[96:99], a[80:83], a[216:219]
    v_mfma_f32_16x16x32_bf16 a[216:219], a[100:103], a[84:87], a[216:219]
    v_mfma_f32_16x16x32_bf16 a[220:223], a[96:99], a[88:91], a[220:223]
    v_mfma_f32_16x16x32_bf16 a[220:223], a[100:103], a[92:95], a[220:223]
    s_waitcnt lgkmcnt(10)
    v_mfma_f32_16x16x32_bf16 a[252:255], a[104:107], a[88:91], a[252:255]
    ds_read_b64_tr_b16 a[96:97], v27 offset:64
    s_waitcnt lgkmcnt(9)
    v_mfma_f32_16x16x32_bf16 a[252:255], a[108:111], a[92:95], a[252:255]
    v_mfma_f32_16x16x32_bf16 a[248:251], a[104:107], a[80:83], a[248:251]
    ds_read_b64_tr_b16 a[98:99], v27 offset:1856
    v_mfma_f32_16x16x32_bf16 a[248:251], a[108:111], a[84:87], a[248:251]
    v_mfma_f32_16x16x32_bf16 a[244:247], a[104:107], a[72:75], a[244:247]
    ds_read_b64_tr_b16 a[100:101], v27 offset:10304
    v_mfma_f32_16x16x32_bf16 a[244:247], a[108:111], a[76:79], a[244:247]
    v_mfma_f32_16x16x32_bf16 a[240:243], a[104:107], a[64:67], a[240:243]
    ds_read_b64_tr_b16 a[102:103], v27 offset:12096
    v_mfma_f32_16x16x32_bf16 a[240:243], a[108:111], a[68:71], a[240:243]
    v_mfma_f32_16x16x32_bf16 a[236:239], a[104:107], a[24:27], a[236:239]
    v_mfma_f32_16x16x32_bf16 a[236:239], a[108:111], a[28:31], a[236:239]
    v_mfma_f32_16x16x32_bf16 a[232:235], a[104:107], a[16:19], a[232:235]
    v_mfma_f32_16x16x32_bf16 a[232:235], a[108:111], a[20:23], a[232:235]
    v_mfma_f32_16x16x32_bf16 a[228:231], a[104:107], a[8:11], a[228:231]
    v_mfma_f32_16x16x32_bf16 a[228:231], a[108:111], a[12:15], a[228:231]
    v_mfma_f32_16x16x32_bf16 a[224:227], a[104:107], a[0:3], a[224:227]
    v_mfma_f32_16x16x32_bf16 a[224:227], a[108:111], a[4:7], a[224:227]
    s_waitcnt lgkmcnt(10)
    v_mfma_f32_16x16x32_bf16 v[128:131], a[112:115], a[0:3], v[128:131]
    ds_read_b64_tr_b16 a[104:105], v28 offset:64
    s_waitcnt lgkmcnt(9)
    v_mfma_f32_16x16x32_bf16 v[128:131], a[116:119], a[4:7], v[128:131]
    v_mfma_f32_16x16x32_bf16 v[132:135], a[112:115], a[8:11], v[132:135]
    ds_read_b64_tr_b16 a[106:107], v28 offset:1856
    v_mfma_f32_16x16x32_bf16 v[132:135], a[116:119], a[12:15], v[132:135]
    v_mfma_f32_16x16x32_bf16 v[136:139], a[112:115], a[16:19], v[136:139]
    ds_read_b64_tr_b16 a[108:109], v28 offset:10304
    v_mfma_f32_16x16x32_bf16 v[136:139], a[116:119], a[20:23], v[136:139]
    v_mfma_f32_16x16x32_bf16 v[140:143], a[112:115], a[24:27], v[140:143]
    ds_read_b64_tr_b16 a[110:111], v28 offset:12096
    v_mfma_f32_16x16x32_bf16 v[140:143], a[116:119], a[28:31], v[140:143]
    v_mfma_f32_16x16x32_bf16 v[144:147], a[112:115], a[64:67], v[144:147]
    v_mfma_f32_16x16x32_bf16 v[144:147], a[116:119], a[68:71], v[144:147]
    v_mfma_f32_16x16x32_bf16 v[148:151], a[112:115], a[72:75], v[148:151]
    v_mfma_f32_16x16x32_bf16 v[148:151], a[116:119], a[76:79], v[148:151]
    v_mfma_f32_16x16x32_bf16 v[152:155], a[112:115], a[80:83], v[152:155]
    v_mfma_f32_16x16x32_bf16 v[152:155], a[116:119], a[84:87], v[152:155]
    v_mfma_f32_16x16x32_bf16 v[156:159], a[112:115], a[88:91], v[156:159]
    v_mfma_f32_16x16x32_bf16 v[156:159], a[116:119], a[92:95], v[156:159]
    s_waitcnt vmcnt(5) lgkmcnt(0)
    s_barrier
    v_mfma_f32_16x16x32_bf16 v[188:191], a[120:123], a[88:91], v[188:191]
    ds_read_b64_tr_b16 a[112:113], v25 offset:41984
    s_add_u32 m0, s91, 65536
    v_mfma_f32_16x16x32_bf16 v[188:191], a[124:127], a[92:95], v[188:191]
    buffer_load_dwordx4 v16, s[64:67], s84 offen offset:0 lds
    v_mfma_f32_16x16x32_bf16 v[184:187], a[120:123], a[80:83], v[184:187]
    ds_read_b64_tr_b16 a[114:115], v25 offset:42240
    v_mfma_f32_16x16x32_bf16 v[184:187], a[124:127], a[84:87], v[184:187]
    v_mfma_f32_16x16x32_bf16 v[180:183], a[120:123], a[72:75], v[180:183]
    ds_read_b64_tr_b16 a[116:117], v25 offset:62464
    v_mfma_f32_16x16x32_bf16 v[180:183], a[124:127], a[76:79], v[180:183]
    v_mfma_f32_16x16x32_bf16 v[176:179], a[120:123], a[64:67], v[176:179]
    ds_read_b64_tr_b16 a[118:119], v25 offset:62720
    v_mfma_f32_16x16x32_bf16 v[176:179], a[124:127], a[68:71], v[176:179]
    buffer_load_dwordx4 v17, s[64:67], s84 offen offset:1024 lds
    v_mfma_f32_16x16x32_bf16 v[172:175], a[120:123], a[24:27], v[172:175]
    ds_read_b128 a[32:35], v23 offset:32768
    v_mfma_f32_16x16x32_bf16 v[172:175], a[124:127], a[28:31], v[172:175]
    v_mfma_f32_16x16x32_bf16 v[168:171], a[120:123], a[16:19], v[168:171]
    ds_read_b128 a[36:39], v24 offset:32768
    v_mfma_f32_16x16x32_bf16 v[168:171], a[124:127], a[20:23], v[168:171]
    v_mfma_f32_16x16x32_bf16 v[164:167], a[120:123], a[8:11], v[164:167]
    ds_read_b128 a[40:43], v23 offset:34816
    v_mfma_f32_16x16x32_bf16 v[164:167], a[124:127], a[12:15], v[164:167]
    v_mfma_f32_16x16x32_bf16 v[160:163], a[120:123], a[0:3], v[160:163]
    ds_read_b128 a[44:47], v24 offset:34816
    buffer_load_dwordx4 v18, s[64:67], s84 offen offset:2048 lds
    v_mfma_f32_16x16x32_bf16 v[160:163], a[124:127], a[4:7], v[160:163]
    v_mfma_f32_16x16x32_bf16 v[192:195], a[96:99], a[0:3], v[192:195]
    ds_read_b64_tr_b16 a[120:121], v26 offset:41984
    v_mfma_f32_16x16x32_bf16 v[192:195], a[100:103], a[4:7], v[192:195]
    v_mfma_f32_16x16x32_bf16 v[196:199], a[96:99], a[8:11], v[196:199]
    ds_read_b64_tr_b16 a[122:123], v26 offset:42240
    v_mfma_f32_16x16x32_bf16 v[196:199], a[100:103], a[12:15], v[196:199]
    v_mfma_f32_16x16x32_bf16 v[200:203], a[96:99], a[16:19], v[200:203]
    ds_read_b64_tr_b16 a[124:125], v26 offset:62464
    buffer_load_dwordx4 v19, s[64:67], s84 offen offset:3072 lds
    v_mfma_f32_16x16x32_bf16 v[200:203], a[100:103], a[20:23], v[200:203]
    v_mfma_f32_16x16x32_bf16 v[204:207], a[96:99], a[24:27], v[204:207]
    ds_read_b64_tr_b16 a[126:127], v26 offset:62720
    v_mfma_f32_16x16x32_bf16 v[204:207], a[100:103], a[28:31], v[204:207]
    v_mfma_f32_16x16x32_bf16 v[208:211], a[96:99], a[64:67], v[208:211]
    ds_read_b128 a[48:51], v23 offset:36864
    v_mfma_f32_16x16x32_bf16 v[208:211], a[100:103], a[68:71], v[208:211]
    v_mfma_f32_16x16x32_bf16 v[212:215], a[96:99], a[72:75], v[212:215]
    ds_read_b128 a[52:55], v24 offset:36864
    s_add_u32 m0, s91, 69632
    v_mfma_f32_16x16x32_bf16 v[212:215], a[100:103], a[76:79], v[212:215]
    buffer_load_dwordx4 v20, s[64:67], s84 offen offset:0 lds
    v_mfma_f32_16x16x32_bf16 v[216:219], a[96:99], a[80:83], v[216:219]
    ds_read_b128 a[56:59], v23 offset:38912
    v_mfma_f32_16x16x32_bf16 v[216:219], a[100:103], a[84:87], v[216:219]
    v_mfma_f32_16x16x32_bf16 v[220:223], a[96:99], a[88:91], v[220:223]
    ds_read_b128 a[60:63], v24 offset:38912
    v_mfma_f32_16x16x32_bf16 v[220:223], a[100:103], a[92:95], v[220:223]
    v_mfma_f32_16x16x32_bf16 v[252:255], a[104:107], a[88:91], v[252:255]
    ds_read_b64_tr_b16 a[96:97], v25 offset:40960
    v_mfma_f32_16x16x32_bf16 v[252:255], a[108:111], a[92:95], v[252:255]
    buffer_load_dwordx4 v21, s[64:67], s84 offen offset:1024 lds
    v_mfma_f32_16x16x32_bf16 v[248:251], a[104:107], a[80:83], v[248:251]
    ds_read_b128 a[88:91], v23 offset:47104
    v_mfma_f32_16x16x32_bf16 v[248:251], a[108:111], a[84:87], v[248:251]
    ds_read_b128 a[92:95], v24 offset:47104
    v_mfma_f32_16x16x32_bf16 v[244:247], a[104:107], a[72:75], v[244:247]
    ds_read_b128 a[80:83], v23 offset:45056
    v_mfma_f32_16x16x32_bf16 v[244:247], a[108:111], a[76:79], v[244:247]
    ds_read_b128 a[84:87], v24 offset:45056
    v_mfma_f32_16x16x32_bf16 v[240:243], a[104:107], a[64:67], v[240:243]
    v_mfma_f32_16x16x32_bf16 v[240:243], a[108:111], a[68:71], v[240:243]
    ds_read_b128 a[72:75], v23 offset:43008
    v_mfma_f32_16x16x32_bf16 v[236:239], a[104:107], a[24:27], v[236:239]
    ds_read_b128 a[76:79], v24 offset:43008
    buffer_load_dwordx4 v22, s[64:67], s84 offen offset:2048 lds
    v_mfma_f32_16x16x32_bf16 v[236:239], a[108:111], a[28:31], v[236:239]
    ds_read_b128 a[64:67], v23 offset:40960
    v_mfma_f32_16x16x32_bf16 v[232:235], a[104:107], a[16:19], v[232:235]
    ds_read_b128 a[68:71], v24 offset:40960
    v_mfma_f32_16x16x32_bf16 v[232:235], a[108:111], a[20:23], v[232:235]
    ds_read_b64_tr_b16 a[98:99], v25 offset:41216
    v_mfma_f32_16x16x32_bf16 v[228:231], a[104:107], a[8:11], v[228:231]
    v_mfma_f32_16x16x32_bf16 v[228:231], a[108:111], a[12:15], v[228:231]
    ds_read_b64_tr_b16 a[100:101], v25 offset:61440
    v_mfma_f32_16x16x32_bf16 v[224:227], a[104:107], a[0:3], v[224:227]
    buffer_load_dwordx4 v14, s[60:63], s83 offen offset:3072 lds
    v_mfma_f32_16x16x32_bf16 v[224:227], a[108:111], a[4:7], v[224:227]
    ds_read_b64_tr_b16 a[102:103], v25 offset:61696
    s_sub_u32 s48, s48, 1
    s_cmp_lg_u32 s48, 0
    s_cbranch_scc1 gated_mix__softmax_full_mha__glu_gated_bilinear__prompt_kernel_c0loop
gated_mix__softmax_full_mha__glu_gated_bilinear__prompt_kernel_c0out:
    s_waitcnt lgkmcnt(15)
    v_mfma_f32_16x16x32_bf16 v[64:67], a[112:115], a[32:35], v[64:67]
    ds_read_b64_tr_b16 a[104:105], v26 offset:40960
    v_mfma_f32_16x16x32_bf16 v[64:67], a[116:119], a[36:39], v[64:67]
    v_mfma_f32_16x16x32_bf16 v[68:71], a[112:115], a[40:43], v[68:71]
    ds_read_b64_tr_b16 a[106:107], v26 offset:41216
    v_mfma_f32_16x16x32_bf16 v[68:71], a[116:119], a[44:47], v[68:71]
    v_mfma_f32_16x16x32_bf16 v[72:75], a[112:115], a[48:51], v[72:75]
    ds_read_b64_tr_b16 a[108:109], v26 offset:61440
    s_waitcnt lgkmcnt(15)
    v_mfma_f32_16x16x32_bf16 v[72:75], a[116:119], a[52:55], v[72:75]
    s_add_u32 m0, s91, 73728
    v_mfma_f32_16x16x32_bf16 v[76:79], a[112:115], a[56:59], v[76:79]
    ds_read_b64_tr_b16 a[110:111], v26 offset:61696
    buffer_load_dwordx4 v15, s[60:63], s83 offen offset:0 lds
    v_mfma_f32_16x16x32_bf16 v[76:79], a[116:119], a[60:63], v[76:79]
    s_waitcnt lgkmcnt(8)
    v_mfma_f32_16x16x32_bf16 v[80:83], a[112:115], a[64:67], v[80:83]
    s_waitcnt lgkmcnt(7)
    v_mfma_f32_16x16x32_bf16 v[80:83], a[116:119], a[68:71], v[80:83]
    v_mfma_f32_16x16x32_bf16 v[84:87], a[112:115], a[72:75], v[84:87]
    v_mfma_f32_16x16x32_bf16 v[84:87], a[116:119], a[76:79], v[84:87]
    v_mfma_f32_16x16x32_bf16 v[88:91], a[112:115], a[80:83], v[88:91]
    v_mfma_f32_16x16x32_bf16 v[88:91], a[116:119], a[84:87], v[88:91]
    v_mfma_f32_16x16x32_bf16 v[92:95], a[112:115], a[88:91], v[92:95]
    buffer_load_dwordx4 v14, s[60:63], s83 offen offset:1024 lds
    v_mfma_f32_16x16x32_bf16 v[92:95], a[116:119], a[92:95], v[92:95]
    v_mfma_f32_16x16x32_bf16 v[124:127], a[120:123], a[88:91], v[124:127]
    ds_read_b64_tr_b16 a[112:113], v27 offset:40960
    v_mfma_f32_16x16x32_bf16 v[124:127], a[124:127], a[92:95], v[124:127]
    v_mfma_f32_16x16x32_bf16 v[120:123], a[120:123], a[80:83], v[120:123]
    ds_read_b64_tr_b16 a[114:115], v27 offset:42752
    v_mfma_f32_16x16x32_bf16 v[120:123], a[124:127], a[84:87], v[120:123]
    v_mfma_f32_16x16x32_bf16 v[116:119], a[120:123], a[72:75], v[116:119]
    ds_read_b64_tr_b16 a[116:117], v27 offset:51200
    v_mfma_f32_16x16x32_bf16 v[116:119], a[124:127], a[76:79], v[116:119]
    s_add_u32 m0, s90, 0
    v_mfma_f32_16x16x32_bf16 v[112:115], a[120:123], a[64:67], v[112:115]
    ds_read_b64_tr_b16 a[118:119], v27 offset:52992
    buffer_load_dwordx4 v6, s[56:59], s82 offen offset:0 lds
    v_mfma_f32_16x16x32_bf16 v[112:115], a[124:127], a[68:71], v[112:115]
    v_mfma_f32_16x16x32_bf16 v[108:111], a[120:123], a[56:59], v[108:111]
    v_mfma_f32_16x16x32_bf16 v[108:111], a[124:127], a[60:63], v[108:111]
    v_mfma_f32_16x16x32_bf16 v[104:107], a[120:123], a[48:51], v[104:107]
    buffer_load_dwordx4 v7, s[56:59], s82 offen offset:1024 lds
    v_mfma_f32_16x16x32_bf16 v[104:107], a[124:127], a[52:55], v[104:107]
    v_mfma_f32_16x16x32_bf16 v[100:103], a[120:123], a[40:43], v[100:103]
    v_mfma_f32_16x16x32_bf16 v[100:103], a[124:127], a[44:47], v[100:103]
    v_mfma_f32_16x16x32_bf16 v[96:99], a[120:123], a[32:35], v[96:99]
    buffer_load_dwordx4 v8, s[56:59], s82 offen offset:2048 lds
    v_mfma_f32_16x16x32_bf16 v[96:99], a[124:127], a[36:39], v[96:99]
    s_waitcnt lgkmcnt(10)
    v_mfma_f32_16x16x32_bf16 a[128:131], a[96:99], a[32:35], a[128:131]
    ds_read_b64_tr_b16 a[120:121], v28 offset:40960
    s_waitcnt lgkmcnt(9)
    v_mfma_f32_16x16x32_bf16 a[128:131], a[100:103], a[36:39], a[128:131]
    v_mfma_f32_16x16x32_bf16 a[132:135], a[96:99], a[40:43], a[132:135]
    ds_read_b64_tr_b16 a[122:123], v28 offset:42752
    buffer_load_dwordx4 v9, s[56:59], s82 offen offset:3072 lds
    v_mfma_f32_16x16x32_bf16 a[132:135], a[100:103], a[44:47], a[132:135]
    v_mfma_f32_16x16x32_bf16 a[136:139], a[96:99], a[48:51], a[136:139]
    ds_read_b64_tr_b16 a[124:125], v28 offset:51200
    v_mfma_f32_16x16x32_bf16 a[136:139], a[100:103], a[52:55], a[136:139]
    s_add_u32 m0, s90, 4096
    v_mfma_f32_16x16x32_bf16 a[140:143], a[96:99], a[56:59], a[140:143]
    ds_read_b64_tr_b16 a[126:127], v28 offset:52992
    buffer_load_dwordx4 v10, s[56:59], s82 offen offset:0 lds
    v_mfma_f32_16x16x32_bf16 a[140:143], a[100:103], a[60:63], a[140:143]
    v_mfma_f32_16x16x32_bf16 a[144:147], a[96:99], a[64:67], a[144:147]
    v_mfma_f32_16x16x32_bf16 a[144:147], a[100:103], a[68:71], a[144:147]
    v_mfma_f32_16x16x32_bf16 a[148:151], a[96:99], a[72:75], a[148:151]
    buffer_load_dwordx4 v11, s[56:59], s82 offen offset:1024 lds
    v_mfma_f32_16x16x32_bf16 a[148:151], a[100:103], a[76:79], a[148:151]
    v_mfma_f32_16x16x32_bf16 a[152:155], a[96:99], a[80:83], a[152:155]
    v_mfma_f32_16x16x32_bf16 a[152:155], a[100:103], a[84:87], a[152:155]
    v_mfma_f32_16x16x32_bf16 a[156:159], a[96:99], a[88:91], a[156:159]
    buffer_load_dwordx4 v12, s[56:59], s82 offen offset:2048 lds
    v_mfma_f32_16x16x32_bf16 a[156:159], a[100:103], a[92:95], a[156:159]
    s_waitcnt lgkmcnt(10)
    v_mfma_f32_16x16x32_bf16 a[188:191], a[104:107], a[88:91], a[188:191]
    ds_read_b64_tr_b16 a[96:97], v27 offset:40992
    s_waitcnt lgkmcnt(9)
    v_mfma_f32_16x16x32_bf16 a[188:191], a[108:111], a[92:95], a[188:191]
    v_mfma_f32_16x16x32_bf16 a[184:187], a[104:107], a[80:83], a[184:187]
    ds_read_b64_tr_b16 a[98:99], v27 offset:42784
    buffer_load_dwordx4 v13, s[56:59], s82 offen offset:3072 lds
    v_mfma_f32_16x16x32_bf16 a[184:187], a[108:111], a[84:87], a[184:187]
    v_mfma_f32_16x16x32_bf16 a[180:183], a[104:107], a[72:75], a[180:183]
    ds_read_b64_tr_b16 a[100:101], v27 offset:51232
    s_add_u32 s83, s83, 393216
    v_mfma_f32_16x16x32_bf16 a[180:183], a[108:111], a[76:79], a[180:183]
    s_add_u32 s84, s84, 458752
    v_mfma_f32_16x16x32_bf16 a[176:179], a[104:107], a[64:67], a[176:179]
    ds_read_b64_tr_b16 a[102:103], v27 offset:53024
    s_add_u32 s82, s82, 128
    v_mfma_f32_16x16x32_bf16 a[176:179], a[108:111], a[68:71], a[176:179]
    s_cmp_eq_u32 s48, 0
    v_mfma_f32_16x16x32_bf16 a[172:175], a[104:107], a[56:59], a[172:175]
    s_cselect_b32 s45, s47, 2.0
    v_mfma_f32_16x16x32_bf16 a[172:175], a[108:111], a[60:63], a[172:175]
    s_cselect_b32 s46, 0, 2.0
    v_mfma_f32_16x16x32_bf16 a[168:171], a[104:107], a[48:51], a[168:171]
    s_cselect_b32 s76, s18, s76
    v_mfma_f32_16x16x32_bf16 a[168:171], a[108:111], a[52:55], a[168:171]
    s_cselect_b32 s77, s19, s77
    v_mfma_f32_16x16x32_bf16 a[164:167], a[104:107], a[40:43], a[164:167]
    s_cselect_b32 s78, 0x800, s78
    v_mfma_f32_16x16x32_bf16 a[164:167], a[108:111], a[44:47], a[164:167]
    buffer_load_dwordx4 v[52:55], v29, s[76:79], s46 offen offset:0
    v_mfma_f32_16x16x32_bf16 a[160:163], a[104:107], a[32:35], a[160:163]
    v_mfma_f32_16x16x32_bf16 a[160:163], a[108:111], a[36:39], a[160:163]
    s_waitcnt lgkmcnt(10)
    v_mfma_f32_16x16x32_bf16 a[192:195], a[112:115], a[32:35], a[192:195]
    ds_read_b64_tr_b16 a[104:105], v28 offset:40992
    buffer_load_dwordx4 v[56:59], v29, s[76:79], s46 offen offset:16
    s_waitcnt lgkmcnt(9)
    v_mfma_f32_16x16x32_bf16 a[192:195], a[116:119], a[36:39], a[192:195]
    v_mfma_f32_16x16x32_bf16 a[196:199], a[112:115], a[40:43], a[196:199]
    ds_read_b64_tr_b16 a[106:107], v28 offset:42784
    v_mfma_f32_16x16x32_bf16 a[196:199], a[116:119], a[44:47], a[196:199]
    buffer_load_dwordx4 v[36:39], v29, s[56:59], s45 offen offset:0
    v_mfma_f32_16x16x32_bf16 a[200:203], a[112:115], a[48:51], a[200:203]
    ds_read_b64_tr_b16 a[108:109], v28 offset:51232
    v_mfma_f32_16x16x32_bf16 a[200:203], a[116:119], a[52:55], a[200:203]
    v_mfma_f32_16x16x32_bf16 a[204:207], a[112:115], a[56:59], a[204:207]
    ds_read_b64_tr_b16 a[110:111], v28 offset:53024
    buffer_load_dwordx4 v[40:43], v29, s[56:59], s45 offen offset:16
    v_mfma_f32_16x16x32_bf16 a[204:207], a[116:119], a[60:63], a[204:207]
    v_mfma_f32_16x16x32_bf16 a[208:211], a[112:115], a[64:67], a[208:211]
    v_mfma_f32_16x16x32_bf16 a[208:211], a[116:119], a[68:71], a[208:211]
    buffer_load_dwordx4 v[44:47], v29, s[56:59], s45 offen offset:2048
    v_mfma_f32_16x16x32_bf16 a[212:215], a[112:115], a[72:75], a[212:215]
    v_mfma_f32_16x16x32_bf16 a[212:215], a[116:119], a[76:79], a[212:215]
    v_mfma_f32_16x16x32_bf16 a[216:219], a[112:115], a[80:83], a[216:219]
    buffer_load_dwordx4 v[48:51], v29, s[56:59], s45 offen offset:2064
    v_mfma_f32_16x16x32_bf16 a[216:219], a[116:119], a[84:87], a[216:219]
    v_mfma_f32_16x16x32_bf16 a[220:223], a[112:115], a[88:91], a[220:223]
    v_mfma_f32_16x16x32_bf16 a[220:223], a[116:119], a[92:95], a[220:223]
    s_waitcnt lgkmcnt(10)
    v_mfma_f32_16x16x32_bf16 a[252:255], a[120:123], a[88:91], a[252:255]
    ds_read_b64_tr_b16 a[112:113], v27 offset:41024
    s_waitcnt lgkmcnt(9)
    v_mfma_f32_16x16x32_bf16 a[252:255], a[124:127], a[92:95], a[252:255]
    v_mfma_f32_16x16x32_bf16 a[248:251], a[120:123], a[80:83], a[248:251]
    ds_read_b64_tr_b16 a[114:115], v27 offset:42816
    v_mfma_f32_16x16x32_bf16 a[248:251], a[124:127], a[84:87], a[248:251]
    v_mfma_f32_16x16x32_bf16 a[244:247], a[120:123], a[72:75], a[244:247]
    ds_read_b64_tr_b16 a[116:117], v27 offset:51264
    v_mfma_f32_16x16x32_bf16 a[244:247], a[124:127], a[76:79], a[244:247]
    v_mfma_f32_16x16x32_bf16 a[240:243], a[120:123], a[64:67], a[240:243]
    ds_read_b64_tr_b16 a[118:119], v27 offset:53056
    v_mfma_f32_16x16x32_bf16 a[240:243], a[124:127], a[68:71], a[240:243]
    v_mfma_f32_16x16x32_bf16 a[236:239], a[120:123], a[56:59], a[236:239]
    v_mfma_f32_16x16x32_bf16 a[236:239], a[124:127], a[60:63], a[236:239]
    v_mfma_f32_16x16x32_bf16 a[232:235], a[120:123], a[48:51], a[232:235]
    v_mfma_f32_16x16x32_bf16 a[232:235], a[124:127], a[52:55], a[232:235]
    v_mfma_f32_16x16x32_bf16 a[228:231], a[120:123], a[40:43], a[228:231]
    v_mfma_f32_16x16x32_bf16 a[228:231], a[124:127], a[44:47], a[228:231]
    v_mfma_f32_16x16x32_bf16 a[224:227], a[120:123], a[32:35], a[224:227]
    v_mfma_f32_16x16x32_bf16 a[224:227], a[124:127], a[36:39], a[224:227]
    s_waitcnt lgkmcnt(10)
    v_mfma_f32_16x16x32_bf16 v[128:131], a[96:99], a[32:35], v[128:131]
    ds_read_b64_tr_b16 a[120:121], v28 offset:41024
    s_waitcnt lgkmcnt(9)
    v_mfma_f32_16x16x32_bf16 v[128:131], a[100:103], a[36:39], v[128:131]
    v_mfma_f32_16x16x32_bf16 v[132:135], a[96:99], a[40:43], v[132:135]
    ds_read_b64_tr_b16 a[122:123], v28 offset:42816
    v_mfma_f32_16x16x32_bf16 v[132:135], a[100:103], a[44:47], v[132:135]
    v_mfma_f32_16x16x32_bf16 v[136:139], a[96:99], a[48:51], v[136:139]
    ds_read_b64_tr_b16 a[124:125], v28 offset:51264
    v_mfma_f32_16x16x32_bf16 v[136:139], a[100:103], a[52:55], v[136:139]
    v_mfma_f32_16x16x32_bf16 v[140:143], a[96:99], a[56:59], v[140:143]
    ds_read_b64_tr_b16 a[126:127], v28 offset:53056
    v_mfma_f32_16x16x32_bf16 v[140:143], a[100:103], a[60:63], v[140:143]
    v_mfma_f32_16x16x32_bf16 v[144:147], a[96:99], a[64:67], v[144:147]
    v_mfma_f32_16x16x32_bf16 v[144:147], a[100:103], a[68:71], v[144:147]
    v_mfma_f32_16x16x32_bf16 v[148:151], a[96:99], a[72:75], v[148:151]
    v_mfma_f32_16x16x32_bf16 v[148:151], a[100:103], a[76:79], v[148:151]
    v_mfma_f32_16x16x32_bf16 v[152:155], a[96:99], a[80:83], v[152:155]
    v_mfma_f32_16x16x32_bf16 v[152:155], a[100:103], a[84:87], v[152:155]
    v_mfma_f32_16x16x32_bf16 v[156:159], a[96:99], a[88:91], v[156:159]
    v_mfma_f32_16x16x32_bf16 v[156:159], a[100:103], a[92:95], v[156:159]
    s_waitcnt vmcnt(6) lgkmcnt(0)
    s_barrier
    v_mfma_f32_16x16x32_bf16 v[188:191], a[104:107], a[88:91], v[188:191]
    ds_read_b64_tr_b16 a[96:97], v25 offset:1024
    s_add_u32 m0, s91, 106496
    v_mfma_f32_16x16x32_bf16 v[188:191], a[108:111], a[92:95], v[188:191]
    buffer_load_dwordx4 v16, s[64:67], s84 offen offset:0 lds
    v_mfma_f32_16x16x32_bf16 v[184:187], a[104:107], a[80:83], v[184:187]
    ds_read_b64_tr_b16 a[98:99], v25 offset:1280
    v_mfma_f32_16x16x32_bf16 v[184:187], a[108:111], a[84:87], v[184:187]
    v_mfma_f32_16x16x32_bf16 v[180:183], a[104:107], a[72:75], v[180:183]
    ds_read_b64_tr_b16 a[100:101], v25 offset:21504
    v_mfma_f32_16x16x32_bf16 v[180:183], a[108:111], a[76:79], v[180:183]
    v_mfma_f32_16x16x32_bf16 v[176:179], a[104:107], a[64:67], v[176:179]
    ds_read_b64_tr_b16 a[102:103], v25 offset:21760
    v_mfma_f32_16x16x32_bf16 v[176:179], a[108:111], a[68:71], v[176:179]
    buffer_load_dwordx4 v17, s[64:67], s84 offen offset:1024 lds
    v_mfma_f32_16x16x32_bf16 v[172:175], a[104:107], a[56:59], v[172:175]
    ds_read_b128 a[0:3], v23 offset:0
    v_mfma_f32_16x16x32_bf16 v[172:175], a[108:111], a[60:63], v[172:175]
    v_mfma_f32_16x16x32_bf16 v[168:171], a[104:107], a[48:51], v[168:171]
    ds_read_b128 a[4:7], v24 offset:0
    v_mfma_f32_16x16x32_bf16 v[168:171], a[108:111], a[52:55], v[168:171]
    v_mfma_f32_16x16x32_bf16 v[164:167], a[104:107], a[40:43], v[164:167]
    ds_read_b128 a[8:11], v23 offset:2048
    v_mfma_f32_16x16x32_bf16 v[164:167], a[108:111], a[44:47], v[164:167]
    v_mfma_f32_16x16x32_bf16 v[160:163], a[104:107], a[32:35], v[160:163]
    ds_read_b128 a[12:15], v24 offset:2048
    buffer_load_dwordx4 v18, s[64:67], s84 offen offset:2048 lds
    v_mfma_f32_16x16x32_bf16 v[160:163], a[108:111], a[36:39], v[160:163]
    v_mfma_f32_16x16x32_bf16 v[192:195], a[112:115], a[32:35], v[192:195]
    ds_read_b64_tr_b16 a[104:105], v26 offset:1024
    v_mfma_f32_16x16x32_bf16 v[192:195], a[116:119], a[36:39], v[192:195]
    v_mfma_f32_16x16x32_bf16 v[196:199], a[112:115], a[40:43], v[196:199]
    ds_read_b64_tr_b16 a[106:107], v26 offset:1280
    v_mfma_f32_16x16x32_bf16 v[196:199], a[116:119], a[44:47], v[196:199]
    v_mfma_f32_16x16x32_bf16 v[200:203], a[112:115], a[48:51], v[200:203]
    ds_read_b64_tr_b16 a[108:109], v26 offset:21504
    buffer_load_dwordx4 v19, s[64:67], s84 offen offset:3072 lds
    v_mfma_f32_16x16x32_bf16 v[200:203], a[116:119], a[52:55], v[200:203]
    v_mfma_f32_16x16x32_bf16 v[204:207], a[112:115], a[56:59], v[204:207]
    ds_read_b64_tr_b16 a[110:111], v26 offset:21760
    v_mfma_f32_16x16x32_bf16 v[204:207], a[116:119], a[60:63], v[204:207]
    v_mfma_f32_16x16x32_bf16 v[208:211], a[112:115], a[64:67], v[208:211]
    ds_read_b128 a[16:19], v23 offset:4096
    v_mfma_f32_16x16x32_bf16 v[208:211], a[116:119], a[68:71], v[208:211]
    v_mfma_f32_16x16x32_bf16 v[212:215], a[112:115], a[72:75], v[212:215]
    ds_read_b128 a[20:23], v24 offset:4096
    s_add_u32 m0, s91, 110592
    v_mfma_f32_16x16x32_bf16 v[212:215], a[116:119], a[76:79], v[212:215]
    buffer_load_dwordx4 v20, s[64:67], s84 offen offset:0 lds
    v_mfma_f32_16x16x32_bf16 v[216:219], a[112:115], a[80:83], v[216:219]
    ds_read_b128 a[24:27], v23 offset:6144
    v_mfma_f32_16x16x32_bf16 v[216:219], a[116:119], a[84:87], v[216:219]
    v_mfma_f32_16x16x32_bf16 v[220:223], a[112:115], a[88:91], v[220:223]
    ds_read_b128 a[28:31], v24 offset:6144
    v_mfma_f32_16x16x32_bf16 v[220:223], a[116:119], a[92:95], v[220:223]
    v_mfma_f32_16x16x32_bf16 v[252:255], a[120:123], a[88:91], v[252:255]
    ds_read_b64_tr_b16 a[112:113], v25 offset:0
    v_mfma_f32_16x16x32_bf16 v[252:255], a[124:127], a[92:95], v[252:255]
    buffer_load_dwordx4 v21, s[64:67], s84 offen offset:1024 lds
    v_mfma_f32_16x16x32_bf16 v[248:251], a[120:123], a[80:83], v[248:251]
    ds_read_b128 a[88:91], v23 offset:14336
    v_mfma_f32_16x16x32_bf16 v[248:251], a[124:127], a[84:87], v[248:251]
    ds_read_b128 a[92:95], v24 offset:14336
    v_mfma_f32_16x16x32_bf16 v[244:247], a[120:123], a[72:75], v[244:247]
    ds_read_b128 a[80:83], v23 offset:12288
    v_mfma_f32_16x16x32_bf16 v[244:247], a[124:127], a[76:79], v[244:247]
    ds_read_b128 a[84:87], v24 offset:12288
    v_mfma_f32_16x16x32_bf16 v[240:243], a[120:123], a[64:67], v[240:243]
    v_mfma_f32_16x16x32_bf16 v[240:243], a[124:127], a[68:71], v[240:243]
    ds_read_b128 a[72:75], v23 offset:10240
    v_mfma_f32_16x16x32_bf16 v[236:239], a[120:123], a[56:59], v[236:239]
    ds_read_b128 a[76:79], v24 offset:10240
    buffer_load_dwordx4 v22, s[64:67], s84 offen offset:2048 lds
    v_mfma_f32_16x16x32_bf16 v[236:239], a[124:127], a[60:63], v[236:239]
    ds_read_b128 a[64:67], v23 offset:8192
    v_mfma_f32_16x16x32_bf16 v[232:235], a[120:123], a[48:51], v[232:235]
    ds_read_b128 a[68:71], v24 offset:8192
    v_mfma_f32_16x16x32_bf16 v[232:235], a[124:127], a[52:55], v[232:235]
    ds_read_b64_tr_b16 a[114:115], v25 offset:256
    v_mfma_f32_16x16x32_bf16 v[228:231], a[120:123], a[40:43], v[228:231]
    v_mfma_f32_16x16x32_bf16 v[228:231], a[124:127], a[44:47], v[228:231]
    ds_read_b64_tr_b16 a[116:117], v25 offset:20480
    v_mfma_f32_16x16x32_bf16 v[224:227], a[120:123], a[32:35], v[224:227]
    buffer_load_dwordx4 v14, s[60:63], s83 offen offset:3072 lds
    v_mfma_f32_16x16x32_bf16 v[224:227], a[124:127], a[36:39], v[224:227]
    ds_read_b64_tr_b16 a[118:119], v25 offset:20736
    s_waitcnt lgkmcnt(15)
    v_mfma_f32_16x16x32_bf16 v[64:67], a[96:99], a[0:3], v[64:67]
    ds_read_b64_tr_b16 a[120:121], v26 offset:0
    v_mfma_f32_16x16x32_bf16 v[64:67], a[100:103], a[4:7], v[64:67]
    s_waitcnt vmcnt(11)
    v_lshlrev_b32 v60, 16, v36
    v_lshlrev_b32 v61, 16, v52
    v_mfma_f32_16x16x32_bf16 v[68:71], a[96:99], a[8:11], v[68:71]
    ds_read_b64_tr_b16 a[122:123], v26 offset:256
    v_and_b32 v62, s92, v36
    v_mfma_f32_16x16x32_bf16 v[68:71], a[100:103], a[12:15], v[68:71]
    v_and_b32 v63, s92, v52
    v_mul_f32 v60, v60, v61
    v_mfma_f32_16x16x32_bf16 v[72:75], a[96:99], a[16:19], v[72:75]
    ds_read_b64_tr_b16 a[124:125], v26 offset:20480
    v_mul_f32 v62, v62, v63
    s_waitcnt lgkmcnt(15)
    v_mfma_f32_16x16x32_bf16 v[72:75], a[100:103], a[20:23], v[72:75]
    s_add_u32 m0, s91, 114688
    v_cvt_pk_bf16_f32 v60, v60, v62
    v_mfma_f32_16x16x32_bf16 v[76:79], a[96:99], a[24:27], v[76:79]
    ds_read_b64_tr_b16 a[126:127], v26 offset:20736
    buffer_load_dwordx4 v15, s[60:63], s83 offen offset:0 lds
    v_mfma_f32_16x16x32_bf16 v[76:79], a[100:103], a[28:31], v[76:79]
    v_lshlrev_b32 v61, 16, v60
    v_and_b32 v62, s92, v60
    s_waitcnt lgkmcnt(8)
    v_mfma_f32_16x16x32_bf16 v[80:83], a[96:99], a[64:67], v[80:83]
    v_add_f32 v29, v61, v62
    v_lshlrev_b32 v60, 16, v37
    s_waitcnt lgkmcnt(7)
    v_mfma_f32_16x16x32_bf16 v[80:83], a[100:103], a[68:71], v[80:83]
    v_lshlrev_b32 v61, 16, v53
    v_and_b32 v62, s92, v37
    v_mfma_f32_16x16x32_bf16 v[84:87], a[96:99], a[72:75], v[84:87]
    v_and_b32 v63, s92, v53
    v_mul_f32 v60, v60, v61
    v_mfma_f32_16x16x32_bf16 v[84:87], a[100:103], a[76:79], v[84:87]
    v_mul_f32 v62, v62, v63
    v_cvt_pk_bf16_f32 v60, v60, v62
    v_mfma_f32_16x16x32_bf16 v[88:91], a[96:99], a[80:83], v[88:91]
    v_lshlrev_b32 v61, 16, v60
    v_and_b32 v62, s92, v60
    v_mfma_f32_16x16x32_bf16 v[88:91], a[100:103], a[84:87], v[88:91]
    v_add_f32 v61, v61, v62
    v_add_f32 v29, v29, v61
    v_mfma_f32_16x16x32_bf16 v[92:95], a[96:99], a[88:91], v[92:95]
    buffer_load_dwordx4 v14, s[60:63], s83 offen offset:1024 lds
    v_lshlrev_b32 v60, 16, v38
    v_mfma_f32_16x16x32_bf16 v[92:95], a[100:103], a[92:95], v[92:95]
    v_lshlrev_b32 v61, 16, v54
    v_and_b32 v62, s92, v38
    v_mfma_f32_16x16x32_bf16 v[124:127], a[104:107], a[88:91], v[124:127]
    ds_read_b64_tr_b16 a[96:97], v27 offset:0
    v_and_b32 v63, s92, v54
    v_mfma_f32_16x16x32_bf16 v[124:127], a[108:111], a[92:95], v[124:127]
    v_mul_f32 v60, v60, v61
    v_mul_f32 v62, v62, v63
    v_mfma_f32_16x16x32_bf16 v[120:123], a[104:107], a[80:83], v[120:123]
    ds_read_b64_tr_b16 a[98:99], v27 offset:1792
    v_cvt_pk_bf16_f32 v60, v60, v62
    v_mfma_f32_16x16x32_bf16 v[120:123], a[108:111], a[84:87], v[120:123]
    v_lshlrev_b32 v61, 16, v60
    v_and_b32 v62, s92, v60
    v_mfma_f32_16x16x32_bf16 v[116:119], a[104:107], a[72:75], v[116:119]
    ds_read_b64_tr_b16 a[100:101], v27 offset:10240
    v_add_f32 v61, v61, v62
    v_mfma_f32_16x16x32_bf16 v[116:119], a[108:111], a[76:79], v[116:119]
    s_add_u32 m0, s90, 32768
    v_add_f32 v29, v29, v61
    v_mfma_f32_16x16x32_bf16 v[112:115], a[104:107], a[64:67], v[112:115]
    ds_read_b64_tr_b16 a[102:103], v27 offset:12032
    buffer_load_dwordx4 v6, s[56:59], s82 offen offset:0 lds
    v_mfma_f32_16x16x32_bf16 v[112:115], a[108:111], a[68:71], v[112:115]
    v_lshlrev_b32 v60, 16, v39
    v_lshlrev_b32 v61, 16, v55
    v_mfma_f32_16x16x32_bf16 v[108:111], a[104:107], a[24:27], v[108:111]
    v_and_b32 v62, s92, v39
    v_and_b32 v63, s92, v55
    v_mfma_f32_16x16x32_bf16 v[108:111], a[108:111], a[28:31], v[108:111]
    v_mul_f32 v60, v60, v61
    v_mul_f32 v62, v62, v63
    v_mfma_f32_16x16x32_bf16 v[104:107], a[104:107], a[16:19], v[104:107]
    buffer_load_dwordx4 v7, s[56:59], s82 offen offset:1024 lds
    v_cvt_pk_bf16_f32 v60, v60, v62
    v_mfma_f32_16x16x32_bf16 v[104:107], a[108:111], a[20:23], v[104:107]
    v_lshlrev_b32 v61, 16, v60
    v_and_b32 v62, s92, v60
    v_mfma_f32_16x16x32_bf16 v[100:103], a[104:107], a[8:11], v[100:103]
    v_add_f32 v61, v61, v62
    v_add_f32 v29, v29, v61
    v_mfma_f32_16x16x32_bf16 v[100:103], a[108:111], a[12:15], v[100:103]
    s_waitcnt vmcnt(14)
    v_lshlrev_b32 v60, 16, v40
    v_lshlrev_b32 v61, 16, v56
    v_mfma_f32_16x16x32_bf16 v[96:99], a[104:107], a[0:3], v[96:99]
    buffer_load_dwordx4 v8, s[56:59], s82 offen offset:2048 lds
    v_and_b32 v62, s92, v40
    v_mfma_f32_16x16x32_bf16 v[96:99], a[108:111], a[4:7], v[96:99]
    v_and_b32 v63, s92, v56
    v_mul_f32 v60, v60, v61
    s_waitcnt lgkmcnt(10)
    v_mfma_f32_16x16x32_bf16 a[128:131], a[112:115], a[0:3], a[128:131]
    ds_read_b64_tr_b16 a[104:105], v28 offset:0
    v_mul_f32 v62, v62, v63
    s_waitcnt lgkmcnt(9)
    v_mfma_f32_16x16x32_bf16 a[128:131], a[116:119], a[4:7], a[128:131]
    v_cvt_pk_bf16_f32 v60, v60, v62
    v_lshlrev_b32 v61, 16, v60
    v_mfma_f32_16x16x32_bf16 a[132:135], a[112:115], a[8:11], a[132:135]
    ds_read_b64_tr_b16 a[106:107], v28 offset:1792
    buffer_load_dwordx4 v9, s[56:59], s82 offen offset:3072 lds
    v_mfma_f32_16x16x32_bf16 a[132:135], a[116:119], a[12:15], a[132:135]
    v_and_b32 v62, s92, v60
    v_add_f32 v61, v61, v62
    v_mfma_f32_16x16x32_bf16 a[136:139], a[112:115], a[16:19], a[136:139]
    ds_read_b64_tr_b16 a[108:109], v28 offset:10240
    v_add_f32 v29, v29, v61
    v_mfma_f32_16x16x32_bf16 a[136:139], a[116:119], a[20:23], a[136:139]
    s_add_u32 m0, s90, 36864
    v_lshlrev_b32 v60, 16, v41
    v_mfma_f32_16x16x32_bf16 a[140:143], a[112:115], a[24:27], a[140:143]
    ds_read_b64_tr_b16 a[110:111], v28 offset:12032
    buffer_load_dwordx4 v10, s[56:59], s82 offen offset:0 lds
    v_mfma_f32_16x16x32_bf16 a[140:143], a[116:119], a[28:31], a[140:143]
    v_lshlrev_b32 v61, 16, v57
    v_and_b32 v62, s92, v41
    v_mfma_f32_16x16x32_bf16 a[144:147], a[112:115], a[64:67], a[144:147]
    v_and_b32 v63, s92, v57
    v_mul_f32 v60, v60, v61
    v_mfma_f32_16x16x32_bf16 a[144:147], a[116:119], a[68:71], a[144:147]
    v_mul_f32 v62, v62, v63
    v_cvt_pk_bf16_f32 v60, v60, v62
    v_mfma_f32_16x16x32_bf16 a[148:151], a[112:115], a[72:75], a[148:151]
    buffer_load_dwordx4 v11, s[56:59], s82 offen offset:1024 lds
    v_lshlrev_b32 v61, 16, v60
    v_mfma_f32_16x16x32_bf16 a[148:151], a[116:119], a[76:79], a[148:151]
    v_and_b32 v62, s92, v60
    v_add_f32 v61, v61, v62
    v_mfma_f32_16x16x32_bf16 a[152:155], a[112:115], a[80:83], a[152:155]
    v_add_f32 v29, v29, v61
    v_lshlrev_b32 v60, 16, v42
    v_mfma_f32_16x16x32_bf16 a[152:155], a[116:119], a[84:87], a[152:155]
    v_lshlrev_b32 v61, 16, v58
    v_and_b32 v62, s92, v42
    v_mfma_f32_16x16x32_bf16 a[156:159], a[112:115], a[88:91], a[156:159]
    buffer_load_dwordx4 v12, s[56:59], s82 offen offset:2048 lds
    v_and_b32 v63, s92, v58
    v_mfma_f32_16x16x32_bf16 a[156:159], a[116:119], a[92:95], a[156:159]
    v_mul_f32 v60, v60, v61
    v_mul_f32 v62, v62, v63
    s_waitcnt lgkmcnt(10)
    v_mfma_f32_16x16x32_bf16 a[188:191], a[120:123], a[88:91], a[188:191]
    ds_read_b64_tr_b16 a[112:113], v27 offset:32
    v_cvt_pk_bf16_f32 v60, v60, v62
    s_waitcnt lgkmcnt(9)
    v_mfma_f32_16x16x32_bf16 a[188:191], a[124:127], a[92:95], a[188:191]
    v_lshlrev_b32 v61, 16, v60
    v_and_b32 v62, s92, v60
    v_mfma_f32_16x16x32_bf16 a[184:187], a[120:123], a[80:83], a[184:187]
    ds_read_b64_tr_b16 a[114:115], v27 offset:1824
    buffer_load_dwordx4 v13, s[56:59], s82 offen offset:3072 lds
    v_mfma_f32_16x16x32_bf16 a[184:187], a[124:127], a[84:87], a[184:187]
    v_add_f32 v61, v61, v62
    v_add_f32 v29, v29, v61
    v_mfma_f32_16x16x32_bf16 a[180:183], a[120:123], a[72:75], a[180:183]
    ds_read_b64_tr_b16 a[116:117], v27 offset:10272
    s_add_u32 s83, s83, 393216
    v_mfma_f32_16x16x32_bf16 a[180:183], a[124:127], a[76:79], a[180:183]
    s_add_u32 s84, s84, 458752
    v_lshlrev_b32 v60, 16, v43
    v_mfma_f32_16x16x32_bf16 a[176:179], a[120:123], a[64:67], a[176:179]
    ds_read_b64_tr_b16 a[118:119], v27 offset:12064
    s_add_u32 s82, s82, 128
    v_mfma_f32_16x16x32_bf16 a[176:179], a[124:127], a[68:71], a[176:179]
    buffer_load_dword v2, v32, s[72:75], s81 offen
    v_lshlrev_b32 v61, 16, v59
    v_mfma_f32_16x16x32_bf16 a[172:175], a[120:123], a[24:27], a[172:175]
    s_add_u32 s81, s81, 786432
    v_and_b32 v62, s92, v43
    v_mfma_f32_16x16x32_bf16 a[172:175], a[124:127], a[28:31], a[172:175]
    v_and_b32 v63, s92, v59
    v_mul_f32 v60, v60, v61
    v_mfma_f32_16x16x32_bf16 a[168:171], a[120:123], a[16:19], a[168:171]
    v_mul_f32 v62, v62, v63
    v_cvt_pk_bf16_f32 v60, v60, v62
    v_mfma_f32_16x16x32_bf16 a[168:171], a[124:127], a[20:23], a[168:171]
    v_lshlrev_b32 v61, 16, v60
    v_and_b32 v62, s92, v60
    v_mfma_f32_16x16x32_bf16 a[164:167], a[120:123], a[8:11], a[164:167]
    v_add_f32 v61, v61, v62
    v_add_f32 v29, v29, v61
    v_mfma_f32_16x16x32_bf16 a[164:167], a[124:127], a[12:15], a[164:167]
    s_waitcnt vmcnt(20)
    v_lshlrev_b32 v60, 16, v44
    v_lshlrev_b32 v61, 16, v52
    v_mfma_f32_16x16x32_bf16 a[160:163], a[120:123], a[0:3], a[160:163]
    v_and_b32 v62, s92, v44
    v_and_b32 v63, s92, v52
    v_mfma_f32_16x16x32_bf16 a[160:163], a[124:127], a[4:7], a[160:163]
    v_mul_f32 v60, v60, v61
    v_mul_f32 v62, v62, v63
    s_waitcnt lgkmcnt(10)
    v_mfma_f32_16x16x32_bf16 a[192:195], a[96:99], a[0:3], a[192:195]
    ds_read_b64_tr_b16 a[120:121], v28 offset:32
    v_cvt_pk_bf16_f32 v60, v60, v62
    s_waitcnt lgkmcnt(9)
    v_mfma_f32_16x16x32_bf16 a[192:195], a[100:103], a[4:7], a[192:195]
    v_lshlrev_b32 v61, 16, v60
    v_and_b32 v62, s92, v60
    v_mfma_f32_16x16x32_bf16 a[196:199], a[96:99], a[8:11], a[196:199]
    ds_read_b64_tr_b16 a[122:123], v28 offset:1824
    v_add_f32 v30, v61, v62
    v_mfma_f32_16x16x32_bf16 a[196:199], a[100:103], a[12:15], a[196:199]
    v_lshlrev_b32 v60, 16, v45
    v_lshlrev_b32 v61, 16, v53
    v_mfma_f32_16x16x32_bf16 a[200:203], a[96:99], a[16:19], a[200:203]
    ds_read_b64_tr_b16 a[124:125], v28 offset:10272
    v_and_b32 v62, s92, v45
    v_mfma_f32_16x16x32_bf16 a[200:203], a[100:103], a[20:23], a[200:203]
    v_and_b32 v63, s92, v53
    v_mul_f32 v60, v60, v61
    v_mfma_f32_16x16x32_bf16 a[204:207], a[96:99], a[24:27], a[204:207]
    ds_read_b64_tr_b16 a[126:127], v28 offset:12064
    v_mul_f32 v62, v62, v63
    v_mfma_f32_16x16x32_bf16 a[204:207], a[100:103], a[28:31], a[204:207]
    v_cvt_pk_bf16_f32 v60, v60, v62
    v_lshlrev_b32 v61, 16, v60
    v_mfma_f32_16x16x32_bf16 a[208:211], a[96:99], a[64:67], a[208:211]
    v_and_b32 v62, s92, v60
    v_add_f32 v61, v61, v62
    v_mfma_f32_16x16x32_bf16 a[208:211], a[100:103], a[68:71], a[208:211]
    v_add_f32 v30, v30, v61
    v_lshlrev_b32 v60, 16, v46
    v_mfma_f32_16x16x32_bf16 a[212:215], a[96:99], a[72:75], a[212:215]
    v_lshlrev_b32 v61, 16, v54
    v_and_b32 v62, s92, v46
    v_mfma_f32_16x16x32_bf16 a[212:215], a[100:103], a[76:79], a[212:215]
    v_and_b32 v63, s92, v54
    v_mul_f32 v60, v60, v61
    v_mfma_f32_16x16x32_bf16 a[216:219], a[96:99], a[80:83], a[216:219]
    v_mul_f32 v62, v62, v63
    v_cvt_pk_bf16_f32 v60, v60, v62
    v_mfma_f32_16x16x32_bf16 a[216:219], a[100:103], a[84:87], a[216:219]
    v_lshlrev_b32 v61, 16, v60
    v_and_b32 v62, s92, v60
    v_mfma_f32_16x16x32_bf16 a[220:223], a[96:99], a[88:91], a[220:223]
    v_add_f32 v61, v61, v62
    v_add_f32 v30, v30, v61
    v_mfma_f32_16x16x32_bf16 a[220:223], a[100:103], a[92:95], a[220:223]
    v_lshlrev_b32 v60, 16, v47
    v_lshlrev_b32 v61, 16, v55
    s_waitcnt lgkmcnt(10)
    v_mfma_f32_16x16x32_bf16 a[252:255], a[104:107], a[88:91], a[252:255]
    ds_read_b64_tr_b16 a[96:97], v27 offset:64
    v_and_b32 v62, s92, v47
    s_waitcnt lgkmcnt(9)
    v_mfma_f32_16x16x32_bf16 a[252:255], a[108:111], a[92:95], a[252:255]
    v_and_b32 v63, s92, v55
    v_mul_f32 v60, v60, v61
    v_mfma_f32_16x16x32_bf16 a[248:251], a[104:107], a[80:83], a[248:251]
    ds_read_b64_tr_b16 a[98:99], v27 offset:1856
    v_mul_f32 v62, v62, v63
    v_mfma_f32_16x16x32_bf16 a[248:251], a[108:111], a[84:87], a[248:251]
    v_cvt_pk_bf16_f32 v60, v60, v62
    v_lshlrev_b32 v61, 16, v60
    v_mfma_f32_16x16x32_bf16 a[244:247], a[104:107], a[72:75], a[244:247]
    ds_read_b64_tr_b16 a[100:101], v27 offset:10304
    v_and_b32 v62, s92, v60
    v_mfma_f32_16x16x32_bf16 a[244:247], a[108:111], a[76:79], a[244:247]
    v_add_f32 v61, v61, v62
    v_add_f32 v30, v30, v61
    v_mfma_f32_16x16x32_bf16 a[240:243], a[104:107], a[64:67], a[240:243]
    ds_read_b64_tr_b16 a[102:103], v27 offset:12096
    s_waitcnt vmcnt(19)
    v_lshlrev_b32 v60, 16, v48
    v_mfma_f32_16x16x32_bf16 a[240:243], a[108:111], a[68:71], a[240:243]
    v_lshlrev_b32 v61, 16, v56
    v_and_b32 v62, s92, v48
    v_mfma_f32_16x16x32_bf16 a[236:239], a[104:107], a[24:27], a[236:239]
    v_and_b32 v63, s92, v56
    v_mul_f32 v60, v60, v61
    v_mfma_f32_16x16x32_bf16 a[236:239], a[108:111], a[28:31], a[236:239]
    v_mul_f32 v62, v62, v63
    v_cvt_pk_bf16_f32 v60, v60, v62
    v_mfma_f32_16x16x32_bf16 a[232:235], a[104:107], a[16:19], a[232:235]
    v_lshlrev_b32 v61, 16, v60
    v_and_b32 v62, s92, v60
    v_mfma_f32_16x16x32_bf16 a[232:235], a[108:111], a[20:23], a[232:235]
    v_add_f32 v61, v61, v62
    v_add_f32 v30, v30, v61
    v_mfma_f32_16x16x32_bf16 a[228:231], a[104:107], a[8:11], a[228:231]
    v_lshlrev_b32 v60, 16, v49
    v_lshlrev_b32 v61, 16, v57
    v_mfma_f32_16x16x32_bf16 a[228:231], a[108:111], a[12:15], a[228:231]
    v_and_b32 v62, s92, v49
    v_and_b32 v63, s92, v57
    v_mfma_f32_16x16x32_bf16 a[224:227], a[104:107], a[0:3], a[224:227]
    v_mul_f32 v60, v60, v61
    v_mul_f32 v62, v62, v63
    v_mfma_f32_16x16x32_bf16 a[224:227], a[108:111], a[4:7], a[224:227]
    v_cvt_pk_bf16_f32 v60, v60, v62
    v_lshlrev_b32 v61, 16, v60
    s_waitcnt lgkmcnt(10)
    v_mfma_f32_16x16x32_bf16 v[128:131], a[112:115], a[0:3], v[128:131]
    ds_read_b64_tr_b16 a[104:105], v28 offset:64
    v_and_b32 v62, s92, v60
    s_waitcnt lgkmcnt(9)
    v_mfma_f32_16x16x32_bf16 v[128:131], a[116:119], a[4:7], v[128:131]
    v_add_f32 v61, v61, v62
    v_add_f32 v30, v30, v61
    v_mfma_f32_16x16x32_bf16 v[132:135], a[112:115], a[8:11], v[132:135]
    ds_read_b64_tr_b16 a[106:107], v28 offset:1856
    v_lshlrev_b32 v60, 16, v50
    v_mfma_f32_16x16x32_bf16 v[132:135], a[116:119], a[12:15], v[132:135]
    v_lshlrev_b32 v61, 16, v58
    v_and_b32 v62, s92, v50
    v_mfma_f32_16x16x32_bf16 v[136:139], a[112:115], a[16:19], v[136:139]
    ds_read_b64_tr_b16 a[108:109], v28 offset:10304
    v_and_b32 v63, s92, v58
    v_mfma_f32_16x16x32_bf16 v[136:139], a[116:119], a[20:23], v[136:139]
    v_mul_f32 v60, v60, v61
    v_mul_f32 v62, v62, v63
    v_mfma_f32_16x16x32_bf16 v[140:143], a[112:115], a[24:27], v[140:143]
    ds_read_b64_tr_b16 a[110:111], v28 offset:12096
    v_cvt_pk_bf16_f32 v60, v60, v62
    v_mfma_f32_16x16x32_bf16 v[140:143], a[116:119], a[28:31], v[140:143]
    v_lshlrev_b32 v61, 16, v60
    v_and_b32 v62, s92, v60
    v_mfma_f32_16x16x32_bf16 v[144:147], a[112:115], a[64:67], v[144:147]
    v_add_f32 v61, v61, v62
    v_add_f32 v30, v30, v61
    v_mfma_f32_16x16x32_bf16 v[144:147], a[116:119], a[68:71], v[144:147]
    v_lshlrev_b32 v60, 16, v51
    v_lshlrev_b32 v61, 16, v59
    v_mfma_f32_16x16x32_bf16 v[148:151], a[112:115], a[72:75], v[148:151]
    v_and_b32 v62, s92, v51
    v_and_b32 v63, s92, v59
    v_mfma_f32_16x16x32_bf16 v[148:151], a[116:119], a[76:79], v[148:151]
    v_mul_f32 v60, v60, v61
    v_mul_f32 v62, v62, v63
    v_mfma_f32_16x16x32_bf16 v[152:155], a[112:115], a[80:83], v[152:155]
    v_cvt_pk_bf16_f32 v60, v60, v62
    v_lshlrev_b32 v61, 16, v60
    v_mfma_f32_16x16x32_bf16 v[152:155], a[116:119], a[84:87], v[152:155]
    v_and_b32 v62, s92, v60
    v_add_f32 v61, v61, v62
    v_mfma_f32_16x16x32_bf16 v[156:159], a[112:115], a[88:91], v[156:159]
    v_add_f32 v30, v30, v61
    v_add_f32_dpp v29, v29, v29 quad_perm:[1,0,3,2] row_mask:0xf bank_mask:0xf
    v_mfma_f32_16x16x32_bf16 v[156:159], a[116:119], a[92:95], v[156:159]
    v_add_f32_dpp v30, v30, v30 quad_perm:[1,0,3,2] row_mask:0xf bank_mask:0xf
    v_add_f32_dpp v29, v29, v29 quad_perm:[2,3,0,1] row_mask:0xf bank_mask:0xf
    s_waitcnt vmcnt(1) lgkmcnt(0)
    s_barrier
    v_mfma_f32_16x16x32_bf16 v[188:191], a[120:123], a[88:91], v[188:191]
    ds_read_b64_tr_b16 a[112:113], v25 offset:41984
    v_add_f32_dpp v30, v30, v30 quad_perm:[2,3,0,1] row_mask:0xf bank_mask:0xf
    v_mfma_f32_16x16x32_bf16 v[188:191], a[124:127], a[92:95], v[188:191]
    v_add_f32_dpp v29, v29, v29 row_half_mirror row_mask:0xf bank_mask:0xf
    v_add_f32_dpp v30, v30, v30 row_half_mirror row_mask:0xf bank_mask:0xf
    v_mfma_f32_16x16x32_bf16 v[184:187], a[120:123], a[80:83], v[184:187]
    ds_read_b64_tr_b16 a[114:115], v25 offset:42240
    v_add_f32_dpp v29, v29, v29 row_mirror row_mask:0xf bank_mask:0xf
    v_mfma_f32_16x16x32_bf16 v[184:187], a[124:127], a[84:87], v[184:187]
    v_add_f32_dpp v30, v30, v30 row_mirror row_mask:0xf bank_mask:0xf
    v_mov_b32 v60, v29
    v_mfma_f32_16x16x32_bf16 v[180:183], a[120:123], a[72:75], v[180:183]
    ds_read_b64_tr_b16 a[116:117], v25 offset:62464
    v_mov_b32 v61, v30
    v_mfma_f32_16x16x32_bf16 v[180:183], a[124:127], a[76:79], v[180:183]
    v_permlane16_swap_b32 v60, v29
    v_permlane16_swap_b32 v61, v30
    v_mfma_f32_16x16x32_bf16 v[176:179], a[120:123], a[64:67], v[176:179]
    ds_read_b64_tr_b16 a[118:119], v25 offset:62720
    v_add_f32 v29, v29, v60
    v_mfma_f32_16x16x32_bf16 v[176:179], a[124:127], a[68:71], v[176:179]
    v_add_f32 v30, v30, v61
    v_mov_b32 v60, v29
    v_mfma_f32_16x16x32_bf16 v[172:175], a[120:123], a[24:27], v[172:175]
    ds_read_b128 a[32:35], v23 offset:32768
    v_mov_b32 v61, v30
    v_mfma_f32_16x16x32_bf16 v[172:175], a[124:127], a[28:31], v[172:175]
    v_permlane32_swap_b32 v60, v29
    v_permlane32_swap_b32 v61, v30
    v_mfma_f32_16x16x32_bf16 v[168:171], a[120:123], a[16:19], v[168:171]
    ds_read_b128 a[36:39], v24 offset:32768
    v_add_f32 v29, v29, v60
    v_mfma_f32_16x16x32_bf16 v[168:171], a[124:127], a[20:23], v[168:171]
    v_add_f32 v30, v30, v61
    v_and_b32 v61, 1, v1
    v_mfma_f32_16x16x32_bf16 v[164:167], a[120:123], a[8:11], v[164:167]
    ds_read_b128 a[40:43], v23 offset:34816
    v_cmp_eq_u32 vcc, 1, v61
    v_mfma_f32_16x16x32_bf16 v[164:167], a[124:127], a[12:15], v[164:167]
    v_and_b32 v63, 2, v1
    v_cndmask_b32 v60, v29, v30, vcc
    v_mfma_f32_16x16x32_bf16 v[160:163], a[120:123], a[0:3], v[160:163]
    ds_read_b128 a[44:47], v24 offset:34816
    v_cvt_pk_bf16_f32 v60, v60, v60
    v_mfma_f32_16x16x32_bf16 v[160:163], a[124:127], a[4:7], v[160:163]
    v_and_b32 v60, s92, v60
    v_mul_f32 v60, 0xbfb8aa3b, v60
    v_mfma_f32_16x16x32_bf16 v[192:195], a[96:99], a[0:3], v[192:195]
    ds_read_b64_tr_b16 a[120:121], v26 offset:41984
    v_exp_f32 v60, v60
    v_mfma_f32_16x16x32_bf16 v[192:195], a[100:103], a[4:7], v[192:195]
    v_cmp_eq_u32 vcc, 2, v63
    v_add_f32 v60, 1.0, v60
    v_mfma_f32_16x16x32_bf16 v[196:199], a[96:99], a[8:11], v[196:199]
    ds_read_b64_tr_b16 a[122:123], v26 offset:42240
    v_rcp_f32 v60, v60
    v_mfma_f32_16x16x32_bf16 v[196:199], a[100:103], a[12:15], v[196:199]
    v_lshlrev_b32 v63, 4, v63
    v_cvt_pk_bf16_f32 v60, v60, v60
    v_mfma_f32_16x16x32_bf16 v[200:203], a[96:99], a[16:19], v[200:203]
    ds_read_b64_tr_b16 a[124:125], v26 offset:62464
    v_and_b32 v60, s92, v60
    v_mfma_f32_16x16x32_bf16 v[200:203], a[100:103], a[20:23], v[200:203]
    v_sub_f32 v62, 1.0, v60
    v_cvt_pk_bf16_f32 v62, v62, v62
    v_mfma_f32_16x16x32_bf16 v[204:207], a[96:99], a[24:27], v[204:207]
    ds_read_b64_tr_b16 a[126:127], v26 offset:62720
    v_and_b32 v62, s92, v62
    v_mfma_f32_16x16x32_bf16 v[204:207], a[100:103], a[28:31], v[204:207]
    v_cndmask_b32 v60, v60, v62, vcc
    v_lshl_add_u32 v63, v61, 2, v63
    v_mfma_f32_16x16x32_bf16 v[208:211], a[96:99], a[64:67], v[208:211]
    ds_read_b128 a[48:51], v23 offset:36864
    v_cmp_gt_u32 vcc, 4, v1
    v_mfma_f32_16x16x32_bf16 v[208:211], a[100:103], a[68:71], v[208:211]
    s_nop 0
    v_cndmask_b32 v63, 2.0, v63, vcc
    buffer_store_dword v60, v63, s[28:31], s87 offen sc1
    v_mfma_f32_16x16x32_bf16 v[212:215], a[96:99], a[72:75], v[212:215]
    ds_read_b128 a[52:55], v24 offset:36864
    v_mfma_f32_16x16x32_bf16 v[212:215], a[100:103], a[76:79], v[212:215]
    v_mfma_f32_16x16x32_bf16 v[216:219], a[96:99], a[80:83], v[216:219]
    ds_read_b128 a[56:59], v23 offset:38912
    v_mfma_f32_16x16x32_bf16 v[216:219], a[100:103], a[84:87], v[216:219]
    v_mfma_f32_16x16x32_bf16 v[220:223], a[96:99], a[88:91], v[220:223]
    ds_read_b128 a[60:63], v24 offset:38912
    v_mfma_f32_16x16x32_bf16 v[220:223], a[100:103], a[92:95], v[220:223]
    v_mfma_f32_16x16x32_bf16 v[252:255], a[104:107], a[88:91], v[252:255]
    ds_read_b64_tr_b16 a[96:97], v25 offset:40960
    v_mfma_f32_16x16x32_bf16 v[252:255], a[108:111], a[92:95], v[252:255]
    v_mfma_f32_16x16x32_bf16 v[248:251], a[104:107], a[80:83], v[248:251]
    ds_read_b128 a[88:91], v23 offset:47104
    v_mfma_f32_16x16x32_bf16 v[248:251], a[108:111], a[84:87], v[248:251]
    ds_read_b128 a[92:95], v24 offset:47104
    v_mfma_f32_16x16x32_bf16 v[244:247], a[104:107], a[72:75], v[244:247]
    ds_read_b128 a[80:83], v23 offset:45056
    v_mfma_f32_16x16x32_bf16 v[244:247], a[108:111], a[76:79], v[244:247]
    ds_read_b128 a[84:87], v24 offset:45056
    v_mfma_f32_16x16x32_bf16 v[240:243], a[104:107], a[64:67], v[240:243]
    v_mfma_f32_16x16x32_bf16 v[240:243], a[108:111], a[68:71], v[240:243]
    ds_read_b128 a[72:75], v23 offset:43008
    v_mfma_f32_16x16x32_bf16 v[236:239], a[104:107], a[24:27], v[236:239]
    ds_read_b128 a[76:79], v24 offset:43008
    v_mfma_f32_16x16x32_bf16 v[236:239], a[108:111], a[28:31], v[236:239]
    ds_read_b128 a[64:67], v23 offset:40960
    v_mfma_f32_16x16x32_bf16 v[232:235], a[104:107], a[16:19], v[232:235]
    ds_read_b128 a[68:71], v24 offset:40960
    v_mfma_f32_16x16x32_bf16 v[232:235], a[108:111], a[20:23], v[232:235]
    ds_read_b64_tr_b16 a[98:99], v25 offset:41216
    v_mfma_f32_16x16x32_bf16 v[228:231], a[104:107], a[8:11], v[228:231]
    v_mfma_f32_16x16x32_bf16 v[228:231], a[108:111], a[12:15], v[228:231]
    ds_read_b64_tr_b16 a[100:101], v25 offset:61440
    v_mfma_f32_16x16x32_bf16 v[224:227], a[104:107], a[0:3], v[224:227]
    v_mfma_f32_16x16x32_bf16 v[224:227], a[108:111], a[4:7], v[224:227]
    ds_read_b64_tr_b16 a[102:103], v25 offset:61696
    s_waitcnt lgkmcnt(15)
    v_mfma_f32_16x16x32_bf16 v[64:67], a[112:115], a[32:35], v[64:67]
    ds_read_b64_tr_b16 a[104:105], v26 offset:40960
    v_mfma_f32_16x16x32_bf16 v[64:67], a[116:119], a[36:39], v[64:67]
    v_and_b32 v33, 7, v1
    v_lshlrev_b32 v33, 2, v33
    v_mfma_f32_16x16x32_bf16 v[68:71], a[112:115], a[40:43], v[68:71]
    ds_read_b64_tr_b16 a[106:107], v26 offset:41216
    buffer_load_dword v34, v33, s[36:39], 0 offen offset:64 sc1
    v_mfma_f32_16x16x32_bf16 v[68:71], a[116:119], a[44:47], v[68:71]
    v_and_b32 v29, 15, v1
    v_lshrrev_b32 v30, 4, v1
    v_mfma_f32_16x16x32_bf16 v[72:75], a[112:115], a[48:51], v[72:75]
    ds_read_b64_tr_b16 a[108:109], v26 offset:61440
    v_lshlrev_b32 v6, 9, v30
    s_waitcnt lgkmcnt(15)
    v_mfma_f32_16x16x32_bf16 v[72:75], a[116:119], a[52:55], v[72:75]
    v_lshlrev_b32 v7, 4, v1
    s_lshl_b32 s45, s41, 6
    v_mfma_f32_16x16x32_bf16 v[76:79], a[112:115], a[56:59], v[76:79]
    ds_read_b64_tr_b16 a[110:111], v26 offset:61696
    s_lshl_b32 s46, s40, 3
    v_mfma_f32_16x16x32_bf16 v[76:79], a[116:119], a[60:63], v[76:79]
    s_add_u32 s45, s45, s46
    s_lshl_b32 s46, s43, 2
    s_waitcnt lgkmcnt(8)
    v_mfma_f32_16x16x32_bf16 v[80:83], a[112:115], a[64:67], v[80:83]
    s_add_u32 s45, s45, s46
    s_lshl_b32 s83, s45, 12
    s_waitcnt lgkmcnt(7)
    v_mfma_f32_16x16x32_bf16 v[80:83], a[116:119], a[68:71], v[80:83]
    s_add_u32 s83, s83, 4194304
    s_add_u32 s84, s83, 4096
    v_mfma_f32_16x16x32_bf16 v[84:87], a[112:115], a[72:75], v[84:87]
    s_add_u32 s82, s83, 8192
    s_add_u32 s80, s83, 12288
    v_mfma_f32_16x16x32_bf16 v[84:87], a[116:119], a[76:79], v[84:87]
    s_lshl_b32 s45, s40, 1
    s_add_u32 s45, s45, s43
    v_mfma_f32_16x16x32_bf16 v[88:91], a[112:115], a[80:83], v[88:91]
    s_mul_i32 s45, s45, 288
    s_mul_i32 s46, s41, 7
    v_mfma_f32_16x16x32_bf16 v[88:91], a[116:119], a[84:87], v[88:91]
    s_add_u32 s45, s45, s46
    s_lshl_b32 s45, s45, 12
    v_mfma_f32_16x16x32_bf16 v[92:95], a[112:115], a[88:91], v[92:95]
    s_add_u32 s50, s45, 12582912
    s_sub_u32 s81, s50, 4096
    v_mfma_f32_16x16x32_bf16 v[92:95], a[116:119], a[92:95], v[92:95]
    s_lshl_b32 s46, s43, 14
    v_lshrrev_b32 v31, 3, v29
    v_mfma_f32_16x16x32_bf16 v[124:127], a[120:123], a[88:91], v[124:127]
    ds_read_b64_tr_b16 a[112:113], v27 offset:40960
    v_lshl_add_u32 v6, v31, 8, v6
    v_mfma_f32_16x16x32_bf16 v[124:127], a[124:127], a[92:95], v[124:127]
    v_and_b32 v31, 7, v29
    v_lshl_add_u32 v6, v31, 4, v6
    v_mfma_f32_16x16x32_bf16 v[120:123], a[120:123], a[80:83], v[120:123]
    ds_read_b64_tr_b16 a[114:115], v27 offset:42752
    v_add_u32 v8, s46, v6
    v_mfma_f32_16x16x32_bf16 v[120:123], a[124:127], a[84:87], v[120:123]
    s_lshl_b32 s46, s43, 13
    s_add_u32 s46, s46, 147456
    v_mfma_f32_16x16x32_bf16 v[116:119], a[120:123], a[72:75], v[116:119]
    ds_read_b64_tr_b16 a[116:117], v27 offset:51200
    v_add_u32 v9, s46, v6
    v_mfma_f32_16x16x32_bf16 v[116:119], a[124:127], a[76:79], v[116:119]
    s_mov_b32 s56, 0x3e8293ee
    s_mov_b32 s57, s56
    v_mfma_f32_16x16x32_bf16 v[112:115], a[120:123], a[64:67], v[112:115]
    ds_read_b64_tr_b16 a[118:119], v27 offset:52992
    v_cvt_pk_bf16_f32 v92, v92, v93
    v_mfma_f32_16x16x32_bf16 v[112:115], a[124:127], a[68:71], v[112:115]
    v_cvt_pk_bf16_f32 v93, v94, v95
    v_cvt_pk_bf16_f32 v94, v124, v125
    v_mfma_f32_16x16x32_bf16 v[108:111], a[120:123], a[56:59], v[108:111]
    v_cvt_pk_bf16_f32 v95, v126, v127
    buffer_store_dwordx4 v[92:95], v6, s[28:31], s80 offen offset:128 sc1
    v_mfma_f32_16x16x32_bf16 v[108:111], a[124:127], a[60:63], v[108:111]
    ds_write_b128 v8, v[92:95] offset:12416
    v_cvt_pk_bf16_f32 v88, v88, v89
    v_mfma_f32_16x16x32_bf16 v[104:107], a[120:123], a[48:51], v[104:107]
    v_cvt_pk_bf16_f32 v89, v90, v91
    v_cvt_pk_bf16_f32 v90, v120, v121
    v_mfma_f32_16x16x32_bf16 v[104:107], a[124:127], a[52:55], v[104:107]
    v_cvt_pk_bf16_f32 v91, v122, v123
    buffer_store_dwordx4 v[88:91], v6, s[28:31], s80 offen offset:0 sc1
    v_mfma_f32_16x16x32_bf16 v[100:103], a[120:123], a[40:43], v[100:103]
    ds_write_b128 v8, v[88:91] offset:12288
    v_cvt_pk_bf16_f32 v84, v84, v85
    v_mfma_f32_16x16x32_bf16 v[100:103], a[124:127], a[44:47], v[100:103]
    v_cvt_pk_bf16_f32 v85, v86, v87
    v_cvt_pk_bf16_f32 v86, v116, v117
    v_mfma_f32_16x16x32_bf16 v[96:99], a[120:123], a[32:35], v[96:99]
    v_cvt_pk_bf16_f32 v87, v118, v119
    buffer_store_dwordx4 v[84:87], v6, s[28:31], s82 offen offset:128 sc1
    v_mfma_f32_16x16x32_bf16 v[96:99], a[124:127], a[36:39], v[96:99]
    ds_write_b128 v8, v[84:87] offset:8320
    v_cvt_pk_bf16_f32 v80, v80, v81
    s_waitcnt lgkmcnt(13)
    v_mfma_f32_16x16x32_bf16 a[128:131], a[96:99], a[32:35], a[128:131]
    ds_read_b64_tr_b16 a[120:121], v28 offset:40960
    v_cvt_pk_bf16_f32 v81, v82, v83
    s_waitcnt lgkmcnt(12)
    v_mfma_f32_16x16x32_bf16 a[128:131], a[100:103], a[36:39], a[128:131]
    v_cvt_pk_bf16_f32 v82, v112, v113
    v_cvt_pk_bf16_f32 v83, v114, v115
    v_mfma_f32_16x16x32_bf16 a[132:135], a[96:99], a[40:43], a[132:135]
    ds_read_b64_tr_b16 a[122:123], v28 offset:42752
    buffer_store_dwordx4 v[80:83], v6, s[28:31], s82 offen offset:0 sc1
    v_mfma_f32_16x16x32_bf16 a[132:135], a[100:103], a[44:47], a[132:135]
    ds_write_b128 v8, v[80:83] offset:8192
    v_cvt_pk_bf16_f32 v76, v76, v77
    v_mfma_f32_16x16x32_bf16 a[136:139], a[96:99], a[48:51], a[136:139]
    ds_read_b64_tr_b16 a[124:125], v28 offset:51200
    v_cvt_pk_bf16_f32 v77, v78, v79
    v_mfma_f32_16x16x32_bf16 a[136:139], a[100:103], a[52:55], a[136:139]
    v_cvt_pk_bf16_f32 v78, v108, v109
    v_cvt_pk_bf16_f32 v79, v110, v111
    v_mfma_f32_16x16x32_bf16 a[140:143], a[96:99], a[56:59], a[140:143]
    ds_read_b64_tr_b16 a[126:127], v28 offset:52992
    buffer_store_dwordx4 v[76:79], v6, s[28:31], s84 offen offset:128 sc1
    v_mfma_f32_16x16x32_bf16 a[140:143], a[100:103], a[60:63], a[140:143]
    ds_write_b128 v8, v[76:79] offset:4224
    v_cvt_pk_bf16_f32 v72, v72, v73
    v_mfma_f32_16x16x32_bf16 a[144:147], a[96:99], a[64:67], a[144:147]
    v_cvt_pk_bf16_f32 v73, v74, v75
    v_cvt_pk_bf16_f32 v74, v104, v105
    v_mfma_f32_16x16x32_bf16 a[144:147], a[100:103], a[68:71], a[144:147]
    v_cvt_pk_bf16_f32 v75, v106, v107
    buffer_store_dwordx4 v[72:75], v6, s[28:31], s84 offen offset:0 sc1
    v_mfma_f32_16x16x32_bf16 a[148:151], a[96:99], a[72:75], a[148:151]
    ds_write_b128 v8, v[72:75] offset:4096
    v_cvt_pk_bf16_f32 v68, v68, v69
    v_mfma_f32_16x16x32_bf16 a[148:151], a[100:103], a[76:79], a[148:151]
    v_cvt_pk_bf16_f32 v69, v70, v71
    v_cvt_pk_bf16_f32 v70, v100, v101
    v_mfma_f32_16x16x32_bf16 a[152:155], a[96:99], a[80:83], a[152:155]
    v_cvt_pk_bf16_f32 v71, v102, v103
    buffer_store_dwordx4 v[68:71], v6, s[28:31], s83 offen offset:128 sc1
    v_mfma_f32_16x16x32_bf16 a[152:155], a[100:103], a[84:87], a[152:155]
    ds_write_b128 v8, v[68:71] offset:128
    v_cvt_pk_bf16_f32 v64, v64, v65
    v_mfma_f32_16x16x32_bf16 a[156:159], a[96:99], a[88:91], a[156:159]
    v_cvt_pk_bf16_f32 v65, v66, v67
    v_cvt_pk_bf16_f32 v66, v96, v97
    v_mfma_f32_16x16x32_bf16 a[156:159], a[100:103], a[92:95], a[156:159]
    v_cvt_pk_bf16_f32 v67, v98, v99
    buffer_store_dwordx4 v[64:67], v6, s[28:31], s83 offen offset:0 sc1
    s_waitcnt lgkmcnt(15)
    v_mfma_f32_16x16x32_bf16 a[188:191], a[104:107], a[88:91], a[188:191]
    ds_read_b64_tr_b16 a[96:97], v27 offset:40992
    ds_write_b128 v8, v[64:67] offset:0
    v_mfma_f32_16x16x32_bf16 a[188:191], a[108:111], a[92:95], a[188:191]
    v_mfma_f32_16x16x32_bf16 a[184:187], a[104:107], a[80:83], a[184:187]
    ds_read_b64_tr_b16 a[98:99], v27 offset:42784
    v_mfma_f32_16x16x32_bf16 a[184:187], a[108:111], a[84:87], a[184:187]
    v_mfma_f32_16x16x32_bf16 a[180:183], a[104:107], a[72:75], a[180:183]
    ds_read_b64_tr_b16 a[100:101], v27 offset:51232
    v_mfma_f32_16x16x32_bf16 a[180:183], a[108:111], a[76:79], a[180:183]
    v_accvgpr_read_b32 v36, a156
    v_accvgpr_read_b32 v37, a157
    v_mfma_f32_16x16x32_bf16 a[176:179], a[104:107], a[64:67], a[176:179]
    ds_read_b64_tr_b16 a[102:103], v27 offset:53024
    v_accvgpr_read_b32 v38, a158
    v_mfma_f32_16x16x32_bf16 a[176:179], a[108:111], a[68:71], a[176:179]
    v_accvgpr_read_b32 v39, a159
    v_accvgpr_read_b32 v40, a188
    v_mfma_f32_16x16x32_bf16 a[172:175], a[104:107], a[56:59], a[172:175]
    v_accvgpr_read_b32 v41, a189
    v_accvgpr_read_b32 v42, a190
    v_mfma_f32_16x16x32_bf16 a[172:175], a[108:111], a[60:63], a[172:175]
    v_accvgpr_read_b32 v43, a191
    v_mul_f32 v36, s56, v36
    v_mfma_f32_16x16x32_bf16 a[168:171], a[104:107], a[48:51], a[168:171]
    v_mul_f32 v37, s56, v37
    v_mul_f32 v38, s56, v38
    v_mfma_f32_16x16x32_bf16 a[168:171], a[108:111], a[52:55], a[168:171]
    v_mul_f32 v39, s56, v39
    v_mul_f32 v40, s56, v40
    v_mfma_f32_16x16x32_bf16 a[164:167], a[104:107], a[40:43], a[164:167]
    v_mul_f32 v41, s56, v41
    v_mul_f32 v42, s56, v42
    v_mfma_f32_16x16x32_bf16 a[164:167], a[108:111], a[44:47], a[164:167]
    v_mul_f32 v43, s56, v43
    v_cvt_pk_bf16_f32 v52, v36, v37
    v_mfma_f32_16x16x32_bf16 a[160:163], a[104:107], a[32:35], a[160:163]
    v_cvt_pk_bf16_f32 v53, v38, v39
    v_cvt_pk_bf16_f32 v54, v40, v41
    v_mfma_f32_16x16x32_bf16 a[160:163], a[108:111], a[36:39], a[160:163]
    v_cvt_pk_bf16_f32 v55, v42, v43
    ds_write_b128 v9, v[52:55] offset:6272
    s_waitcnt lgkmcnt(15)
    v_mfma_f32_16x16x32_bf16 a[192:195], a[112:115], a[32:35], a[192:195]
    ds_read_b64_tr_b16 a[104:105], v28 offset:40992
    v_accvgpr_read_b32 v36, a152
    v_mfma_f32_16x16x32_bf16 a[192:195], a[116:119], a[36:39], a[192:195]
    v_accvgpr_read_b32 v37, a153
    v_accvgpr_read_b32 v38, a154
    v_mfma_f32_16x16x32_bf16 a[196:199], a[112:115], a[40:43], a[196:199]
    ds_read_b64_tr_b16 a[106:107], v28 offset:42784
    v_accvgpr_read_b32 v39, a155
    v_mfma_f32_16x16x32_bf16 a[196:199], a[116:119], a[44:47], a[196:199]
    v_accvgpr_read_b32 v40, a184
    v_accvgpr_read_b32 v41, a185
    v_mfma_f32_16x16x32_bf16 a[200:203], a[112:115], a[48:51], a[200:203]
    ds_read_b64_tr_b16 a[108:109], v28 offset:51232
    v_accvgpr_read_b32 v42, a186
    v_mfma_f32_16x16x32_bf16 a[200:203], a[116:119], a[52:55], a[200:203]
    v_accvgpr_read_b32 v43, a187
    v_mul_f32 v36, s56, v36
    v_mfma_f32_16x16x32_bf16 a[204:207], a[112:115], a[56:59], a[204:207]
    ds_read_b64_tr_b16 a[110:111], v28 offset:53024
    v_mul_f32 v37, s56, v37
    v_mfma_f32_16x16x32_bf16 a[204:207], a[116:119], a[60:63], a[204:207]
    v_mul_f32 v38, s56, v38
    v_mul_f32 v39, s56, v39
    v_mfma_f32_16x16x32_bf16 a[208:211], a[112:115], a[64:67], a[208:211]
    v_mul_f32 v40, s56, v40
    v_mul_f32 v41, s56, v41
    v_mfma_f32_16x16x32_bf16 a[208:211], a[116:119], a[68:71], a[208:211]
    v_mul_f32 v42, s56, v42
    v_mul_f32 v43, s56, v43
    v_mfma_f32_16x16x32_bf16 a[212:215], a[112:115], a[72:75], a[212:215]
    v_cvt_pk_bf16_f32 v56, v36, v37
    v_cvt_pk_bf16_f32 v57, v38, v39
    v_mfma_f32_16x16x32_bf16 a[212:215], a[116:119], a[76:79], a[212:215]
    v_cvt_pk_bf16_f32 v58, v40, v41
    v_cvt_pk_bf16_f32 v59, v42, v43
    v_mfma_f32_16x16x32_bf16 a[216:219], a[112:115], a[80:83], a[216:219]
    ds_write_b128 v9, v[56:59] offset:6144
    v_accvgpr_read_b32 v36, a148
    v_mfma_f32_16x16x32_bf16 a[216:219], a[116:119], a[84:87], a[216:219]
    v_accvgpr_read_b32 v37, a149
    v_accvgpr_read_b32 v38, a150
    v_mfma_f32_16x16x32_bf16 a[220:223], a[112:115], a[88:91], a[220:223]
    v_accvgpr_read_b32 v39, a151
    v_accvgpr_read_b32 v40, a180
    v_mfma_f32_16x16x32_bf16 a[220:223], a[116:119], a[92:95], a[220:223]
    v_accvgpr_read_b32 v41, a181
    v_accvgpr_read_b32 v42, a182
    s_waitcnt lgkmcnt(15)
    v_mfma_f32_16x16x32_bf16 a[252:255], a[120:123], a[88:91], a[252:255]
    ds_read_b64_tr_b16 a[112:113], v27 offset:41024
    v_accvgpr_read_b32 v43, a183
    s_waitcnt lgkmcnt(15)
    v_mfma_f32_16x16x32_bf16 a[252:255], a[124:127], a[92:95], a[252:255]
    v_mul_f32 v36, s56, v36
    v_mul_f32 v37, s56, v37
    v_mfma_f32_16x16x32_bf16 a[248:251], a[120:123], a[80:83], a[248:251]
    ds_read_b64_tr_b16 a[114:115], v27 offset:42816
    v_mul_f32 v38, s56, v38
    v_mfma_f32_16x16x32_bf16 a[248:251], a[124:127], a[84:87], a[248:251]
    v_mul_f32 v39, s56, v39
    v_mul_f32 v40, s56, v40
    v_mfma_f32_16x16x32_bf16 a[244:247], a[120:123], a[72:75], a[244:247]
    ds_read_b64_tr_b16 a[116:117], v27 offset:51264
    v_mul_f32 v41, s56, v41
    v_mfma_f32_16x16x32_bf16 a[244:247], a[124:127], a[76:79], a[244:247]
    v_mul_f32 v42, s56, v42
    v_mul_f32 v43, s56, v43
    v_mfma_f32_16x16x32_bf16 a[240:243], a[120:123], a[64:67], a[240:243]
    ds_read_b64_tr_b16 a[118:119], v27 offset:53056
    v_cvt_pk_bf16_f32 v60, v36, v37
    v_mfma_f32_16x16x32_bf16 a[240:243], a[124:127], a[68:71], a[240:243]
    v_cvt_pk_bf16_f32 v61, v38, v39
    v_cvt_pk_bf16_f32 v62, v40, v41
    v_mfma_f32_16x16x32_bf16 a[236:239], a[120:123], a[56:59], a[236:239]
    v_cvt_pk_bf16_f32 v63, v42, v43
    ds_write_b128 v9, v[60:63] offset:4224
    v_mfma_f32_16x16x32_bf16 a[236:239], a[124:127], a[60:63], a[236:239]
    v_accvgpr_read_b32 v36, a144
    v_accvgpr_read_b32 v37, a145
    v_mfma_f32_16x16x32_bf16 a[232:235], a[120:123], a[48:51], a[232:235]
    v_accvgpr_read_b32 v38, a146
    v_accvgpr_read_b32 v39, a147
    v_mfma_f32_16x16x32_bf16 a[232:235], a[124:127], a[52:55], a[232:235]
    v_accvgpr_read_b32 v40, a176
    v_accvgpr_read_b32 v41, a177
    v_mfma_f32_16x16x32_bf16 a[228:231], a[120:123], a[40:43], a[228:231]
    v_accvgpr_read_b32 v42, a178
    v_accvgpr_read_b32 v43, a179
    v_mfma_f32_16x16x32_bf16 a[228:231], a[124:127], a[44:47], a[228:231]
    v_mul_f32 v36, s56, v36
    v_mul_f32 v37, s56, v37
    v_mfma_f32_16x16x32_bf16 a[224:227], a[120:123], a[32:35], a[224:227]
    v_mul_f32 v38, s56, v38
    v_mul_f32 v39, s56, v39
    v_mfma_f32_16x16x32_bf16 a[224:227], a[124:127], a[36:39], a[224:227]
    v_mul_f32 v40, s56, v40
    v_mul_f32 v41, s56, v41
    s_waitcnt lgkmcnt(13)
    v_mfma_f32_16x16x32_bf16 v[128:131], a[96:99], a[32:35], v[128:131]
    ds_read_b64_tr_b16 a[120:121], v28 offset:41024
    v_mul_f32 v42, s56, v42
    s_waitcnt lgkmcnt(12)
    v_mfma_f32_16x16x32_bf16 v[128:131], a[100:103], a[36:39], v[128:131]
    v_mul_f32 v43, s56, v43
    v_cvt_pk_bf16_f32 v52, v36, v37
    v_mfma_f32_16x16x32_bf16 v[132:135], a[96:99], a[40:43], v[132:135]
    ds_read_b64_tr_b16 a[122:123], v28 offset:42816
    v_cvt_pk_bf16_f32 v53, v38, v39
    v_mfma_f32_16x16x32_bf16 v[132:135], a[100:103], a[44:47], v[132:135]
    v_cvt_pk_bf16_f32 v54, v40, v41
    v_cvt_pk_bf16_f32 v55, v42, v43
    v_mfma_f32_16x16x32_bf16 v[136:139], a[96:99], a[48:51], v[136:139]
    ds_read_b64_tr_b16 a[124:125], v28 offset:51264
    ds_write_b128 v9, v[52:55] offset:4096
    v_mfma_f32_16x16x32_bf16 v[136:139], a[100:103], a[52:55], v[136:139]
    v_accvgpr_read_b32 v36, a140
    v_accvgpr_read_b32 v37, a141
    v_mfma_f32_16x16x32_bf16 v[140:143], a[96:99], a[56:59], v[140:143]
    ds_read_b64_tr_b16 a[126:127], v28 offset:53056
    v_accvgpr_read_b32 v38, a142
    v_mfma_f32_16x16x32_bf16 v[140:143], a[100:103], a[60:63], v[140:143]
    v_accvgpr_read_b32 v39, a143
    v_accvgpr_read_b32 v40, a172
    v_mfma_f32_16x16x32_bf16 v[144:147], a[96:99], a[64:67], v[144:147]
    v_accvgpr_read_b32 v41, a173
    v_accvgpr_read_b32 v42, a174
    v_mfma_f32_16x16x32_bf16 v[144:147], a[100:103], a[68:71], v[144:147]
    v_accvgpr_read_b32 v43, a175
    v_mul_f32 v36, s56, v36
    v_mfma_f32_16x16x32_bf16 v[148:151], a[96:99], a[72:75], v[148:151]
    v_mul_f32 v37, s56, v37
    v_mul_f32 v38, s56, v38
    v_mfma_f32_16x16x32_bf16 v[148:151], a[100:103], a[76:79], v[148:151]
    v_mul_f32 v39, s56, v39
    v_mul_f32 v40, s56, v40
    v_mfma_f32_16x16x32_bf16 v[152:155], a[96:99], a[80:83], v[152:155]
    v_mul_f32 v41, s56, v41
    v_mov_b32 v29, 1
    s_waitcnt vmcnt(0)
    buffer_store_dword v29, v5, s[32:35], 0 offen sc1
    v_mfma_f32_16x16x32_bf16 v[152:155], a[100:103], a[84:87], v[152:155]
    v_mul_f32 v42, s56, v42
    v_mul_f32 v43, s56, v43
    v_mfma_f32_16x16x32_bf16 v[156:159], a[96:99], a[88:91], v[156:159]
    v_cvt_pk_bf16_f32 v56, v36, v37
    v_cvt_pk_bf16_f32 v57, v38, v39
    v_mfma_f32_16x16x32_bf16 v[156:159], a[100:103], a[92:95], v[156:159]
    v_cvt_pk_bf16_f32 v58, v40, v41
    v_cvt_pk_bf16_f32 v59, v42, v43
    s_waitcnt lgkmcnt(13)
    v_mfma_f32_16x16x32_bf16 v[188:191], a[104:107], a[88:91], v[188:191]
    ds_write_b128 v9, v[56:59] offset:2176
    v_accvgpr_read_b32 v36, a136
    s_waitcnt lgkmcnt(12)
    v_mfma_f32_16x16x32_bf16 v[188:191], a[108:111], a[92:95], v[188:191]
    v_accvgpr_read_b32 v37, a137
    v_accvgpr_read_b32 v38, a138
    v_mfma_f32_16x16x32_bf16 v[184:187], a[104:107], a[80:83], v[184:187]
    v_accvgpr_read_b32 v39, a139
    v_accvgpr_read_b32 v40, a168
    v_mfma_f32_16x16x32_bf16 v[184:187], a[108:111], a[84:87], v[184:187]
    v_accvgpr_read_b32 v41, a169
    v_accvgpr_read_b32 v42, a170
    v_mfma_f32_16x16x32_bf16 v[180:183], a[104:107], a[72:75], v[180:183]
    v_accvgpr_read_b32 v43, a171
    v_mul_f32 v36, s56, v36
    v_mfma_f32_16x16x32_bf16 v[180:183], a[108:111], a[76:79], v[180:183]
    v_mul_f32 v37, s56, v37
    v_mul_f32 v38, s56, v38
    v_mfma_f32_16x16x32_bf16 v[176:179], a[104:107], a[64:67], v[176:179]
    v_mul_f32 v39, s56, v39
    v_mul_f32 v40, s56, v40
    v_mfma_f32_16x16x32_bf16 v[176:179], a[108:111], a[68:71], v[176:179]
    v_mul_f32 v41, s56, v41
    v_mul_f32 v42, s56, v42
    v_mfma_f32_16x16x32_bf16 v[172:175], a[104:107], a[56:59], v[172:175]
    v_mul_f32 v43, s56, v43
    v_cvt_pk_bf16_f32 v60, v36, v37
    v_mfma_f32_16x16x32_bf16 v[172:175], a[108:111], a[60:63], v[172:175]
    v_cvt_pk_bf16_f32 v61, v38, v39
    v_cvt_pk_bf16_f32 v62, v40, v41
    v_mfma_f32_16x16x32_bf16 v[168:171], a[104:107], a[48:51], v[168:171]
    v_cvt_pk_bf16_f32 v63, v42, v43
    ds_write_b128 v9, v[60:63] offset:2048
    v_mfma_f32_16x16x32_bf16 v[168:171], a[108:111], a[52:55], v[168:171]
    v_accvgpr_read_b32 v36, a132
    v_accvgpr_read_b32 v37, a133
    v_mfma_f32_16x16x32_bf16 v[164:167], a[104:107], a[40:43], v[164:167]
    v_accvgpr_read_b32 v38, a134
    v_accvgpr_read_b32 v39, a135
    v_mfma_f32_16x16x32_bf16 v[164:167], a[108:111], a[44:47], v[164:167]
    v_accvgpr_read_b32 v40, a164
    v_accvgpr_read_b32 v41, a165
    v_mfma_f32_16x16x32_bf16 v[160:163], a[104:107], a[32:35], v[160:163]
    v_accvgpr_read_b32 v42, a166
    v_accvgpr_read_b32 v43, a167
    v_mfma_f32_16x16x32_bf16 v[160:163], a[108:111], a[36:39], v[160:163]
    v_mul_f32 v36, s56, v36
    v_mul_f32 v37, s56, v37
    s_waitcnt lgkmcnt(10)
    v_mfma_f32_16x16x32_bf16 v[192:195], a[112:115], a[32:35], v[192:195]
    v_mul_f32 v38, s56, v38
    v_mul_f32 v39, s56, v39
    s_waitcnt lgkmcnt(8)
    v_mfma_f32_16x16x32_bf16 v[192:195], a[116:119], a[36:39], v[192:195]
    v_mul_f32 v40, s56, v40
    v_mul_f32 v41, s56, v41
    v_mfma_f32_16x16x32_bf16 v[196:199], a[112:115], a[40:43], v[196:199]
    v_mul_f32 v42, s56, v42
    v_mul_f32 v43, s56, v43
    v_mfma_f32_16x16x32_bf16 v[196:199], a[116:119], a[44:47], v[196:199]
    v_cvt_pk_bf16_f32 v52, v36, v37
    v_cvt_pk_bf16_f32 v53, v38, v39
    v_mfma_f32_16x16x32_bf16 v[200:203], a[112:115], a[48:51], v[200:203]
    v_cvt_pk_bf16_f32 v54, v40, v41
    v_cvt_pk_bf16_f32 v55, v42, v43
    v_mfma_f32_16x16x32_bf16 v[200:203], a[116:119], a[52:55], v[200:203]
    ds_write_b128 v9, v[52:55] offset:128
    v_accvgpr_read_b32 v36, a128
    v_mfma_f32_16x16x32_bf16 v[204:207], a[112:115], a[56:59], v[204:207]
    v_accvgpr_read_b32 v37, a129
    v_accvgpr_read_b32 v38, a130
    v_mfma_f32_16x16x32_bf16 v[204:207], a[116:119], a[60:63], v[204:207]
    v_accvgpr_read_b32 v39, a131
    v_accvgpr_read_b32 v40, a160
    v_mfma_f32_16x16x32_bf16 v[208:211], a[112:115], a[64:67], v[208:211]
    v_accvgpr_read_b32 v41, a161
    v_accvgpr_read_b32 v42, a162
    v_mfma_f32_16x16x32_bf16 v[208:211], a[116:119], a[68:71], v[208:211]
    v_accvgpr_read_b32 v43, a163
    v_mul_f32 v36, s56, v36
    v_mfma_f32_16x16x32_bf16 v[212:215], a[112:115], a[72:75], v[212:215]
    v_mul_f32 v37, s56, v37
    v_mul_f32 v38, s56, v38
    v_mfma_f32_16x16x32_bf16 v[212:215], a[116:119], a[76:79], v[212:215]
    v_mul_f32 v39, s56, v39
    v_mul_f32 v40, s56, v40
    v_mfma_f32_16x16x32_bf16 v[216:219], a[112:115], a[80:83], v[216:219]
    v_mul_f32 v41, s56, v41
    v_mul_f32 v42, s56, v42
    v_mfma_f32_16x16x32_bf16 v[216:219], a[116:119], a[84:87], v[216:219]
    v_mul_f32 v43, s56, v43
    v_cvt_pk_bf16_f32 v56, v36, v37
    v_mfma_f32_16x16x32_bf16 v[220:223], a[112:115], a[88:91], v[220:223]
    v_cvt_pk_bf16_f32 v57, v38, v39
    v_cvt_pk_bf16_f32 v58, v40, v41
    v_mfma_f32_16x16x32_bf16 v[220:223], a[116:119], a[92:95], v[220:223]
    v_cvt_pk_bf16_f32 v59, v42, v43
    ds_write_b128 v9, v[56:59] offset:0
    s_waitcnt lgkmcnt(7)
    v_mfma_f32_16x16x32_bf16 v[252:255], a[120:123], a[88:91], v[252:255]
    v_mul_f32 v152, v184, v152
    v_mul_f32 v153, v185, v153
    s_waitcnt lgkmcnt(4)
    v_mfma_f32_16x16x32_bf16 v[252:255], a[124:127], a[92:95], v[252:255]
    v_mul_f32 v154, v186, v154
    v_mul_f32 v155, v187, v155
    v_mfma_f32_16x16x32_bf16 v[248:251], a[120:123], a[80:83], v[248:251]
    v_mul_f32 v156, v188, v156
    v_mul_f32 v157, v189, v157
    v_mfma_f32_16x16x32_bf16 v[248:251], a[124:127], a[84:87], v[248:251]
    v_mul_f32 v158, v190, v158
    v_mul_f32 v159, v191, v159
    v_mfma_f32_16x16x32_bf16 v[244:247], a[120:123], a[72:75], v[244:247]
    v_cvt_pk_bf16_f32 v152, v152, v153
    v_cvt_pk_bf16_f32 v153, v154, v155
    v_mfma_f32_16x16x32_bf16 v[244:247], a[124:127], a[76:79], v[244:247]
    v_cvt_pk_bf16_f32 v154, v156, v157
    v_cvt_pk_bf16_f32 v155, v158, v159
    v_mfma_f32_16x16x32_bf16 v[240:243], a[120:123], a[64:67], v[240:243]
    v_permlane16_swap_b32 v152, v154
    v_permlane16_swap_b32 v153, v155
    v_mfma_f32_16x16x32_bf16 v[240:243], a[124:127], a[68:71], v[240:243]
    v_accvgpr_read_b32 v36, a216
    v_accvgpr_read_b32 v37, a217
    v_mfma_f32_16x16x32_bf16 v[236:239], a[120:123], a[56:59], v[236:239]
    v_accvgpr_read_b32 v38, a218
    v_accvgpr_read_b32 v39, a219
    v_mfma_f32_16x16x32_bf16 v[236:239], a[124:127], a[60:63], v[236:239]
    v_accvgpr_read_b32 v40, a248
    v_accvgpr_read_b32 v41, a249
    v_mfma_f32_16x16x32_bf16 v[232:235], a[120:123], a[48:51], v[232:235]
    v_accvgpr_read_b32 v42, a250
    v_accvgpr_read_b32 v43, a251
    v_mfma_f32_16x16x32_bf16 v[232:235], a[124:127], a[52:55], v[232:235]
    v_mul_f32 v36, v40, v36
    v_mul_f32 v37, v41, v37
    v_mfma_f32_16x16x32_bf16 v[228:231], a[120:123], a[40:43], v[228:231]
    v_mul_f32 v38, v42, v38
    v_mul_f32 v39, v43, v39
    v_mfma_f32_16x16x32_bf16 v[228:231], a[124:127], a[44:47], v[228:231]
    v_accvgpr_read_b32 v44, a220
    v_accvgpr_read_b32 v45, a221
    v_mfma_f32_16x16x32_bf16 v[224:227], a[120:123], a[32:35], v[224:227]
    v_accvgpr_read_b32 v46, a222
    v_accvgpr_read_b32 v47, a223
    v_mfma_f32_16x16x32_bf16 v[224:227], a[124:127], a[36:39], v[224:227]
    v_accvgpr_read_b32 v48, a252
    v_accvgpr_read_b32 v49, a253
    v_lshlrev_b32 v16, 4, v1
    s_lshl_b32 s45, s42, 12
    s_add_u32 s45, s45, 147456
    v_add_u32 v17, s45, v16
    s_waitcnt lgkmcnt(0)
    s_barrier
    ds_read_b128 a[40:43], v17 offset:0
    ds_read_b128 a[44:47], v17 offset:1024
    ds_read_b128 a[48:51], v17 offset:2048
    ds_read_b128 a[52:55], v17 offset:3072
    ds_read_b128 a[56:59], v16 offset:0
    ds_read_b128 a[60:63], v16 offset:1024
    ds_read_b128 a[64:67], v16 offset:4096
    ds_read_b128 a[68:71], v16 offset:5120
    v_accvgpr_read_b32 v50, a254
    v_accvgpr_read_b32 v51, a255
    v_pk_mul_f32 v[44:45], v[48:49], v[44:45]
    v_pk_mul_f32 v[46:47], v[50:51], v[46:47]
    v_cvt_pk_bf16_f32 v184, v36, v37
    v_cvt_pk_bf16_f32 v185, v38, v39
    v_cvt_pk_bf16_f32 v186, v44, v45
    v_cvt_pk_bf16_f32 v187, v46, v47
    s_nop 0
    v_permlane16_swap_b32 v184, v186
    v_permlane16_swap_b32 v185, v187
    v_pk_mul_f32 v[144:145], v[176:177], v[144:145]
    v_pk_mul_f32 v[146:147], v[178:179], v[146:147]
    v_pk_mul_f32 v[148:149], v[180:181], v[148:149]
    v_pk_mul_f32 v[150:151], v[182:183], v[150:151]
    v_cvt_pk_bf16_f32 v144, v144, v145
    v_cvt_pk_bf16_f32 v145, v146, v147
    v_cvt_pk_bf16_f32 v146, v148, v149
    v_cvt_pk_bf16_f32 v147, v150, v151
    s_nop 0
    v_permlane16_swap_b32 v144, v146
    v_permlane16_swap_b32 v145, v147
    v_accvgpr_read_b32 v36, a208
    v_accvgpr_read_b32 v37, a209
    v_accvgpr_read_b32 v38, a210
    v_accvgpr_read_b32 v39, a211
    v_accvgpr_read_b32 v40, a240
    s_waitcnt lgkmcnt(3)
    v_mfma_f32_32x32x16_bf16 v[64:79], a[56:59], a[40:43], 0
    v_accvgpr_read_b32 v41, a241
    v_accvgpr_read_b32 v42, a242
    v_accvgpr_read_b32 v43, a243
    v_pk_mul_f32 v[36:37], v[40:41], v[36:37]
    v_pk_mul_f32 v[38:39], v[42:43], v[38:39]
    v_accvgpr_read_b32 v44, a212
    v_accvgpr_read_b32 v45, a213
    s_waitcnt lgkmcnt(2)
    v_mfma_f32_32x32x16_bf16 v[64:79], a[60:63], a[44:47], v[64:79]
    v_accvgpr_read_b32 v46, a214
    v_accvgpr_read_b32 v47, a215
    v_accvgpr_read_b32 v48, a244
    v_accvgpr_read_b32 v49, a245
    v_accvgpr_read_b32 v50, a246
    v_accvgpr_read_b32 v51, a247
    v_pk_mul_f32 v[44:45], v[48:49], v[44:45]
    v_mfma_f32_32x32x16_bf16 v[80:95], a[56:59], a[48:51], 0
    v_pk_mul_f32 v[46:47], v[50:51], v[46:47]
    v_cvt_pk_bf16_f32 v176, v36, v37
    v_cvt_pk_bf16_f32 v177, v38, v39
    v_cvt_pk_bf16_f32 v178, v44, v45
    v_cvt_pk_bf16_f32 v179, v46, v47
    s_nop 0
    v_permlane16_swap_b32 v176, v178
    v_permlane16_swap_b32 v177, v179
    v_mfma_f32_32x32x16_bf16 v[80:95], a[60:63], a[52:55], v[80:95]
    v_pk_mul_f32 v[136:137], v[168:169], v[136:137]
    v_pk_mul_f32 v[138:139], v[170:171], v[138:139]
    v_pk_mul_f32 v[140:141], v[172:173], v[140:141]
    v_pk_mul_f32 v[142:143], v[174:175], v[142:143]
    v_cvt_pk_bf16_f32 v136, v136, v137
    v_cvt_pk_bf16_f32 v137, v138, v139
    v_cvt_pk_bf16_f32 v138, v140, v141
    v_cvt_pk_bf16_f32 v139, v142, v143
    s_nop 0
    v_permlane16_swap_b32 v136, v138
    v_permlane16_swap_b32 v137, v139
    v_accvgpr_read_b32 v36, a200
    v_accvgpr_read_b32 v37, a201
    v_accvgpr_read_b32 v38, a202
    v_accvgpr_read_b32 v39, a203
    v_accvgpr_read_b32 v40, a232
    v_accvgpr_read_b32 v41, a233
    v_accvgpr_read_b32 v42, a234
    v_accvgpr_read_b32 v43, a235
    v_pk_mul_f32 v[36:37], v[40:41], v[36:37]
    v_pk_mul_f32 v[38:39], v[42:43], v[38:39]
    v_accvgpr_read_b32 v44, a204
    v_accvgpr_read_b32 v45, a205
    v_accvgpr_read_b32 v46, a206
    v_accvgpr_read_b32 v47, a207
    v_accvgpr_read_b32 v48, a236
    v_accvgpr_read_b32 v49, a237
    v_accvgpr_read_b32 v50, a238
    v_accvgpr_read_b32 v51, a239
    v_pk_mul_f32 v[44:45], v[48:49], v[44:45]
    v_pk_mul_f32 v[46:47], v[50:51], v[46:47]
    v_cvt_pk_bf16_f32 v168, v36, v37
    v_cvt_pk_bf16_f32 v169, v38, v39
    v_cvt_pk_bf16_f32 v170, v44, v45
    v_cvt_pk_bf16_f32 v171, v46, v47
    s_nop 0
    v_permlane16_swap_b32 v168, v170
    v_permlane16_swap_b32 v169, v171
    v_pk_mul_f32 v[128:129], v[160:161], v[128:129]
    v_pk_mul_f32 v[130:131], v[162:163], v[130:131]
    v_pk_mul_f32 v[132:133], v[164:165], v[132:133]
    v_pk_mul_f32 v[134:135], v[166:167], v[134:135]
    v_cvt_pk_bf16_f32 v128, v128, v129
    v_cvt_pk_bf16_f32 v129, v130, v131
    v_cvt_pk_bf16_f32 v130, v132, v133
    v_cvt_pk_bf16_f32 v131, v134, v135
    s_nop 0
    v_permlane16_swap_b32 v128, v130
    v_permlane16_swap_b32 v129, v131
    v_accvgpr_read_b32 v36, a192
    v_accvgpr_read_b32 v37, a193
    v_accvgpr_read_b32 v38, a194
    v_accvgpr_read_b32 v39, a195
    v_accvgpr_read_b32 v40, a224
    v_accvgpr_read_b32 v41, a225
    v_accvgpr_read_b32 v42, a226
    v_accvgpr_read_b32 v43, a227
    v_pk_mul_f32 v[36:37], v[40:41], v[36:37]
    v_pk_mul_f32 v[38:39], v[42:43], v[38:39]
    v_accvgpr_read_b32 v44, a196
    v_accvgpr_read_b32 v45, a197
    v_accvgpr_read_b32 v46, a198
    v_accvgpr_read_b32 v47, a199
    v_accvgpr_read_b32 v48, a228
    v_accvgpr_read_b32 v49, a229
    v_accvgpr_read_b32 v50, a230
    v_accvgpr_read_b32 v51, a231
    v_pk_mul_f32 v[44:45], v[48:49], v[44:45]
    v_pk_mul_f32 v[46:47], v[50:51], v[46:47]
    v_cvt_pk_bf16_f32 v160, v36, v37
    v_cvt_pk_bf16_f32 v161, v38, v39
    v_cvt_pk_bf16_f32 v162, v44, v45
    v_cvt_pk_bf16_f32 v163, v46, v47
    s_nop 0
    v_permlane16_swap_b32 v160, v162
    v_permlane16_swap_b32 v161, v163
    v_pk_mul_f32 v[216:217], v[216:217], v[248:249]
    v_pk_mul_f32 v[218:219], v[218:219], v[250:251]
    v_pk_mul_f32 v[220:221], v[220:221], v[252:253]
    v_pk_mul_f32 v[222:223], v[222:223], v[254:255]
    v_cvt_pk_bf16_f32 v216, v216, v217
    v_cvt_pk_bf16_f32 v217, v218, v219
    v_cvt_pk_bf16_f32 v218, v220, v221
    v_cvt_pk_bf16_f32 v219, v222, v223
    s_nop 0
    v_permlane16_swap_b32 v216, v218
    v_permlane16_swap_b32 v217, v219
    v_pk_mul_f32 v[208:209], v[208:209], v[240:241]
    v_pk_mul_f32 v[210:211], v[210:211], v[242:243]
    v_pk_mul_f32 v[212:213], v[212:213], v[244:245]
    v_pk_mul_f32 v[214:215], v[214:215], v[246:247]
    v_cvt_pk_bf16_f32 v208, v208, v209
    v_cvt_pk_bf16_f32 v209, v210, v211
    v_cvt_pk_bf16_f32 v210, v212, v213
    v_cvt_pk_bf16_f32 v211, v214, v215
    s_nop 0
    v_permlane16_swap_b32 v208, v210
    v_permlane16_swap_b32 v209, v211
    v_pk_mul_f32 v[200:201], v[200:201], v[232:233]
    v_pk_mul_f32 v[202:203], v[202:203], v[234:235]
    v_pk_mul_f32 v[204:205], v[204:205], v[236:237]
    v_pk_mul_f32 v[206:207], v[206:207], v[238:239]
    v_cvt_pk_bf16_f32 v200, v200, v201
    v_cvt_pk_bf16_f32 v201, v202, v203
    v_cvt_pk_bf16_f32 v202, v204, v205
    v_cvt_pk_bf16_f32 v203, v206, v207
    s_nop 0
    v_permlane16_swap_b32 v200, v202
    v_permlane16_swap_b32 v201, v203
    v_pk_mul_f32 v[192:193], v[192:193], v[224:225]
    v_pk_mul_f32 v[194:195], v[194:195], v[226:227]
    v_pk_mul_f32 v[196:197], v[196:197], v[228:229]
    v_pk_mul_f32 v[198:199], v[198:199], v[230:231]
    v_cvt_pk_bf16_f32 v192, v192, v193
    v_cvt_pk_bf16_f32 v193, v194, v195
    v_cvt_pk_bf16_f32 v194, v196, v197
    v_cvt_pk_bf16_f32 v195, v198, v199
    s_nop 0
    v_permlane16_swap_b32 v192, v194
    v_permlane16_swap_b32 v193, v195
    s_branch gated_mix__softmax_full_mha__glu_gated_bilinear__prompt_kernel_join
gated_mix__softmax_full_mha__glu_gated_bilinear__prompt_kernel_c1:
    ds_read_b64_tr_b16 a[96:97], v25 offset:0
    ds_read_b64_tr_b16 a[98:99], v25 offset:256
    ds_read_b64_tr_b16 a[100:101], v25 offset:20480
    ds_read_b64_tr_b16 a[102:103], v25 offset:20736
    ds_read_b128 a[16:19], v23 offset:4096
    ds_read_b128 a[20:23], v24 offset:4096
    ds_read_b128 a[24:27], v23 offset:6144
    ds_read_b128 a[28:31], v24 offset:6144
    ds_read_b128 a[64:67], v23 offset:8192
    ds_read_b128 a[68:71], v24 offset:8192
    ds_read_b128 a[72:75], v23 offset:10240
    ds_read_b128 a[76:79], v24 offset:10240
    ds_read_b128 a[80:83], v23 offset:12288
    ds_read_b128 a[84:87], v24 offset:12288
    ds_read_b128 a[88:91], v23 offset:14336
    ds_read_b128 a[92:95], v24 offset:14336
    ds_read_b64_tr_b16 a[104:105], v26 offset:0
    ds_read_b64_tr_b16 a[106:107], v26 offset:256
    ds_read_b64_tr_b16 a[108:109], v26 offset:20480
    ds_read_b64_tr_b16 a[110:111], v26 offset:20736
    ds_read_b64_tr_b16 a[112:113], v27 offset:0
    ds_read_b64_tr_b16 a[114:115], v27 offset:1792
    ds_read_b64_tr_b16 a[116:117], v27 offset:10240
    ds_read_b64_tr_b16 a[118:119], v27 offset:12032
    s_waitcnt lgkmcnt(15)
    v_mfma_f32_16x16x32_bf16 v[64:67], a[0:3], a[96:99], 0
    ds_read_b64_tr_b16 a[120:121], v28 offset:0
    s_add_u32 m0, s90, 32768
    v_mfma_f32_16x16x32_bf16 v[64:67], a[4:7], a[100:103], v[64:67]
    buffer_load_dwordx4 v6, s[56:59], s82 offen offset:0 lds
    s_add_u32 s32, s24, 34603008
    s_addc_u32 s33, s25, 0
    v_mfma_f32_16x16x32_bf16 v[68:71], a[8:11], a[96:99], 0
    ds_read_b64_tr_b16 a[122:123], v28 offset:1792
    s_movk_i32 s34, 8192
    v_mfma_f32_16x16x32_bf16 v[68:71], a[12:15], a[100:103], v[68:71]
    s_mov_b32 s35, 0x00020000
    s_mov_b32 s28, s24
    v_mfma_f32_16x16x32_bf16 v[72:75], a[16:19], a[96:99], 0
    ds_read_b64_tr_b16 a[124:125], v28 offset:10240
    s_mov_b32 s29, s25
    v_mfma_f32_16x16x32_bf16 v[72:75], a[20:23], a[100:103], v[72:75]
    buffer_load_dwordx4 v7, s[56:59], s82 offen offset:1024 lds
    s_mov_b32 s30, 268435456
    v_mfma_f32_16x16x32_bf16 v[76:79], a[24:27], a[96:99], 0
    ds_read_b64_tr_b16 a[126:127], v28 offset:12032
    s_mov_b32 s31, 0x00020000
    v_mfma_f32_16x16x32_bf16 v[76:79], a[28:31], a[100:103], v[76:79]
    s_mov_b32 s75, 0x00020000
    s_lshl_b32 s45, s40, 5
    v_mfma_f32_16x16x32_bf16 v[80:83], a[64:67], a[96:99], 0
    s_add_u32 s45, s45, s41
    s_lshl_b32 s87, s45, 7
    s_waitcnt lgkmcnt(15)
    v_mfma_f32_16x16x32_bf16 v[80:83], a[68:71], a[100:103], v[80:83]
    buffer_load_dwordx4 v8, s[56:59], s82 offen offset:2048 lds
    s_lshl_b32 s45, s45, 2
    v_mfma_f32_16x16x32_bf16 v[84:87], a[72:75], a[96:99], 0
    s_add_u32 s45, s45, s42
    s_lshl_b32 s45, s45, 2
    v_mfma_f32_16x16x32_bf16 v[84:87], a[76:79], a[100:103], v[84:87]
    v_mov_b32 v29, s45
    v_cmp_eq_u32 vcc, 0, v1
    v_mfma_f32_16x16x32_bf16 v[88:91], a[80:83], a[96:99], 0
    v_mov_b32 v32, 0
    v_cndmask_b32 v3, 2.0, v29, vcc
    s_waitcnt lgkmcnt(14)
    v_mfma_f32_16x16x32_bf16 v[88:91], a[84:87], a[100:103], v[88:91]
    buffer_load_dwordx4 v9, s[56:59], s82 offen offset:3072 lds
    s_lshl_b32 s45, s41, 3
    s_waitcnt lgkmcnt(13)
    v_mfma_f32_16x16x32_bf16 v[92:95], a[88:91], a[96:99], 0
    s_add_u32 s45, s45, s40
    s_lshl_b32 s45, s45, 2
    s_waitcnt lgkmcnt(12)
    v_mfma_f32_16x16x32_bf16 v[92:95], a[92:95], a[100:103], v[92:95]
    s_add_u32 s45, s45, s42
    s_lshl_b32 s45, s45, 2
    s_waitcnt lgkmcnt(10)
    v_mfma_f32_16x16x32_bf16 v[124:127], a[88:91], a[104:107], 0
    ds_read_b64_tr_b16 a[96:97], v27 offset:32
    s_add_u32 m0, s90, 36864
    s_waitcnt lgkmcnt(9)
    v_mfma_f32_16x16x32_bf16 v[124:127], a[92:95], a[108:111], v[124:127]
    buffer_load_dwordx4 v10, s[56:59], s82 offen offset:0 lds
    s_add_u32 s45, s45, 4096
    v_mfma_f32_16x16x32_bf16 v[120:123], a[80:83], a[104:107], 0
    ds_read_b64_tr_b16 a[98:99], v27 offset:1824
    v_mov_b32 v29, s45
    v_mfma_f32_16x16x32_bf16 v[120:123], a[84:87], a[108:111], v[120:123]
    buffer_store_dword v32, v3, s[32:35], 0 offen sc1
    v_cndmask_b32 v5, 2.0, v29, vcc
    v_mfma_f32_16x16x32_bf16 v[116:119], a[72:75], a[104:107], 0
    ds_read_b64_tr_b16 a[100:101], v27 offset:10272
    s_lshl_b32 s46, s42, 3
    v_mfma_f32_16x16x32_bf16 v[116:119], a[76:79], a[108:111], v[116:119]
    buffer_load_dwordx4 v11, s[56:59], s82 offen offset:1024 lds
    buffer_store_dword v32, v5, s[32:35], 0 offen sc1
    v_mfma_f32_16x16x32_bf16 v[112:115], a[64:67], a[104:107], 0
    ds_read_b64_tr_b16 a[102:103], v27 offset:12064
    s_add_u32 s87, s87, s46
    v_mfma_f32_16x16x32_bf16 v[112:115], a[68:71], a[108:111], v[112:115]
    s_add_u32 s87, s87, 33554432
    s_lshl_b32 s45, s41, 3
    v_mfma_f32_16x16x32_bf16 v[108:111], a[24:27], a[104:107], 0
    s_lshl_b32 s46, s42, 1
    s_add_u32 s45, s45, s46
    v_mfma_f32_16x16x32_bf16 v[108:111], a[28:31], a[108:111], v[108:111]
    buffer_load_dwordx4 v12, s[56:59], s82 offen offset:2048 lds
    s_lshl_b32 s47, s45, 11
    v_mfma_f32_16x16x32_bf16 v[104:107], a[16:19], a[104:107], 0
    s_mov_b32 s92, 0xffff0000
    v_lshlrev_b32 v29, 5, v1
    v_mfma_f32_16x16x32_bf16 v[104:107], a[20:23], a[108:111], v[104:107]
    s_mov_b32 s36, s22
    s_mov_b32 s37, s23
    v_mfma_f32_16x16x32_bf16 v[100:103], a[8:11], a[104:107], 0
    s_movk_i32 s38, 256
    s_mov_b32 s39, 0x00020000
    v_mfma_f32_16x16x32_bf16 v[100:103], a[12:15], a[108:111], v[100:103]
    buffer_load_dwordx4 v13, s[56:59], s82 offen offset:3072 lds
    s_and_b32 s89, s2, 7
    v_mfma_f32_16x16x32_bf16 v[96:99], a[0:3], a[104:107], 0
    s_lshl_b32 s89, s89, 2
    s_and_b32 s88, s40, 3
    v_mfma_f32_16x16x32_bf16 v[96:99], a[4:7], a[108:111], v[96:99]
    s_add_u32 s83, s83, 393216
    s_add_u32 s88, s88, 3
    s_waitcnt lgkmcnt(10)
    v_mfma_f32_16x16x32_bf16 a[128:131], a[112:115], a[0:3], 0
    ds_read_b64_tr_b16 a[104:105], v28 offset:32
    s_add_u32 s84, s84, 458752
    s_waitcnt lgkmcnt(9)
    v_mfma_f32_16x16x32_bf16 a[128:131], a[116:119], a[4:7], a[128:131]
    s_add_u32 s82, s82, 128
    v_mov_b32 v31, 1
    v_mfma_f32_16x16x32_bf16 a[132:135], a[112:115], a[8:11], 0
    ds_read_b64_tr_b16 a[106:107], v28 offset:1824
    buffer_load_dword v2, v33, s[68:71], s85 offen
    v_mfma_f32_16x16x32_bf16 a[132:135], a[116:119], a[12:15], a[132:135]
    s_add_u32 s85, s85, s86
    v_cmp_eq_u32 s[26:27], 0, v0
    v_mfma_f32_16x16x32_bf16 a[136:139], a[112:115], a[16:19], 0
    ds_read_b64_tr_b16 a[108:109], v28 offset:10272
    v_cndmask_b32 v30, 2.0, 0, s[26:27]
    v_mfma_f32_16x16x32_bf16 a[136:139], a[116:119], a[20:23], a[136:139]
    s_getpc_b64 s[26:27]
gated_mix__softmax_full_mha__glu_gated_bilinear__prompt_kernel_pc1:
    s_lshr_b32 s45, s2, 3
    v_mfma_f32_16x16x32_bf16 a[140:143], a[112:115], a[24:27], 0
    ds_read_b64_tr_b16 a[110:111], v28 offset:12064
    s_lshl_b32 s46, s45, 9
    v_mfma_f32_16x16x32_bf16 a[140:143], a[116:119], a[28:31], a[140:143]
    s_add_u32 s46, s46, gated_mix__softmax_full_mha__glu_gated_bilinear__prompt_kernel_c1out-gated_mix__softmax_full_mha__glu_gated_bilinear__prompt_kernel_pc1
    v_and_b32 v37, 3, v1
    v_mfma_f32_16x16x32_bf16 a[144:147], a[112:115], a[64:67], 0
    v_lshl_add_u32 v37, v37, 7, s46
    s_lshl_b32 s45, s45, 2
    v_mfma_f32_16x16x32_bf16 a[144:147], a[116:119], a[68:71], a[144:147]
    s_add_u32 s45, s45, s42
    s_lshl_b32 s45, s45, 8
    v_mfma_f32_16x16x32_bf16 a[148:151], a[112:115], a[72:75], 0
    s_add_u32 s45, s45, gated_mix__softmax_full_mha__glu_gated_bilinear__prompt_kernel_join-gated_mix__softmax_full_mha__glu_gated_bilinear__prompt_kernel_pc1
    v_and_b32 v36, 1, v1
    v_mfma_f32_16x16x32_bf16 a[148:151], a[116:119], a[76:79], a[148:151]
    v_lshl_add_u32 v36, v36, 7, s45
    v_and_b32 v38, 4, v1
    v_mfma_f32_16x16x32_bf16 a[152:155], a[112:115], a[80:83], 0
    v_cmp_eq_u32 vcc, 0, v38
    s_nop 1
    v_cndmask_b32 v34, v36, v37, vcc
    v_mfma_f32_16x16x32_bf16 a[152:155], a[116:119], a[84:87], a[152:155]
    v_min_u32 v34, gated_mix__softmax_full_mha__glu_gated_bilinear__prompt_kernel_end-gated_mix__softmax_full_mha__glu_gated_bilinear__prompt_kernel_pc1, v34
    v_mov_b32 v61, s27
    v_mfma_f32_16x16x32_bf16 a[156:159], a[112:115], a[88:91], 0
    v_add_co_u32 v60, vcc, s26, v34
    s_nop 1
    v_addc_co_u32 v61, vcc, 0, v61, vcc
    s_mov_b32 s76, s18
    v_mfma_f32_16x16x32_bf16 a[156:159], a[116:119], a[92:95], a[156:159]
    s_mov_b32 s77, s19
    s_movk_i32 s78, 2048
    s_waitcnt lgkmcnt(10)
    v_mfma_f32_16x16x32_bf16 a[188:191], a[120:123], a[88:91], 0
    ds_read_b64_tr_b16 a[112:113], v27 offset:64
    s_mov_b32 s79, 0x00020000
    s_waitcnt lgkmcnt(9)
    v_mfma_f32_16x16x32_bf16 a[188:191], a[124:127], a[92:95], a[188:191]
    v_lshlrev_b32 v35, 7, v1
    buffer_load_dword v2, v35, s[76:79], 0 offen
    v_mfma_f32_16x16x32_bf16 a[184:187], a[120:123], a[80:83], 0
    ds_read_b64_tr_b16 a[114:115], v27 offset:1856
    s_lshl_b32 s45, s2, 2
    v_mfma_f32_16x16x32_bf16 a[184:187], a[124:127], a[84:87], a[184:187]
    s_add_u32 s45, s45, s42
    s_lshl_b32 s46, s45, 11
    v_mfma_f32_16x16x32_bf16 a[180:183], a[120:123], a[72:75], 0
    ds_read_b64_tr_b16 a[116:117], v27 offset:10304
    v_lshl_add_u32 v35, v1, 7, s46
    v_mfma_f32_16x16x32_bf16 a[180:183], a[124:127], a[76:79], a[180:183]
    v_cmp_gt_u32 s[26:27], 16, v1
    s_mov_b32 s76, s8
    v_mfma_f32_16x16x32_bf16 a[176:179], a[120:123], a[64:67], 0
    ds_read_b64_tr_b16 a[118:119], v27 offset:12096
    s_mov_b32 s77, s9
    v_mfma_f32_16x16x32_bf16 a[176:179], a[124:127], a[68:71], a[176:179]
    s_mov_b32 s78, 2097152
    v_cndmask_b32 v35, 2.0, v35, s[26:27]
    v_mfma_f32_16x16x32_bf16 a[172:175], a[120:123], a[24:27], 0
    s_lshl_b32 s45, s2, 2
    s_add_u32 s45, s45, s42
    v_mfma_f32_16x16x32_bf16 a[172:175], a[124:127], a[28:31], a[172:175]
    s_mul_i32 s46, s45, 768
    v_lshl_add_u32 v32, v1, 7, s46
    v_mfma_f32_16x16x32_bf16 a[168:171], a[120:123], a[16:19], 0
    v_cmp_gt_u32 vcc, 6, v1
    s_mov_b32 s72, s16
    v_mfma_f32_16x16x32_bf16 a[168:171], a[124:127], a[20:23], a[168:171]
    s_mov_b32 s73, s17
    s_mov_b32 s74, 7340032
    v_mfma_f32_16x16x32_bf16 a[164:167], a[120:123], a[8:11], 0
    v_cndmask_b32 v32, 2.0, v32, vcc
    s_mov_b32 s81, 0
    v_mfma_f32_16x16x32_bf16 a[164:167], a[124:127], a[12:15], a[164:167]
    v_mfma_f32_16x16x32_bf16 a[160:163], a[120:123], a[0:3], 0
    v_mfma_f32_16x16x32_bf16 a[160:163], a[124:127], a[4:7], a[160:163]
    s_waitcnt lgkmcnt(10)
    v_mfma_f32_16x16x32_bf16 a[192:195], a[96:99], a[0:3], 0
    ds_read_b64_tr_b16 a[120:121], v28 offset:64
    s_waitcnt lgkmcnt(9)
    v_mfma_f32_16x16x32_bf16 a[192:195], a[100:103], a[4:7], a[192:195]
    v_mfma_f32_16x16x32_bf16 a[196:199], a[96:99], a[8:11], 0
    ds_read_b64_tr_b16 a[122:123], v28 offset:1856
    v_mfma_f32_16x16x32_bf16 a[196:199], a[100:103], a[12:15], a[196:199]
    v_mfma_f32_16x16x32_bf16 a[200:203], a[96:99], a[16:19], 0
    ds_read_b64_tr_b16 a[124:125], v28 offset:10304
    v_mfma_f32_16x16x32_bf16 a[200:203], a[100:103], a[20:23], a[200:203]
    v_mfma_f32_16x16x32_bf16 a[204:207], a[96:99], a[24:27], 0
    ds_read_b64_tr_b16 a[126:127], v28 offset:12096
    v_mfma_f32_16x16x32_bf16 a[204:207], a[100:103], a[28:31], a[204:207]
    v_mfma_f32_16x16x32_bf16 a[208:211], a[96:99], a[64:67], 0
    v_mfma_f32_16x16x32_bf16 a[208:211], a[100:103], a[68:71], a[208:211]
    v_mfma_f32_16x16x32_bf16 a[212:215], a[96:99], a[72:75], 0
    v_mfma_f32_16x16x32_bf16 a[212:215], a[100:103], a[76:79], a[212:215]
    v_mfma_f32_16x16x32_bf16 a[216:219], a[96:99], a[80:83], 0
    v_mfma_f32_16x16x32_bf16 a[216:219], a[100:103], a[84:87], a[216:219]
    v_mfma_f32_16x16x32_bf16 a[220:223], a[96:99], a[88:91], 0
    v_mfma_f32_16x16x32_bf16 a[220:223], a[100:103], a[92:95], a[220:223]
    s_waitcnt lgkmcnt(10)
    v_mfma_f32_16x16x32_bf16 a[252:255], a[104:107], a[88:91], 0
    ds_read_b64_tr_b16 a[96:97], v27 offset:96
    s_waitcnt lgkmcnt(9)
    v_mfma_f32_16x16x32_bf16 a[252:255], a[108:111], a[92:95], a[252:255]
    v_mfma_f32_16x16x32_bf16 a[248:251], a[104:107], a[80:83], 0
    ds_read_b64_tr_b16 a[98:99], v27 offset:1888
    v_mfma_f32_16x16x32_bf16 a[248:251], a[108:111], a[84:87], a[248:251]
    v_mfma_f32_16x16x32_bf16 a[244:247], a[104:107], a[72:75], 0
    ds_read_b64_tr_b16 a[100:101], v27 offset:10336
    v_mfma_f32_16x16x32_bf16 a[244:247], a[108:111], a[76:79], a[244:247]
    v_mfma_f32_16x16x32_bf16 a[240:243], a[104:107], a[64:67], 0
    ds_read_b64_tr_b16 a[102:103], v27 offset:12128
    v_mfma_f32_16x16x32_bf16 a[240:243], a[108:111], a[68:71], a[240:243]
    v_mfma_f32_16x16x32_bf16 a[236:239], a[104:107], a[24:27], 0
    v_mfma_f32_16x16x32_bf16 a[236:239], a[108:111], a[28:31], a[236:239]
    v_mfma_f32_16x16x32_bf16 a[232:235], a[104:107], a[16:19], 0
    v_mfma_f32_16x16x32_bf16 a[232:235], a[108:111], a[20:23], a[232:235]
    v_mfma_f32_16x16x32_bf16 a[228:231], a[104:107], a[8:11], 0
    v_mfma_f32_16x16x32_bf16 a[228:231], a[108:111], a[12:15], a[228:231]
    v_mfma_f32_16x16x32_bf16 a[224:227], a[104:107], a[0:3], 0
    v_mfma_f32_16x16x32_bf16 a[224:227], a[108:111], a[4:7], a[224:227]
    s_waitcnt lgkmcnt(10)
    v_mfma_f32_16x16x32_bf16 v[128:131], a[112:115], a[0:3], 0
    ds_read_b64_tr_b16 a[104:105], v28 offset:96
    s_waitcnt lgkmcnt(9)
    v_mfma_f32_16x16x32_bf16 v[128:131], a[116:119], a[4:7], v[128:131]
    v_mfma_f32_16x16x32_bf16 v[132:135], a[112:115], a[8:11], 0
    ds_read_b64_tr_b16 a[106:107], v28 offset:1888
    v_mfma_f32_16x16x32_bf16 v[132:135], a[116:119], a[12:15], v[132:135]
    v_mfma_f32_16x16x32_bf16 v[136:139], a[112:115], a[16:19], 0
    ds_read_b64_tr_b16 a[108:109], v28 offset:10336
    v_mfma_f32_16x16x32_bf16 v[136:139], a[116:119], a[20:23], v[136:139]
    v_mfma_f32_16x16x32_bf16 v[140:143], a[112:115], a[24:27], 0
    ds_read_b64_tr_b16 a[110:111], v28 offset:12128
    v_mfma_f32_16x16x32_bf16 v[140:143], a[116:119], a[28:31], v[140:143]
    v_mfma_f32_16x16x32_bf16 v[144:147], a[112:115], a[64:67], 0
    v_mfma_f32_16x16x32_bf16 v[144:147], a[116:119], a[68:71], v[144:147]
    v_mfma_f32_16x16x32_bf16 v[148:151], a[112:115], a[72:75], 0
    v_mfma_f32_16x16x32_bf16 v[148:151], a[116:119], a[76:79], v[148:151]
    v_mfma_f32_16x16x32_bf16 v[152:155], a[112:115], a[80:83], 0
    v_mfma_f32_16x16x32_bf16 v[152:155], a[116:119], a[84:87], v[152:155]
    v_mfma_f32_16x16x32_bf16 v[156:159], a[112:115], a[88:91], 0
    v_mfma_f32_16x16x32_bf16 v[156:159], a[116:119], a[92:95], v[156:159]
    s_waitcnt vmcnt(2) lgkmcnt(0)
    s_barrier
    v_mfma_f32_16x16x32_bf16 v[188:191], a[120:123], a[88:91], 0
    ds_read_b64_tr_b16 a[112:113], v25 offset:40960
    s_add_u32 m0, s91, 65536
    v_mfma_f32_16x16x32_bf16 v[188:191], a[124:127], a[92:95], v[188:191]
    buffer_load_dwordx4 v16, s[64:67], s84 offen offset:0 lds
    v_mfma_f32_16x16x32_bf16 v[184:187], a[120:123], a[80:83], 0
    ds_read_b64_tr_b16 a[114:115], v25 offset:41216
    v_mfma_f32_16x16x32_bf16 v[184:187], a[124:127], a[84:87], v[184:187]
    v_mfma_f32_16x16x32_bf16 v[180:183], a[120:123], a[72:75], 0
    ds_read_b64_tr_b16 a[116:117], v25 offset:61440
    v_mfma_f32_16x16x32_bf16 v[180:183], a[124:127], a[76:79], v[180:183]
    v_mfma_f32_16x16x32_bf16 v[176:179], a[120:123], a[64:67], 0
    ds_read_b64_tr_b16 a[118:119], v25 offset:61696
    v_mfma_f32_16x16x32_bf16 v[176:179], a[124:127], a[68:71], v[176:179]
    buffer_load_dwordx4 v17, s[64:67], s84 offen offset:1024 lds
    v_mfma_f32_16x16x32_bf16 v[172:175], a[120:123], a[24:27], 0
    ds_read_b128 a[32:35], v23 offset:32768
    v_mfma_f32_16x16x32_bf16 v[172:175], a[124:127], a[28:31], v[172:175]
    v_mfma_f32_16x16x32_bf16 v[168:171], a[120:123], a[16:19], 0
    ds_read_b128 a[36:39], v24 offset:32768
    v_mfma_f32_16x16x32_bf16 v[168:171], a[124:127], a[20:23], v[168:171]
    v_mfma_f32_16x16x32_bf16 v[164:167], a[120:123], a[8:11], 0
    ds_read_b128 a[40:43], v23 offset:34816
    v_mfma_f32_16x16x32_bf16 v[164:167], a[124:127], a[12:15], v[164:167]
    v_mfma_f32_16x16x32_bf16 v[160:163], a[120:123], a[0:3], 0
    ds_read_b128 a[44:47], v24 offset:34816
    buffer_load_dwordx4 v18, s[64:67], s84 offen offset:2048 lds
    v_mfma_f32_16x16x32_bf16 v[160:163], a[124:127], a[4:7], v[160:163]
    v_mfma_f32_16x16x32_bf16 v[192:195], a[96:99], a[0:3], 0
    ds_read_b64_tr_b16 a[120:121], v26 offset:40960
    v_mfma_f32_16x16x32_bf16 v[192:195], a[100:103], a[4:7], v[192:195]
    v_mfma_f32_16x16x32_bf16 v[196:199], a[96:99], a[8:11], 0
    ds_read_b64_tr_b16 a[122:123], v26 offset:41216
    v_mfma_f32_16x16x32_bf16 v[196:199], a[100:103], a[12:15], v[196:199]
    v_mfma_f32_16x16x32_bf16 v[200:203], a[96:99], a[16:19], 0
    ds_read_b64_tr_b16 a[124:125], v26 offset:61440
    buffer_load_dwordx4 v19, s[64:67], s84 offen offset:3072 lds
    v_mfma_f32_16x16x32_bf16 v[200:203], a[100:103], a[20:23], v[200:203]
    v_mfma_f32_16x16x32_bf16 v[204:207], a[96:99], a[24:27], 0
    ds_read_b64_tr_b16 a[126:127], v26 offset:61696
    v_mfma_f32_16x16x32_bf16 v[204:207], a[100:103], a[28:31], v[204:207]
    v_mfma_f32_16x16x32_bf16 v[208:211], a[96:99], a[64:67], 0
    ds_read_b128 a[48:51], v23 offset:36864
    v_mfma_f32_16x16x32_bf16 v[208:211], a[100:103], a[68:71], v[208:211]
    v_mfma_f32_16x16x32_bf16 v[212:215], a[96:99], a[72:75], 0
    ds_read_b128 a[52:55], v24 offset:36864
    s_add_u32 m0, s91, 69632
    v_mfma_f32_16x16x32_bf16 v[212:215], a[100:103], a[76:79], v[212:215]
    buffer_load_dwordx4 v20, s[64:67], s84 offen offset:0 lds
    v_mfma_f32_16x16x32_bf16 v[216:219], a[96:99], a[80:83], 0
    ds_read_b128 a[56:59], v23 offset:38912
    v_mfma_f32_16x16x32_bf16 v[216:219], a[100:103], a[84:87], v[216:219]
    v_mfma_f32_16x16x32_bf16 v[220:223], a[96:99], a[88:91], 0
    ds_read_b128 a[60:63], v24 offset:38912
    v_mfma_f32_16x16x32_bf16 v[220:223], a[100:103], a[92:95], v[220:223]
    v_mfma_f32_16x16x32_bf16 v[252:255], a[104:107], a[88:91], 0
    ds_read_b64_tr_b16 a[96:97], v27 offset:40960
    v_mfma_f32_16x16x32_bf16 v[252:255], a[108:111], a[92:95], v[252:255]
    buffer_load_dwordx4 v21, s[64:67], s84 offen offset:1024 lds
    v_mfma_f32_16x16x32_bf16 v[248:251], a[104:107], a[80:83], 0
    ds_read_b128 a[88:91], v23 offset:47104
    v_mfma_f32_16x16x32_bf16 v[248:251], a[108:111], a[84:87], v[248:251]
    ds_read_b128 a[92:95], v24 offset:47104
    v_mfma_f32_16x16x32_bf16 v[244:247], a[104:107], a[72:75], 0
    ds_read_b128 a[80:83], v23 offset:45056
    v_mfma_f32_16x16x32_bf16 v[244:247], a[108:111], a[76:79], v[244:247]
    ds_read_b128 a[84:87], v24 offset:45056
    v_mfma_f32_16x16x32_bf16 v[240:243], a[104:107], a[64:67], 0
    v_mfma_f32_16x16x32_bf16 v[240:243], a[108:111], a[68:71], v[240:243]
    ds_read_b128 a[72:75], v23 offset:43008
    v_mfma_f32_16x16x32_bf16 v[236:239], a[104:107], a[24:27], 0
    ds_read_b128 a[76:79], v24 offset:43008
    buffer_load_dwordx4 v22, s[64:67], s84 offen offset:2048 lds
    v_mfma_f32_16x16x32_bf16 v[236:239], a[108:111], a[28:31], v[236:239]
    ds_read_b128 a[64:67], v23 offset:40960
    v_mfma_f32_16x16x32_bf16 v[232:235], a[104:107], a[16:19], 0
    ds_read_b128 a[68:71], v24 offset:40960
    v_mfma_f32_16x16x32_bf16 v[232:235], a[108:111], a[20:23], v[232:235]
    ds_read_b64_tr_b16 a[98:99], v27 offset:42752
    v_mfma_f32_16x16x32_bf16 v[228:231], a[104:107], a[8:11], 0
    v_mfma_f32_16x16x32_bf16 v[228:231], a[108:111], a[12:15], v[228:231]
    ds_read_b64_tr_b16 a[100:101], v27 offset:51200
    v_mfma_f32_16x16x32_bf16 v[224:227], a[104:107], a[0:3], 0
    buffer_load_dwordx4 v14, s[60:63], s83 offen offset:3072 lds
    v_mfma_f32_16x16x32_bf16 v[224:227], a[108:111], a[4:7], v[224:227]
    ds_read_b64_tr_b16 a[102:103], v27 offset:52992
    s_mov_b32 s48, 6
gated_mix__softmax_full_mha__glu_gated_bilinear__prompt_kernel_c1loop:
    s_waitcnt lgkmcnt(15)
    v_mfma_f32_16x16x32_bf16 v[64:67], a[32:35], a[112:115], v[64:67]
    ds_read_b64_tr_b16 a[104:105], v28 offset:40960
    v_mfma_f32_16x16x32_bf16 v[64:67], a[36:39], a[116:119], v[64:67]
    v_mfma_f32_16x16x32_bf16 v[68:71], a[40:43], a[112:115], v[68:71]
    ds_read_b64_tr_b16 a[106:107], v28 offset:42752
    v_mfma_f32_16x16x32_bf16 v[68:71], a[44:47], a[116:119], v[68:71]
    v_mfma_f32_16x16x32_bf16 v[72:75], a[48:51], a[112:115], v[72:75]
    ds_read_b64_tr_b16 a[108:109], v28 offset:51200
    s_waitcnt lgkmcnt(15)
    v_mfma_f32_16x16x32_bf16 v[72:75], a[52:55], a[116:119], v[72:75]
    s_add_u32 m0, s91, 73728
    v_mfma_f32_16x16x32_bf16 v[76:79], a[56:59], a[112:115], v[76:79]
    ds_read_b64_tr_b16 a[110:111], v28 offset:52992
    buffer_load_dwordx4 v15, s[60:63], s83 offen offset:0 lds
    v_mfma_f32_16x16x32_bf16 v[76:79], a[60:63], a[116:119], v[76:79]
    s_waitcnt lgkmcnt(8)
    v_mfma_f32_16x16x32_bf16 v[80:83], a[64:67], a[112:115], v[80:83]
    s_waitcnt lgkmcnt(7)
    v_mfma_f32_16x16x32_bf16 v[80:83], a[68:71], a[116:119], v[80:83]
    v_mfma_f32_16x16x32_bf16 v[84:87], a[72:75], a[112:115], v[84:87]
    v_mfma_f32_16x16x32_bf16 v[84:87], a[76:79], a[116:119], v[84:87]
    v_mfma_f32_16x16x32_bf16 v[88:91], a[80:83], a[112:115], v[88:91]
    v_mfma_f32_16x16x32_bf16 v[88:91], a[84:87], a[116:119], v[88:91]
    v_mfma_f32_16x16x32_bf16 v[92:95], a[88:91], a[112:115], v[92:95]
    buffer_load_dwordx4 v14, s[60:63], s83 offen offset:1024 lds
    v_mfma_f32_16x16x32_bf16 v[92:95], a[92:95], a[116:119], v[92:95]
    v_mfma_f32_16x16x32_bf16 v[124:127], a[88:91], a[120:123], v[124:127]
    ds_read_b64_tr_b16 a[112:113], v27 offset:40992
    v_mfma_f32_16x16x32_bf16 v[124:127], a[92:95], a[124:127], v[124:127]
    v_mfma_f32_16x16x32_bf16 v[120:123], a[80:83], a[120:123], v[120:123]
    ds_read_b64_tr_b16 a[114:115], v27 offset:42784
    v_mfma_f32_16x16x32_bf16 v[120:123], a[84:87], a[124:127], v[120:123]
    v_mfma_f32_16x16x32_bf16 v[116:119], a[72:75], a[120:123], v[116:119]
    ds_read_b64_tr_b16 a[116:117], v27 offset:51232
    v_mfma_f32_16x16x32_bf16 v[116:119], a[76:79], a[124:127], v[116:119]
    s_add_u32 m0, s90, 0
    v_mfma_f32_16x16x32_bf16 v[112:115], a[64:67], a[120:123], v[112:115]
    ds_read_b64_tr_b16 a[118:119], v27 offset:53024
    buffer_load_dwordx4 v6, s[56:59], s82 offen offset:0 lds
    v_mfma_f32_16x16x32_bf16 v[112:115], a[68:71], a[124:127], v[112:115]
    v_mfma_f32_16x16x32_bf16 v[108:111], a[56:59], a[120:123], v[108:111]
    v_mfma_f32_16x16x32_bf16 v[108:111], a[60:63], a[124:127], v[108:111]
    v_mfma_f32_16x16x32_bf16 v[104:107], a[48:51], a[120:123], v[104:107]
    buffer_load_dwordx4 v7, s[56:59], s82 offen offset:1024 lds
    v_mfma_f32_16x16x32_bf16 v[104:107], a[52:55], a[124:127], v[104:107]
    v_mfma_f32_16x16x32_bf16 v[100:103], a[40:43], a[120:123], v[100:103]
    v_mfma_f32_16x16x32_bf16 v[100:103], a[44:47], a[124:127], v[100:103]
    v_mfma_f32_16x16x32_bf16 v[96:99], a[32:35], a[120:123], v[96:99]
    buffer_load_dwordx4 v8, s[56:59], s82 offen offset:2048 lds
    v_mfma_f32_16x16x32_bf16 v[96:99], a[36:39], a[124:127], v[96:99]
    s_waitcnt lgkmcnt(10)
    v_mfma_f32_16x16x32_bf16 a[128:131], a[96:99], a[32:35], a[128:131]
    ds_read_b64_tr_b16 a[120:121], v28 offset:40992
    s_waitcnt lgkmcnt(9)
    v_mfma_f32_16x16x32_bf16 a[128:131], a[100:103], a[36:39], a[128:131]
    v_mfma_f32_16x16x32_bf16 a[132:135], a[96:99], a[40:43], a[132:135]
    ds_read_b64_tr_b16 a[122:123], v28 offset:42784
    buffer_load_dwordx4 v9, s[56:59], s82 offen offset:3072 lds
    v_mfma_f32_16x16x32_bf16 a[132:135], a[100:103], a[44:47], a[132:135]
    v_mfma_f32_16x16x32_bf16 a[136:139], a[96:99], a[48:51], a[136:139]
    ds_read_b64_tr_b16 a[124:125], v28 offset:51232
    v_mfma_f32_16x16x32_bf16 a[136:139], a[100:103], a[52:55], a[136:139]
    s_add_u32 m0, s90, 4096
    v_mfma_f32_16x16x32_bf16 a[140:143], a[96:99], a[56:59], a[140:143]
    ds_read_b64_tr_b16 a[126:127], v28 offset:53024
    buffer_load_dwordx4 v10, s[56:59], s82 offen offset:0 lds
    v_mfma_f32_16x16x32_bf16 a[140:143], a[100:103], a[60:63], a[140:143]
    v_mfma_f32_16x16x32_bf16 a[144:147], a[96:99], a[64:67], a[144:147]
    v_mfma_f32_16x16x32_bf16 a[144:147], a[100:103], a[68:71], a[144:147]
    v_mfma_f32_16x16x32_bf16 a[148:151], a[96:99], a[72:75], a[148:151]
    buffer_load_dwordx4 v11, s[56:59], s82 offen offset:1024 lds
    v_mfma_f32_16x16x32_bf16 a[148:151], a[100:103], a[76:79], a[148:151]
    v_mfma_f32_16x16x32_bf16 a[152:155], a[96:99], a[80:83], a[152:155]
    v_mfma_f32_16x16x32_bf16 a[152:155], a[100:103], a[84:87], a[152:155]
    v_mfma_f32_16x16x32_bf16 a[156:159], a[96:99], a[88:91], a[156:159]
    buffer_load_dwordx4 v12, s[56:59], s82 offen offset:2048 lds
    v_mfma_f32_16x16x32_bf16 a[156:159], a[100:103], a[92:95], a[156:159]
    s_waitcnt lgkmcnt(10)
    v_mfma_f32_16x16x32_bf16 a[188:191], a[104:107], a[88:91], a[188:191]
    ds_read_b64_tr_b16 a[96:97], v27 offset:41024
    s_waitcnt lgkmcnt(9)
    v_mfma_f32_16x16x32_bf16 a[188:191], a[108:111], a[92:95], a[188:191]
    v_mfma_f32_16x16x32_bf16 a[184:187], a[104:107], a[80:83], a[184:187]
    ds_read_b64_tr_b16 a[98:99], v27 offset:42816
    buffer_load_dwordx4 v13, s[56:59], s82 offen offset:3072 lds
    v_mfma_f32_16x16x32_bf16 a[184:187], a[108:111], a[84:87], a[184:187]
    v_mfma_f32_16x16x32_bf16 a[180:183], a[104:107], a[72:75], a[180:183]
    ds_read_b64_tr_b16 a[100:101], v27 offset:51264
    s_add_u32 s83, s83, 393216
    v_mfma_f32_16x16x32_bf16 a[180:183], a[108:111], a[76:79], a[180:183]
    s_add_u32 s84, s84, 458752
    v_mfma_f32_16x16x32_bf16 a[176:179], a[104:107], a[64:67], a[176:179]
    ds_read_b64_tr_b16 a[102:103], v27 offset:53056
    s_add_u32 s82, s82, 128
    v_mfma_f32_16x16x32_bf16 a[176:179], a[108:111], a[68:71], a[176:179]
    buffer_load_dword v2, v33, s[68:71], s85 offen
    v_mfma_f32_16x16x32_bf16 a[172:175], a[104:107], a[56:59], a[172:175]
    s_add_u32 s85, s85, s86
    v_mfma_f32_16x16x32_bf16 a[172:175], a[108:111], a[60:63], a[172:175]
    buffer_load_dword v2, v32, s[72:75], s81 offen
    v_mfma_f32_16x16x32_bf16 a[168:171], a[104:107], a[48:51], a[168:171]
    s_add_u32 s81, s81, 786432
    v_mfma_f32_16x16x32_bf16 a[168:171], a[108:111], a[52:55], a[168:171]
    v_mfma_f32_16x16x32_bf16 a[164:167], a[104:107], a[40:43], a[164:167]
    v_mfma_f32_16x16x32_bf16 a[164:167], a[108:111], a[44:47], a[164:167]
    v_mfma_f32_16x16x32_bf16 a[160:163], a[104:107], a[32:35], a[160:163]
    v_mfma_f32_16x16x32_bf16 a[160:163], a[108:111], a[36:39], a[160:163]
    s_waitcnt lgkmcnt(10)
    v_mfma_f32_16x16x32_bf16 a[192:195], a[112:115], a[32:35], a[192:195]
    ds_read_b64_tr_b16 a[104:105], v28 offset:41024
    s_waitcnt lgkmcnt(9)
    v_mfma_f32_16x16x32_bf16 a[192:195], a[116:119], a[36:39], a[192:195]
    v_mfma_f32_16x16x32_bf16 a[196:199], a[112:115], a[40:43], a[196:199]
    ds_read_b64_tr_b16 a[106:107], v28 offset:42816
    v_mfma_f32_16x16x32_bf16 a[196:199], a[116:119], a[44:47], a[196:199]
    v_mfma_f32_16x16x32_bf16 a[200:203], a[112:115], a[48:51], a[200:203]
    ds_read_b64_tr_b16 a[108:109], v28 offset:51264
    v_mfma_f32_16x16x32_bf16 a[200:203], a[116:119], a[52:55], a[200:203]
    v_mfma_f32_16x16x32_bf16 a[204:207], a[112:115], a[56:59], a[204:207]
    ds_read_b64_tr_b16 a[110:111], v28 offset:53056
    v_mfma_f32_16x16x32_bf16 a[204:207], a[116:119], a[60:63], a[204:207]
    v_mfma_f32_16x16x32_bf16 a[208:211], a[112:115], a[64:67], a[208:211]
    v_mfma_f32_16x16x32_bf16 a[208:211], a[116:119], a[68:71], a[208:211]
    v_mfma_f32_16x16x32_bf16 a[212:215], a[112:115], a[72:75], a[212:215]
    v_mfma_f32_16x16x32_bf16 a[212:215], a[116:119], a[76:79], a[212:215]
    v_mfma_f32_16x16x32_bf16 a[216:219], a[112:115], a[80:83], a[216:219]
    v_mfma_f32_16x16x32_bf16 a[216:219], a[116:119], a[84:87], a[216:219]
    v_mfma_f32_16x16x32_bf16 a[220:223], a[112:115], a[88:91], a[220:223]
    v_mfma_f32_16x16x32_bf16 a[220:223], a[116:119], a[92:95], a[220:223]
    s_waitcnt lgkmcnt(10)
    v_mfma_f32_16x16x32_bf16 a[252:255], a[120:123], a[88:91], a[252:255]
    ds_read_b64_tr_b16 a[112:113], v27 offset:41056
    s_waitcnt lgkmcnt(9)
    v_mfma_f32_16x16x32_bf16 a[252:255], a[124:127], a[92:95], a[252:255]
    v_mfma_f32_16x16x32_bf16 a[248:251], a[120:123], a[80:83], a[248:251]
    ds_read_b64_tr_b16 a[114:115], v27 offset:42848
    v_mfma_f32_16x16x32_bf16 a[248:251], a[124:127], a[84:87], a[248:251]
    v_mfma_f32_16x16x32_bf16 a[244:247], a[120:123], a[72:75], a[244:247]
    ds_read_b64_tr_b16 a[116:117], v27 offset:51296
    v_mfma_f32_16x16x32_bf16 a[244:247], a[124:127], a[76:79], a[244:247]
    v_mfma_f32_16x16x32_bf16 a[240:243], a[120:123], a[64:67], a[240:243]
    ds_read_b64_tr_b16 a[118:119], v27 offset:53088
    v_mfma_f32_16x16x32_bf16 a[240:243], a[124:127], a[68:71], a[240:243]
    v_mfma_f32_16x16x32_bf16 a[236:239], a[120:123], a[56:59], a[236:239]
    v_mfma_f32_16x16x32_bf16 a[236:239], a[124:127], a[60:63], a[236:239]
    v_mfma_f32_16x16x32_bf16 a[232:235], a[120:123], a[48:51], a[232:235]
    v_mfma_f32_16x16x32_bf16 a[232:235], a[124:127], a[52:55], a[232:235]
    v_mfma_f32_16x16x32_bf16 a[228:231], a[120:123], a[40:43], a[228:231]
    v_mfma_f32_16x16x32_bf16 a[228:231], a[124:127], a[44:47], a[228:231]
    v_mfma_f32_16x16x32_bf16 a[224:227], a[120:123], a[32:35], a[224:227]
    v_mfma_f32_16x16x32_bf16 a[224:227], a[124:127], a[36:39], a[224:227]
    s_waitcnt lgkmcnt(10)
    v_mfma_f32_16x16x32_bf16 v[128:131], a[96:99], a[32:35], v[128:131]
    ds_read_b64_tr_b16 a[120:121], v28 offset:41056
    s_waitcnt lgkmcnt(9)
    v_mfma_f32_16x16x32_bf16 v[128:131], a[100:103], a[36:39], v[128:131]
    v_mfma_f32_16x16x32_bf16 v[132:135], a[96:99], a[40:43], v[132:135]
    ds_read_b64_tr_b16 a[122:123], v28 offset:42848
    v_mfma_f32_16x16x32_bf16 v[132:135], a[100:103], a[44:47], v[132:135]
    v_mfma_f32_16x16x32_bf16 v[136:139], a[96:99], a[48:51], v[136:139]
    ds_read_b64_tr_b16 a[124:125], v28 offset:51296
    v_mfma_f32_16x16x32_bf16 v[136:139], a[100:103], a[52:55], v[136:139]
    v_mfma_f32_16x16x32_bf16 v[140:143], a[96:99], a[56:59], v[140:143]
    ds_read_b64_tr_b16 a[126:127], v28 offset:53088
    v_mfma_f32_16x16x32_bf16 v[140:143], a[100:103], a[60:63], v[140:143]
    v_mfma_f32_16x16x32_bf16 v[144:147], a[96:99], a[64:67], v[144:147]
    v_mfma_f32_16x16x32_bf16 v[144:147], a[100:103], a[68:71], v[144:147]
    v_mfma_f32_16x16x32_bf16 v[148:151], a[96:99], a[72:75], v[148:151]
    v_mfma_f32_16x16x32_bf16 v[148:151], a[100:103], a[76:79], v[148:151]
    v_mfma_f32_16x16x32_bf16 v[152:155], a[96:99], a[80:83], v[152:155]
    v_mfma_f32_16x16x32_bf16 v[152:155], a[100:103], a[84:87], v[152:155]
    v_mfma_f32_16x16x32_bf16 v[156:159], a[96:99], a[88:91], v[156:159]
    v_mfma_f32_16x16x32_bf16 v[156:159], a[100:103], a[92:95], v[156:159]
    s_waitcnt vmcnt(2) lgkmcnt(0)
    s_barrier
    v_mfma_f32_16x16x32_bf16 v[188:191], a[104:107], a[88:91], v[188:191]
    ds_read_b64_tr_b16 a[96:97], v25 offset:0
    s_add_u32 m0, s91, 106496
    v_mfma_f32_16x16x32_bf16 v[188:191], a[108:111], a[92:95], v[188:191]
    buffer_load_dwordx4 v16, s[64:67], s84 offen offset:0 lds
    v_mfma_f32_16x16x32_bf16 v[184:187], a[104:107], a[80:83], v[184:187]
    ds_read_b64_tr_b16 a[98:99], v25 offset:256
    v_mfma_f32_16x16x32_bf16 v[184:187], a[108:111], a[84:87], v[184:187]
    v_mfma_f32_16x16x32_bf16 v[180:183], a[104:107], a[72:75], v[180:183]
    ds_read_b64_tr_b16 a[100:101], v25 offset:20480
    v_mfma_f32_16x16x32_bf16 v[180:183], a[108:111], a[76:79], v[180:183]
    v_mfma_f32_16x16x32_bf16 v[176:179], a[104:107], a[64:67], v[176:179]
    ds_read_b64_tr_b16 a[102:103], v25 offset:20736
    v_mfma_f32_16x16x32_bf16 v[176:179], a[108:111], a[68:71], v[176:179]
    buffer_load_dwordx4 v17, s[64:67], s84 offen offset:1024 lds
    v_mfma_f32_16x16x32_bf16 v[172:175], a[104:107], a[56:59], v[172:175]
    ds_read_b128 a[0:3], v23 offset:0
    v_mfma_f32_16x16x32_bf16 v[172:175], a[108:111], a[60:63], v[172:175]
    v_mfma_f32_16x16x32_bf16 v[168:171], a[104:107], a[48:51], v[168:171]
    ds_read_b128 a[4:7], v24 offset:0
    v_mfma_f32_16x16x32_bf16 v[168:171], a[108:111], a[52:55], v[168:171]
    v_mfma_f32_16x16x32_bf16 v[164:167], a[104:107], a[40:43], v[164:167]
    ds_read_b128 a[8:11], v23 offset:2048
    v_mfma_f32_16x16x32_bf16 v[164:167], a[108:111], a[44:47], v[164:167]
    v_mfma_f32_16x16x32_bf16 v[160:163], a[104:107], a[32:35], v[160:163]
    ds_read_b128 a[12:15], v24 offset:2048
    buffer_load_dwordx4 v18, s[64:67], s84 offen offset:2048 lds
    v_mfma_f32_16x16x32_bf16 v[160:163], a[108:111], a[36:39], v[160:163]
    v_mfma_f32_16x16x32_bf16 v[192:195], a[112:115], a[32:35], v[192:195]
    ds_read_b64_tr_b16 a[104:105], v26 offset:0
    v_mfma_f32_16x16x32_bf16 v[192:195], a[116:119], a[36:39], v[192:195]
    v_mfma_f32_16x16x32_bf16 v[196:199], a[112:115], a[40:43], v[196:199]
    ds_read_b64_tr_b16 a[106:107], v26 offset:256
    v_mfma_f32_16x16x32_bf16 v[196:199], a[116:119], a[44:47], v[196:199]
    v_mfma_f32_16x16x32_bf16 v[200:203], a[112:115], a[48:51], v[200:203]
    ds_read_b64_tr_b16 a[108:109], v26 offset:20480
    buffer_load_dwordx4 v19, s[64:67], s84 offen offset:3072 lds
    v_mfma_f32_16x16x32_bf16 v[200:203], a[116:119], a[52:55], v[200:203]
    v_mfma_f32_16x16x32_bf16 v[204:207], a[112:115], a[56:59], v[204:207]
    ds_read_b64_tr_b16 a[110:111], v26 offset:20736
    v_mfma_f32_16x16x32_bf16 v[204:207], a[116:119], a[60:63], v[204:207]
    v_mfma_f32_16x16x32_bf16 v[208:211], a[112:115], a[64:67], v[208:211]
    ds_read_b128 a[16:19], v23 offset:4096
    v_mfma_f32_16x16x32_bf16 v[208:211], a[116:119], a[68:71], v[208:211]
    v_mfma_f32_16x16x32_bf16 v[212:215], a[112:115], a[72:75], v[212:215]
    ds_read_b128 a[20:23], v24 offset:4096
    s_add_u32 m0, s91, 110592
    v_mfma_f32_16x16x32_bf16 v[212:215], a[116:119], a[76:79], v[212:215]
    buffer_load_dwordx4 v20, s[64:67], s84 offen offset:0 lds
    v_mfma_f32_16x16x32_bf16 v[216:219], a[112:115], a[80:83], v[216:219]
    ds_read_b128 a[24:27], v23 offset:6144
    v_mfma_f32_16x16x32_bf16 v[216:219], a[116:119], a[84:87], v[216:219]
    v_mfma_f32_16x16x32_bf16 v[220:223], a[112:115], a[88:91], v[220:223]
    ds_read_b128 a[28:31], v24 offset:6144
    v_mfma_f32_16x16x32_bf16 v[220:223], a[116:119], a[92:95], v[220:223]
    v_mfma_f32_16x16x32_bf16 v[252:255], a[120:123], a[88:91], v[252:255]
    ds_read_b64_tr_b16 a[112:113], v27 offset:0
    v_mfma_f32_16x16x32_bf16 v[252:255], a[124:127], a[92:95], v[252:255]
    buffer_load_dwordx4 v21, s[64:67], s84 offen offset:1024 lds
    v_mfma_f32_16x16x32_bf16 v[248:251], a[120:123], a[80:83], v[248:251]
    ds_read_b128 a[88:91], v23 offset:14336
    v_mfma_f32_16x16x32_bf16 v[248:251], a[124:127], a[84:87], v[248:251]
    ds_read_b128 a[92:95], v24 offset:14336
    v_mfma_f32_16x16x32_bf16 v[244:247], a[120:123], a[72:75], v[244:247]
    ds_read_b128 a[80:83], v23 offset:12288
    v_mfma_f32_16x16x32_bf16 v[244:247], a[124:127], a[76:79], v[244:247]
    ds_read_b128 a[84:87], v24 offset:12288
    v_mfma_f32_16x16x32_bf16 v[240:243], a[120:123], a[64:67], v[240:243]
    v_mfma_f32_16x16x32_bf16 v[240:243], a[124:127], a[68:71], v[240:243]
    ds_read_b128 a[72:75], v23 offset:10240
    v_mfma_f32_16x16x32_bf16 v[236:239], a[120:123], a[56:59], v[236:239]
    ds_read_b128 a[76:79], v24 offset:10240
    buffer_load_dwordx4 v22, s[64:67], s84 offen offset:2048 lds
    v_mfma_f32_16x16x32_bf16 v[236:239], a[124:127], a[60:63], v[236:239]
    ds_read_b128 a[64:67], v23 offset:8192
    v_mfma_f32_16x16x32_bf16 v[232:235], a[120:123], a[48:51], v[232:235]
    ds_read_b128 a[68:71], v24 offset:8192
    v_mfma_f32_16x16x32_bf16 v[232:235], a[124:127], a[52:55], v[232:235]
    ds_read_b64_tr_b16 a[114:115], v27 offset:1792
    v_mfma_f32_16x16x32_bf16 v[228:231], a[120:123], a[40:43], v[228:231]
    v_mfma_f32_16x16x32_bf16 v[228:231], a[124:127], a[44:47], v[228:231]
    ds_read_b64_tr_b16 a[116:117], v27 offset:10240
    v_mfma_f32_16x16x32_bf16 v[224:227], a[120:123], a[32:35], v[224:227]
    buffer_load_dwordx4 v14, s[60:63], s83 offen offset:3072 lds
    v_mfma_f32_16x16x32_bf16 v[224:227], a[124:127], a[36:39], v[224:227]
    ds_read_b64_tr_b16 a[118:119], v27 offset:12032
    s_waitcnt lgkmcnt(15)
    v_mfma_f32_16x16x32_bf16 v[64:67], a[0:3], a[96:99], v[64:67]
    ds_read_b64_tr_b16 a[120:121], v28 offset:0
    v_mfma_f32_16x16x32_bf16 v[64:67], a[4:7], a[100:103], v[64:67]
    v_mfma_f32_16x16x32_bf16 v[68:71], a[8:11], a[96:99], v[68:71]
    ds_read_b64_tr_b16 a[122:123], v28 offset:1792
    v_mfma_f32_16x16x32_bf16 v[68:71], a[12:15], a[100:103], v[68:71]
    v_mfma_f32_16x16x32_bf16 v[72:75], a[16:19], a[96:99], v[72:75]
    ds_read_b64_tr_b16 a[124:125], v28 offset:10240
    s_waitcnt lgkmcnt(15)
    v_mfma_f32_16x16x32_bf16 v[72:75], a[20:23], a[100:103], v[72:75]
    s_add_u32 m0, s91, 114688
    v_mfma_f32_16x16x32_bf16 v[76:79], a[24:27], a[96:99], v[76:79]
    ds_read_b64_tr_b16 a[126:127], v28 offset:12032
    buffer_load_dwordx4 v15, s[60:63], s83 offen offset:0 lds
    v_mfma_f32_16x16x32_bf16 v[76:79], a[28:31], a[100:103], v[76:79]
    s_waitcnt lgkmcnt(8)
    v_mfma_f32_16x16x32_bf16 v[80:83], a[64:67], a[96:99], v[80:83]
    s_waitcnt lgkmcnt(7)
    v_mfma_f32_16x16x32_bf16 v[80:83], a[68:71], a[100:103], v[80:83]
    v_mfma_f32_16x16x32_bf16 v[84:87], a[72:75], a[96:99], v[84:87]
    v_mfma_f32_16x16x32_bf16 v[84:87], a[76:79], a[100:103], v[84:87]
    v_mfma_f32_16x16x32_bf16 v[88:91], a[80:83], a[96:99], v[88:91]
    v_mfma_f32_16x16x32_bf16 v[88:91], a[84:87], a[100:103], v[88:91]
    v_mfma_f32_16x16x32_bf16 v[92:95], a[88:91], a[96:99], v[92:95]
    buffer_load_dwordx4 v14, s[60:63], s83 offen offset:1024 lds
    v_mfma_f32_16x16x32_bf16 v[92:95], a[92:95], a[100:103], v[92:95]
    v_mfma_f32_16x16x32_bf16 v[124:127], a[88:91], a[104:107], v[124:127]
    ds_read_b64_tr_b16 a[96:97], v27 offset:32
    v_mfma_f32_16x16x32_bf16 v[124:127], a[92:95], a[108:111], v[124:127]
    v_mfma_f32_16x16x32_bf16 v[120:123], a[80:83], a[104:107], v[120:123]
    ds_read_b64_tr_b16 a[98:99], v27 offset:1824
    v_mfma_f32_16x16x32_bf16 v[120:123], a[84:87], a[108:111], v[120:123]
    v_mfma_f32_16x16x32_bf16 v[116:119], a[72:75], a[104:107], v[116:119]
    ds_read_b64_tr_b16 a[100:101], v27 offset:10272
    v_mfma_f32_16x16x32_bf16 v[116:119], a[76:79], a[108:111], v[116:119]
    s_add_u32 m0, s90, 32768
    v_mfma_f32_16x16x32_bf16 v[112:115], a[64:67], a[104:107], v[112:115]
    ds_read_b64_tr_b16 a[102:103], v27 offset:12064
    buffer_load_dwordx4 v6, s[56:59], s82 offen offset:0 lds
    v_mfma_f32_16x16x32_bf16 v[112:115], a[68:71], a[108:111], v[112:115]
    v_mfma_f32_16x16x32_bf16 v[108:111], a[24:27], a[104:107], v[108:111]
    v_mfma_f32_16x16x32_bf16 v[108:111], a[28:31], a[108:111], v[108:111]
    v_mfma_f32_16x16x32_bf16 v[104:107], a[16:19], a[104:107], v[104:107]
    buffer_load_dwordx4 v7, s[56:59], s82 offen offset:1024 lds
    v_mfma_f32_16x16x32_bf16 v[104:107], a[20:23], a[108:111], v[104:107]
    v_mfma_f32_16x16x32_bf16 v[100:103], a[8:11], a[104:107], v[100:103]
    v_mfma_f32_16x16x32_bf16 v[100:103], a[12:15], a[108:111], v[100:103]
    v_mfma_f32_16x16x32_bf16 v[96:99], a[0:3], a[104:107], v[96:99]
    buffer_load_dwordx4 v8, s[56:59], s82 offen offset:2048 lds
    v_mfma_f32_16x16x32_bf16 v[96:99], a[4:7], a[108:111], v[96:99]
    s_waitcnt lgkmcnt(10)
    v_mfma_f32_16x16x32_bf16 a[128:131], a[112:115], a[0:3], a[128:131]
    ds_read_b64_tr_b16 a[104:105], v28 offset:32
    s_waitcnt lgkmcnt(9)
    v_mfma_f32_16x16x32_bf16 a[128:131], a[116:119], a[4:7], a[128:131]
    v_mfma_f32_16x16x32_bf16 a[132:135], a[112:115], a[8:11], a[132:135]
    ds_read_b64_tr_b16 a[106:107], v28 offset:1824
    buffer_load_dwordx4 v9, s[56:59], s82 offen offset:3072 lds
    v_mfma_f32_16x16x32_bf16 a[132:135], a[116:119], a[12:15], a[132:135]
    v_mfma_f32_16x16x32_bf16 a[136:139], a[112:115], a[16:19], a[136:139]
    ds_read_b64_tr_b16 a[108:109], v28 offset:10272
    v_mfma_f32_16x16x32_bf16 a[136:139], a[116:119], a[20:23], a[136:139]
    s_add_u32 m0, s90, 36864
    v_mfma_f32_16x16x32_bf16 a[140:143], a[112:115], a[24:27], a[140:143]
    ds_read_b64_tr_b16 a[110:111], v28 offset:12064
    buffer_load_dwordx4 v10, s[56:59], s82 offen offset:0 lds
    v_mfma_f32_16x16x32_bf16 a[140:143], a[116:119], a[28:31], a[140:143]
    v_mfma_f32_16x16x32_bf16 a[144:147], a[112:115], a[64:67], a[144:147]
    v_mfma_f32_16x16x32_bf16 a[144:147], a[116:119], a[68:71], a[144:147]
    v_mfma_f32_16x16x32_bf16 a[148:151], a[112:115], a[72:75], a[148:151]
    buffer_load_dwordx4 v11, s[56:59], s82 offen offset:1024 lds
    v_mfma_f32_16x16x32_bf16 a[148:151], a[116:119], a[76:79], a[148:151]
    v_mfma_f32_16x16x32_bf16 a[152:155], a[112:115], a[80:83], a[152:155]
    v_mfma_f32_16x16x32_bf16 a[152:155], a[116:119], a[84:87], a[152:155]
    v_mfma_f32_16x16x32_bf16 a[156:159], a[112:115], a[88:91], a[156:159]
    buffer_load_dwordx4 v12, s[56:59], s82 offen offset:2048 lds
    v_mfma_f32_16x16x32_bf16 a[156:159], a[116:119], a[92:95], a[156:159]
    s_waitcnt lgkmcnt(10)
    v_mfma_f32_16x16x32_bf16 a[188:191], a[120:123], a[88:91], a[188:191]
    ds_read_b64_tr_b16 a[112:113], v27 offset:64
    s_waitcnt lgkmcnt(9)
    v_mfma_f32_16x16x32_bf16 a[188:191], a[124:127], a[92:95], a[188:191]
    v_mfma_f32_16x16x32_bf16 a[184:187], a[120:123], a[80:83], a[184:187]
    ds_read_b64_tr_b16 a[114:115], v27 offset:1856
    buffer_load_dwordx4 v13, s[56:59], s82 offen offset:3072 lds
    v_mfma_f32_16x16x32_bf16 a[184:187], a[124:127], a[84:87], a[184:187]
    v_mfma_f32_16x16x32_bf16 a[180:183], a[120:123], a[72:75], a[180:183]
    ds_read_b64_tr_b16 a[116:117], v27 offset:10304
    s_add_u32 s83, s83, 393216
    v_mfma_f32_16x16x32_bf16 a[180:183], a[124:127], a[76:79], a[180:183]
    s_add_u32 s84, s84, 458752
    v_mfma_f32_16x16x32_bf16 a[176:179], a[120:123], a[64:67], a[176:179]
    ds_read_b64_tr_b16 a[118:119], v27 offset:12096
    s_add_u32 s82, s82, 128
    v_mfma_f32_16x16x32_bf16 a[176:179], a[124:127], a[68:71], a[176:179]
    buffer_load_dword v2, v33, s[68:71], s85 offen
    v_mfma_f32_16x16x32_bf16 a[172:175], a[120:123], a[24:27], a[172:175]
    s_add_u32 s85, s85, s86
    v_mfma_f32_16x16x32_bf16 a[172:175], a[124:127], a[28:31], a[172:175]
    buffer_load_dword v2, v32, s[72:75], s81 offen
    v_mfma_f32_16x16x32_bf16 a[168:171], a[120:123], a[16:19], a[168:171]
    s_add_u32 s81, s81, 786432
    v_mfma_f32_16x16x32_bf16 a[168:171], a[124:127], a[20:23], a[168:171]
    v_mfma_f32_16x16x32_bf16 a[164:167], a[120:123], a[8:11], a[164:167]
    v_mfma_f32_16x16x32_bf16 a[164:167], a[124:127], a[12:15], a[164:167]
    s_cmp_eq_u32 s48, s88
    v_mfma_f32_16x16x32_bf16 a[160:163], a[120:123], a[0:3], a[160:163]
    v_mfma_f32_16x16x32_bf16 a[160:163], a[124:127], a[4:7], a[160:163]
    s_cselect_b32 s45, s89, 2.0
    s_waitcnt lgkmcnt(10)
    v_mfma_f32_16x16x32_bf16 a[192:195], a[96:99], a[0:3], a[192:195]
    ds_read_b64_tr_b16 a[120:121], v28 offset:64
    s_waitcnt lgkmcnt(9)
    v_mfma_f32_16x16x32_bf16 a[192:195], a[100:103], a[4:7], a[192:195]
    buffer_atomic_add v31, v30, s[36:39], s45 offen offset:64 sc1
    v_mfma_f32_16x16x32_bf16 a[196:199], a[96:99], a[8:11], a[196:199]
    ds_read_b64_tr_b16 a[122:123], v28 offset:1856
    v_mfma_f32_16x16x32_bf16 a[196:199], a[100:103], a[12:15], a[196:199]
    v_mfma_f32_16x16x32_bf16 a[200:203], a[96:99], a[16:19], a[200:203]
    ds_read_b64_tr_b16 a[124:125], v28 offset:10304
    s_cmp_eq_u32 s48, 2
    v_mfma_f32_16x16x32_bf16 a[200:203], a[100:103], a[20:23], a[200:203]
    v_mfma_f32_16x16x32_bf16 a[204:207], a[96:99], a[24:27], a[204:207]
    ds_read_b64_tr_b16 a[126:127], v28 offset:12096
    s_cselect_b32 s45, 0, 2.0
    v_mfma_f32_16x16x32_bf16 a[204:207], a[100:103], a[28:31], a[204:207]
    v_mfma_f32_16x16x32_bf16 a[208:211], a[96:99], a[64:67], a[208:211]
    buffer_load_dword v2, v35, s[76:79], s45 offen
    v_mfma_f32_16x16x32_bf16 a[208:211], a[100:103], a[68:71], a[208:211]
    v_mfma_f32_16x16x32_bf16 a[212:215], a[96:99], a[72:75], a[212:215]
    v_mfma_f32_16x16x32_bf16 a[212:215], a[100:103], a[76:79], a[212:215]
    global_load_dword v2, v[60:61], off
    v_mfma_f32_16x16x32_bf16 a[216:219], a[96:99], a[80:83], a[216:219]
    v_mfma_f32_16x16x32_bf16 a[216:219], a[100:103], a[84:87], a[216:219]
    v_mfma_f32_16x16x32_bf16 a[220:223], a[96:99], a[88:91], a[220:223]
    v_mfma_f32_16x16x32_bf16 a[220:223], a[100:103], a[92:95], a[220:223]
    s_waitcnt lgkmcnt(10)
    v_mfma_f32_16x16x32_bf16 a[252:255], a[104:107], a[88:91], a[252:255]
    ds_read_b64_tr_b16 a[96:97], v27 offset:96
    s_waitcnt lgkmcnt(9)
    v_mfma_f32_16x16x32_bf16 a[252:255], a[108:111], a[92:95], a[252:255]
    v_mfma_f32_16x16x32_bf16 a[248:251], a[104:107], a[80:83], a[248:251]
    ds_read_b64_tr_b16 a[98:99], v27 offset:1888
    v_mfma_f32_16x16x32_bf16 a[248:251], a[108:111], a[84:87], a[248:251]
    v_mfma_f32_16x16x32_bf16 a[244:247], a[104:107], a[72:75], a[244:247]
    ds_read_b64_tr_b16 a[100:101], v27 offset:10336
    v_mfma_f32_16x16x32_bf16 a[244:247], a[108:111], a[76:79], a[244:247]
    v_mfma_f32_16x16x32_bf16 a[240:243], a[104:107], a[64:67], a[240:243]
    ds_read_b64_tr_b16 a[102:103], v27 offset:12128
    v_mfma_f32_16x16x32_bf16 a[240:243], a[108:111], a[68:71], a[240:243]
    v_mfma_f32_16x16x32_bf16 a[236:239], a[104:107], a[24:27], a[236:239]
    v_mfma_f32_16x16x32_bf16 a[236:239], a[108:111], a[28:31], a[236:239]
    v_mfma_f32_16x16x32_bf16 a[232:235], a[104:107], a[16:19], a[232:235]
    v_mfma_f32_16x16x32_bf16 a[232:235], a[108:111], a[20:23], a[232:235]
    v_mfma_f32_16x16x32_bf16 a[228:231], a[104:107], a[8:11], a[228:231]
    v_mfma_f32_16x16x32_bf16 a[228:231], a[108:111], a[12:15], a[228:231]
    v_mfma_f32_16x16x32_bf16 a[224:227], a[104:107], a[0:3], a[224:227]
    v_mfma_f32_16x16x32_bf16 a[224:227], a[108:111], a[4:7], a[224:227]
    s_waitcnt lgkmcnt(10)
    v_mfma_f32_16x16x32_bf16 v[128:131], a[112:115], a[0:3], v[128:131]
    ds_read_b64_tr_b16 a[104:105], v28 offset:96
    s_waitcnt lgkmcnt(9)
    v_mfma_f32_16x16x32_bf16 v[128:131], a[116:119], a[4:7], v[128:131]
    v_mfma_f32_16x16x32_bf16 v[132:135], a[112:115], a[8:11], v[132:135]
    ds_read_b64_tr_b16 a[106:107], v28 offset:1888
    v_mfma_f32_16x16x32_bf16 v[132:135], a[116:119], a[12:15], v[132:135]
    v_mfma_f32_16x16x32_bf16 v[136:139], a[112:115], a[16:19], v[136:139]
    ds_read_b64_tr_b16 a[108:109], v28 offset:10336
    v_mfma_f32_16x16x32_bf16 v[136:139], a[116:119], a[20:23], v[136:139]
    v_mfma_f32_16x16x32_bf16 v[140:143], a[112:115], a[24:27], v[140:143]
    ds_read_b64_tr_b16 a[110:111], v28 offset:12128
    v_mfma_f32_16x16x32_bf16 v[140:143], a[116:119], a[28:31], v[140:143]
    v_mfma_f32_16x16x32_bf16 v[144:147], a[112:115], a[64:67], v[144:147]
    v_mfma_f32_16x16x32_bf16 v[144:147], a[116:119], a[68:71], v[144:147]
    v_mfma_f32_16x16x32_bf16 v[148:151], a[112:115], a[72:75], v[148:151]
    v_mfma_f32_16x16x32_bf16 v[148:151], a[116:119], a[76:79], v[148:151]
    v_mfma_f32_16x16x32_bf16 v[152:155], a[112:115], a[80:83], v[152:155]
    v_mfma_f32_16x16x32_bf16 v[152:155], a[116:119], a[84:87], v[152:155]
    v_mfma_f32_16x16x32_bf16 v[156:159], a[112:115], a[88:91], v[156:159]
    v_mfma_f32_16x16x32_bf16 v[156:159], a[116:119], a[92:95], v[156:159]
    s_waitcnt vmcnt(5) lgkmcnt(0)
    s_barrier
    v_mfma_f32_16x16x32_bf16 v[188:191], a[120:123], a[88:91], v[188:191]
    ds_read_b64_tr_b16 a[112:113], v25 offset:40960
    s_add_u32 m0, s91, 65536
    v_mfma_f32_16x16x32_bf16 v[188:191], a[124:127], a[92:95], v[188:191]
    buffer_load_dwordx4 v16, s[64:67], s84 offen offset:0 lds
    v_mfma_f32_16x16x32_bf16 v[184:187], a[120:123], a[80:83], v[184:187]
    ds_read_b64_tr_b16 a[114:115], v25 offset:41216
    v_mfma_f32_16x16x32_bf16 v[184:187], a[124:127], a[84:87], v[184:187]
    v_mfma_f32_16x16x32_bf16 v[180:183], a[120:123], a[72:75], v[180:183]
    ds_read_b64_tr_b16 a[116:117], v25 offset:61440
    v_mfma_f32_16x16x32_bf16 v[180:183], a[124:127], a[76:79], v[180:183]
    v_mfma_f32_16x16x32_bf16 v[176:179], a[120:123], a[64:67], v[176:179]
    ds_read_b64_tr_b16 a[118:119], v25 offset:61696
    v_mfma_f32_16x16x32_bf16 v[176:179], a[124:127], a[68:71], v[176:179]
    buffer_load_dwordx4 v17, s[64:67], s84 offen offset:1024 lds
    v_mfma_f32_16x16x32_bf16 v[172:175], a[120:123], a[24:27], v[172:175]
    ds_read_b128 a[32:35], v23 offset:32768
    v_mfma_f32_16x16x32_bf16 v[172:175], a[124:127], a[28:31], v[172:175]
    v_mfma_f32_16x16x32_bf16 v[168:171], a[120:123], a[16:19], v[168:171]
    ds_read_b128 a[36:39], v24 offset:32768
    v_mfma_f32_16x16x32_bf16 v[168:171], a[124:127], a[20:23], v[168:171]
    v_mfma_f32_16x16x32_bf16 v[164:167], a[120:123], a[8:11], v[164:167]
    ds_read_b128 a[40:43], v23 offset:34816
    v_mfma_f32_16x16x32_bf16 v[164:167], a[124:127], a[12:15], v[164:167]
    v_mfma_f32_16x16x32_bf16 v[160:163], a[120:123], a[0:3], v[160:163]
    ds_read_b128 a[44:47], v24 offset:34816
    buffer_load_dwordx4 v18, s[64:67], s84 offen offset:2048 lds
    v_mfma_f32_16x16x32_bf16 v[160:163], a[124:127], a[4:7], v[160:163]
    v_mfma_f32_16x16x32_bf16 v[192:195], a[96:99], a[0:3], v[192:195]
    ds_read_b64_tr_b16 a[120:121], v26 offset:40960
    v_mfma_f32_16x16x32_bf16 v[192:195], a[100:103], a[4:7], v[192:195]
    v_mfma_f32_16x16x32_bf16 v[196:199], a[96:99], a[8:11], v[196:199]
    ds_read_b64_tr_b16 a[122:123], v26 offset:41216
    v_mfma_f32_16x16x32_bf16 v[196:199], a[100:103], a[12:15], v[196:199]
    v_mfma_f32_16x16x32_bf16 v[200:203], a[96:99], a[16:19], v[200:203]
    ds_read_b64_tr_b16 a[124:125], v26 offset:61440
    buffer_load_dwordx4 v19, s[64:67], s84 offen offset:3072 lds
    v_mfma_f32_16x16x32_bf16 v[200:203], a[100:103], a[20:23], v[200:203]
    v_mfma_f32_16x16x32_bf16 v[204:207], a[96:99], a[24:27], v[204:207]
    ds_read_b64_tr_b16 a[126:127], v26 offset:61696
    v_mfma_f32_16x16x32_bf16 v[204:207], a[100:103], a[28:31], v[204:207]
    v_mfma_f32_16x16x32_bf16 v[208:211], a[96:99], a[64:67], v[208:211]
    ds_read_b128 a[48:51], v23 offset:36864
    v_mfma_f32_16x16x32_bf16 v[208:211], a[100:103], a[68:71], v[208:211]
    v_mfma_f32_16x16x32_bf16 v[212:215], a[96:99], a[72:75], v[212:215]
    ds_read_b128 a[52:55], v24 offset:36864
    s_add_u32 m0, s91, 69632
    v_mfma_f32_16x16x32_bf16 v[212:215], a[100:103], a[76:79], v[212:215]
    buffer_load_dwordx4 v20, s[64:67], s84 offen offset:0 lds
    v_mfma_f32_16x16x32_bf16 v[216:219], a[96:99], a[80:83], v[216:219]
    ds_read_b128 a[56:59], v23 offset:38912
    v_mfma_f32_16x16x32_bf16 v[216:219], a[100:103], a[84:87], v[216:219]
    v_mfma_f32_16x16x32_bf16 v[220:223], a[96:99], a[88:91], v[220:223]
    ds_read_b128 a[60:63], v24 offset:38912
    v_mfma_f32_16x16x32_bf16 v[220:223], a[100:103], a[92:95], v[220:223]
    v_mfma_f32_16x16x32_bf16 v[252:255], a[104:107], a[88:91], v[252:255]
    ds_read_b64_tr_b16 a[96:97], v27 offset:40960
    v_mfma_f32_16x16x32_bf16 v[252:255], a[108:111], a[92:95], v[252:255]
    buffer_load_dwordx4 v21, s[64:67], s84 offen offset:1024 lds
    v_mfma_f32_16x16x32_bf16 v[248:251], a[104:107], a[80:83], v[248:251]
    ds_read_b128 a[88:91], v23 offset:47104
    v_mfma_f32_16x16x32_bf16 v[248:251], a[108:111], a[84:87], v[248:251]
    ds_read_b128 a[92:95], v24 offset:47104
    v_mfma_f32_16x16x32_bf16 v[244:247], a[104:107], a[72:75], v[244:247]
    ds_read_b128 a[80:83], v23 offset:45056
    v_mfma_f32_16x16x32_bf16 v[244:247], a[108:111], a[76:79], v[244:247]
    ds_read_b128 a[84:87], v24 offset:45056
    v_mfma_f32_16x16x32_bf16 v[240:243], a[104:107], a[64:67], v[240:243]
    v_mfma_f32_16x16x32_bf16 v[240:243], a[108:111], a[68:71], v[240:243]
    ds_read_b128 a[72:75], v23 offset:43008
    v_mfma_f32_16x16x32_bf16 v[236:239], a[104:107], a[24:27], v[236:239]
    ds_read_b128 a[76:79], v24 offset:43008
    buffer_load_dwordx4 v22, s[64:67], s84 offen offset:2048 lds
    v_mfma_f32_16x16x32_bf16 v[236:239], a[108:111], a[28:31], v[236:239]
    ds_read_b128 a[64:67], v23 offset:40960
    v_mfma_f32_16x16x32_bf16 v[232:235], a[104:107], a[16:19], v[232:235]
    ds_read_b128 a[68:71], v24 offset:40960
    v_mfma_f32_16x16x32_bf16 v[232:235], a[108:111], a[20:23], v[232:235]
    ds_read_b64_tr_b16 a[98:99], v27 offset:42752
    v_mfma_f32_16x16x32_bf16 v[228:231], a[104:107], a[8:11], v[228:231]
    v_mfma_f32_16x16x32_bf16 v[228:231], a[108:111], a[12:15], v[228:231]
    ds_read_b64_tr_b16 a[100:101], v27 offset:51200
    v_mfma_f32_16x16x32_bf16 v[224:227], a[104:107], a[0:3], v[224:227]
    buffer_load_dwordx4 v14, s[60:63], s83 offen offset:3072 lds
    v_mfma_f32_16x16x32_bf16 v[224:227], a[108:111], a[4:7], v[224:227]
    ds_read_b64_tr_b16 a[102:103], v27 offset:52992
    s_sub_u32 s48, s48, 1
    s_cmp_lg_u32 s48, 0
    s_cbranch_scc1 gated_mix__softmax_full_mha__glu_gated_bilinear__prompt_kernel_c1loop
gated_mix__softmax_full_mha__glu_gated_bilinear__prompt_kernel_c1out:
    s_waitcnt lgkmcnt(15)
    v_mfma_f32_16x16x32_bf16 v[64:67], a[32:35], a[112:115], v[64:67]
    ds_read_b64_tr_b16 a[104:105], v28 offset:40960
    v_mfma_f32_16x16x32_bf16 v[64:67], a[36:39], a[116:119], v[64:67]
    v_mfma_f32_16x16x32_bf16 v[68:71], a[40:43], a[112:115], v[68:71]
    ds_read_b64_tr_b16 a[106:107], v28 offset:42752
    v_mfma_f32_16x16x32_bf16 v[68:71], a[44:47], a[116:119], v[68:71]
    v_mfma_f32_16x16x32_bf16 v[72:75], a[48:51], a[112:115], v[72:75]
    ds_read_b64_tr_b16 a[108:109], v28 offset:51200
    s_waitcnt lgkmcnt(15)
    v_mfma_f32_16x16x32_bf16 v[72:75], a[52:55], a[116:119], v[72:75]
    s_add_u32 m0, s91, 73728
    v_mfma_f32_16x16x32_bf16 v[76:79], a[56:59], a[112:115], v[76:79]
    ds_read_b64_tr_b16 a[110:111], v28 offset:52992
    buffer_load_dwordx4 v15, s[60:63], s83 offen offset:0 lds
    v_mfma_f32_16x16x32_bf16 v[76:79], a[60:63], a[116:119], v[76:79]
    s_waitcnt lgkmcnt(8)
    v_mfma_f32_16x16x32_bf16 v[80:83], a[64:67], a[112:115], v[80:83]
    s_waitcnt lgkmcnt(7)
    v_mfma_f32_16x16x32_bf16 v[80:83], a[68:71], a[116:119], v[80:83]
    v_mfma_f32_16x16x32_bf16 v[84:87], a[72:75], a[112:115], v[84:87]
    v_mfma_f32_16x16x32_bf16 v[84:87], a[76:79], a[116:119], v[84:87]
    v_mfma_f32_16x16x32_bf16 v[88:91], a[80:83], a[112:115], v[88:91]
    v_mfma_f32_16x16x32_bf16 v[88:91], a[84:87], a[116:119], v[88:91]
    v_mfma_f32_16x16x32_bf16 v[92:95], a[88:91], a[112:115], v[92:95]
    buffer_load_dwordx4 v14, s[60:63], s83 offen offset:1024 lds
    v_mfma_f32_16x16x32_bf16 v[92:95], a[92:95], a[116:119], v[92:95]
    v_mfma_f32_16x16x32_bf16 v[124:127], a[88:91], a[120:123], v[124:127]
    ds_read_b64_tr_b16 a[112:113], v27 offset:40992
    v_mfma_f32_16x16x32_bf16 v[124:127], a[92:95], a[124:127], v[124:127]
    v_mfma_f32_16x16x32_bf16 v[120:123], a[80:83], a[120:123], v[120:123]
    ds_read_b64_tr_b16 a[114:115], v27 offset:42784
    v_mfma_f32_16x16x32_bf16 v[120:123], a[84:87], a[124:127], v[120:123]
    v_mfma_f32_16x16x32_bf16 v[116:119], a[72:75], a[120:123], v[116:119]
    ds_read_b64_tr_b16 a[116:117], v27 offset:51232
    v_mfma_f32_16x16x32_bf16 v[116:119], a[76:79], a[124:127], v[116:119]
    s_add_u32 m0, s90, 0
    v_mfma_f32_16x16x32_bf16 v[112:115], a[64:67], a[120:123], v[112:115]
    ds_read_b64_tr_b16 a[118:119], v27 offset:53024
    buffer_load_dwordx4 v6, s[56:59], s82 offen offset:0 lds
    v_mfma_f32_16x16x32_bf16 v[112:115], a[68:71], a[124:127], v[112:115]
    v_mfma_f32_16x16x32_bf16 v[108:111], a[56:59], a[120:123], v[108:111]
    v_mfma_f32_16x16x32_bf16 v[108:111], a[60:63], a[124:127], v[108:111]
    v_mfma_f32_16x16x32_bf16 v[104:107], a[48:51], a[120:123], v[104:107]
    buffer_load_dwordx4 v7, s[56:59], s82 offen offset:1024 lds
    v_mfma_f32_16x16x32_bf16 v[104:107], a[52:55], a[124:127], v[104:107]
    v_mfma_f32_16x16x32_bf16 v[100:103], a[40:43], a[120:123], v[100:103]
    v_mfma_f32_16x16x32_bf16 v[100:103], a[44:47], a[124:127], v[100:103]
    v_mfma_f32_16x16x32_bf16 v[96:99], a[32:35], a[120:123], v[96:99]
    buffer_load_dwordx4 v8, s[56:59], s82 offen offset:2048 lds
    v_mfma_f32_16x16x32_bf16 v[96:99], a[36:39], a[124:127], v[96:99]
    s_waitcnt lgkmcnt(10)
    v_mfma_f32_16x16x32_bf16 a[128:131], a[96:99], a[32:35], a[128:131]
    ds_read_b64_tr_b16 a[120:121], v28 offset:40992
    s_waitcnt lgkmcnt(9)
    v_mfma_f32_16x16x32_bf16 a[128:131], a[100:103], a[36:39], a[128:131]
    v_mfma_f32_16x16x32_bf16 a[132:135], a[96:99], a[40:43], a[132:135]
    ds_read_b64_tr_b16 a[122:123], v28 offset:42784
    buffer_load_dwordx4 v9, s[56:59], s82 offen offset:3072 lds
    v_mfma_f32_16x16x32_bf16 a[132:135], a[100:103], a[44:47], a[132:135]
    v_mfma_f32_16x16x32_bf16 a[136:139], a[96:99], a[48:51], a[136:139]
    ds_read_b64_tr_b16 a[124:125], v28 offset:51232
    v_mfma_f32_16x16x32_bf16 a[136:139], a[100:103], a[52:55], a[136:139]
    s_add_u32 m0, s90, 4096
    v_mfma_f32_16x16x32_bf16 a[140:143], a[96:99], a[56:59], a[140:143]
    ds_read_b64_tr_b16 a[126:127], v28 offset:53024
    buffer_load_dwordx4 v10, s[56:59], s82 offen offset:0 lds
    v_mfma_f32_16x16x32_bf16 a[140:143], a[100:103], a[60:63], a[140:143]
    v_mfma_f32_16x16x32_bf16 a[144:147], a[96:99], a[64:67], a[144:147]
    v_mfma_f32_16x16x32_bf16 a[144:147], a[100:103], a[68:71], a[144:147]
    v_mfma_f32_16x16x32_bf16 a[148:151], a[96:99], a[72:75], a[148:151]
    buffer_load_dwordx4 v11, s[56:59], s82 offen offset:1024 lds
    v_mfma_f32_16x16x32_bf16 a[148:151], a[100:103], a[76:79], a[148:151]
    v_mfma_f32_16x16x32_bf16 a[152:155], a[96:99], a[80:83], a[152:155]
    v_mfma_f32_16x16x32_bf16 a[152:155], a[100:103], a[84:87], a[152:155]
    v_mfma_f32_16x16x32_bf16 a[156:159], a[96:99], a[88:91], a[156:159]
    buffer_load_dwordx4 v12, s[56:59], s82 offen offset:2048 lds
    v_mfma_f32_16x16x32_bf16 a[156:159], a[100:103], a[92:95], a[156:159]
    s_waitcnt lgkmcnt(10)
    v_mfma_f32_16x16x32_bf16 a[188:191], a[104:107], a[88:91], a[188:191]
    ds_read_b64_tr_b16 a[96:97], v27 offset:41024
    s_waitcnt lgkmcnt(9)
    v_mfma_f32_16x16x32_bf16 a[188:191], a[108:111], a[92:95], a[188:191]
    v_mfma_f32_16x16x32_bf16 a[184:187], a[104:107], a[80:83], a[184:187]
    ds_read_b64_tr_b16 a[98:99], v27 offset:42816
    buffer_load_dwordx4 v13, s[56:59], s82 offen offset:3072 lds
    v_mfma_f32_16x16x32_bf16 a[184:187], a[108:111], a[84:87], a[184:187]
    v_mfma_f32_16x16x32_bf16 a[180:183], a[104:107], a[72:75], a[180:183]
    ds_read_b64_tr_b16 a[100:101], v27 offset:51264
    s_add_u32 s83, s83, 393216
    v_mfma_f32_16x16x32_bf16 a[180:183], a[108:111], a[76:79], a[180:183]
    s_add_u32 s84, s84, 458752
    v_mfma_f32_16x16x32_bf16 a[176:179], a[104:107], a[64:67], a[176:179]
    ds_read_b64_tr_b16 a[102:103], v27 offset:53056
    s_add_u32 s82, s82, 128
    v_mfma_f32_16x16x32_bf16 a[176:179], a[108:111], a[68:71], a[176:179]
    s_cmp_eq_u32 s48, 0
    v_mfma_f32_16x16x32_bf16 a[172:175], a[104:107], a[56:59], a[172:175]
    s_cselect_b32 s45, s47, 2.0
    v_mfma_f32_16x16x32_bf16 a[172:175], a[108:111], a[60:63], a[172:175]
    s_cselect_b32 s46, 0, 2.0
    v_mfma_f32_16x16x32_bf16 a[168:171], a[104:107], a[48:51], a[168:171]
    s_cselect_b32 s76, s18, s76
    v_mfma_f32_16x16x32_bf16 a[168:171], a[108:111], a[52:55], a[168:171]
    s_cselect_b32 s77, s19, s77
    v_mfma_f32_16x16x32_bf16 a[164:167], a[104:107], a[40:43], a[164:167]
    s_cselect_b32 s78, 0x800, s78
    v_mfma_f32_16x16x32_bf16 a[164:167], a[108:111], a[44:47], a[164:167]
    buffer_load_dwordx4 v[52:55], v29, s[76:79], s46 offen offset:0
    v_mfma_f32_16x16x32_bf16 a[160:163], a[104:107], a[32:35], a[160:163]
    v_mfma_f32_16x16x32_bf16 a[160:163], a[108:111], a[36:39], a[160:163]
    s_waitcnt lgkmcnt(10)
    v_mfma_f32_16x16x32_bf16 a[192:195], a[112:115], a[32:35], a[192:195]
    ds_read_b64_tr_b16 a[104:105], v28 offset:41024
    buffer_load_dwordx4 v[56:59], v29, s[76:79], s46 offen offset:16
    s_waitcnt lgkmcnt(9)
    v_mfma_f32_16x16x32_bf16 a[192:195], a[116:119], a[36:39], a[192:195]
    v_mfma_f32_16x16x32_bf16 a[196:199], a[112:115], a[40:43], a[196:199]
    ds_read_b64_tr_b16 a[106:107], v28 offset:42816
    v_mfma_f32_16x16x32_bf16 a[196:199], a[116:119], a[44:47], a[196:199]
    buffer_load_dwordx4 v[36:39], v29, s[56:59], s45 offen offset:0
    v_mfma_f32_16x16x32_bf16 a[200:203], a[112:115], a[48:51], a[200:203]
    ds_read_b64_tr_b16 a[108:109], v28 offset:51264
    v_mfma_f32_16x16x32_bf16 a[200:203], a[116:119], a[52:55], a[200:203]
    v_mfma_f32_16x16x32_bf16 a[204:207], a[112:115], a[56:59], a[204:207]
    ds_read_b64_tr_b16 a[110:111], v28 offset:53056
    buffer_load_dwordx4 v[40:43], v29, s[56:59], s45 offen offset:16
    v_mfma_f32_16x16x32_bf16 a[204:207], a[116:119], a[60:63], a[204:207]
    v_mfma_f32_16x16x32_bf16 a[208:211], a[112:115], a[64:67], a[208:211]
    v_mfma_f32_16x16x32_bf16 a[208:211], a[116:119], a[68:71], a[208:211]
    buffer_load_dwordx4 v[44:47], v29, s[56:59], s45 offen offset:2048
    v_mfma_f32_16x16x32_bf16 a[212:215], a[112:115], a[72:75], a[212:215]
    v_mfma_f32_16x16x32_bf16 a[212:215], a[116:119], a[76:79], a[212:215]
    v_mfma_f32_16x16x32_bf16 a[216:219], a[112:115], a[80:83], a[216:219]
    buffer_load_dwordx4 v[48:51], v29, s[56:59], s45 offen offset:2064
    v_mfma_f32_16x16x32_bf16 a[216:219], a[116:119], a[84:87], a[216:219]
    v_mfma_f32_16x16x32_bf16 a[220:223], a[112:115], a[88:91], a[220:223]
    v_mfma_f32_16x16x32_bf16 a[220:223], a[116:119], a[92:95], a[220:223]
    s_waitcnt lgkmcnt(10)
    v_mfma_f32_16x16x32_bf16 a[252:255], a[120:123], a[88:91], a[252:255]
    ds_read_b64_tr_b16 a[112:113], v27 offset:41056
    s_waitcnt lgkmcnt(9)
    v_mfma_f32_16x16x32_bf16 a[252:255], a[124:127], a[92:95], a[252:255]
    v_mfma_f32_16x16x32_bf16 a[248:251], a[120:123], a[80:83], a[248:251]
    ds_read_b64_tr_b16 a[114:115], v27 offset:42848
    v_mfma_f32_16x16x32_bf16 a[248:251], a[124:127], a[84:87], a[248:251]
    v_mfma_f32_16x16x32_bf16 a[244:247], a[120:123], a[72:75], a[244:247]
    ds_read_b64_tr_b16 a[116:117], v27 offset:51296
    v_mfma_f32_16x16x32_bf16 a[244:247], a[124:127], a[76:79], a[244:247]
    v_mfma_f32_16x16x32_bf16 a[240:243], a[120:123], a[64:67], a[240:243]
    ds_read_b64_tr_b16 a[118:119], v27 offset:53088
    v_mfma_f32_16x16x32_bf16 a[240:243], a[124:127], a[68:71], a[240:243]
    v_mfma_f32_16x16x32_bf16 a[236:239], a[120:123], a[56:59], a[236:239]
    v_mfma_f32_16x16x32_bf16 a[236:239], a[124:127], a[60:63], a[236:239]
    v_mfma_f32_16x16x32_bf16 a[232:235], a[120:123], a[48:51], a[232:235]
    v_mfma_f32_16x16x32_bf16 a[232:235], a[124:127], a[52:55], a[232:235]
    v_mfma_f32_16x16x32_bf16 a[228:231], a[120:123], a[40:43], a[228:231]
    v_mfma_f32_16x16x32_bf16 a[228:231], a[124:127], a[44:47], a[228:231]
    v_mfma_f32_16x16x32_bf16 a[224:227], a[120:123], a[32:35], a[224:227]
    v_mfma_f32_16x16x32_bf16 a[224:227], a[124:127], a[36:39], a[224:227]
    s_waitcnt lgkmcnt(10)
    v_mfma_f32_16x16x32_bf16 v[128:131], a[96:99], a[32:35], v[128:131]
    ds_read_b64_tr_b16 a[120:121], v28 offset:41056
    s_waitcnt lgkmcnt(9)
    v_mfma_f32_16x16x32_bf16 v[128:131], a[100:103], a[36:39], v[128:131]
    v_mfma_f32_16x16x32_bf16 v[132:135], a[96:99], a[40:43], v[132:135]
    ds_read_b64_tr_b16 a[122:123], v28 offset:42848
    v_mfma_f32_16x16x32_bf16 v[132:135], a[100:103], a[44:47], v[132:135]
    v_mfma_f32_16x16x32_bf16 v[136:139], a[96:99], a[48:51], v[136:139]
    ds_read_b64_tr_b16 a[124:125], v28 offset:51296
    v_mfma_f32_16x16x32_bf16 v[136:139], a[100:103], a[52:55], v[136:139]
    v_mfma_f32_16x16x32_bf16 v[140:143], a[96:99], a[56:59], v[140:143]
    ds_read_b64_tr_b16 a[126:127], v28 offset:53088
    v_mfma_f32_16x16x32_bf16 v[140:143], a[100:103], a[60:63], v[140:143]
    v_mfma_f32_16x16x32_bf16 v[144:147], a[96:99], a[64:67], v[144:147]
    v_mfma_f32_16x16x32_bf16 v[144:147], a[100:103], a[68:71], v[144:147]
    v_mfma_f32_16x16x32_bf16 v[148:151], a[96:99], a[72:75], v[148:151]
    v_mfma_f32_16x16x32_bf16 v[148:151], a[100:103], a[76:79], v[148:151]
    v_mfma_f32_16x16x32_bf16 v[152:155], a[96:99], a[80:83], v[152:155]
    v_mfma_f32_16x16x32_bf16 v[152:155], a[100:103], a[84:87], v[152:155]
    v_mfma_f32_16x16x32_bf16 v[156:159], a[96:99], a[88:91], v[156:159]
    v_mfma_f32_16x16x32_bf16 v[156:159], a[100:103], a[92:95], v[156:159]
    s_waitcnt vmcnt(6) lgkmcnt(0)
    s_barrier
    v_mfma_f32_16x16x32_bf16 v[188:191], a[104:107], a[88:91], v[188:191]
    ds_read_b64_tr_b16 a[96:97], v25 offset:0
    s_add_u32 m0, s91, 106496
    v_mfma_f32_16x16x32_bf16 v[188:191], a[108:111], a[92:95], v[188:191]
    buffer_load_dwordx4 v16, s[64:67], s84 offen offset:0 lds
    v_mfma_f32_16x16x32_bf16 v[184:187], a[104:107], a[80:83], v[184:187]
    ds_read_b64_tr_b16 a[98:99], v25 offset:256
    v_mfma_f32_16x16x32_bf16 v[184:187], a[108:111], a[84:87], v[184:187]
    v_mfma_f32_16x16x32_bf16 v[180:183], a[104:107], a[72:75], v[180:183]
    ds_read_b64_tr_b16 a[100:101], v25 offset:20480
    v_mfma_f32_16x16x32_bf16 v[180:183], a[108:111], a[76:79], v[180:183]
    v_mfma_f32_16x16x32_bf16 v[176:179], a[104:107], a[64:67], v[176:179]
    ds_read_b64_tr_b16 a[102:103], v25 offset:20736
    v_mfma_f32_16x16x32_bf16 v[176:179], a[108:111], a[68:71], v[176:179]
    buffer_load_dwordx4 v17, s[64:67], s84 offen offset:1024 lds
    v_mfma_f32_16x16x32_bf16 v[172:175], a[104:107], a[56:59], v[172:175]
    ds_read_b128 a[0:3], v23 offset:0
    v_mfma_f32_16x16x32_bf16 v[172:175], a[108:111], a[60:63], v[172:175]
    v_mfma_f32_16x16x32_bf16 v[168:171], a[104:107], a[48:51], v[168:171]
    ds_read_b128 a[4:7], v24 offset:0
    v_mfma_f32_16x16x32_bf16 v[168:171], a[108:111], a[52:55], v[168:171]
    v_mfma_f32_16x16x32_bf16 v[164:167], a[104:107], a[40:43], v[164:167]
    ds_read_b128 a[8:11], v23 offset:2048
    v_mfma_f32_16x16x32_bf16 v[164:167], a[108:111], a[44:47], v[164:167]
    v_mfma_f32_16x16x32_bf16 v[160:163], a[104:107], a[32:35], v[160:163]
    ds_read_b128 a[12:15], v24 offset:2048
    buffer_load_dwordx4 v18, s[64:67], s84 offen offset:2048 lds
    v_mfma_f32_16x16x32_bf16 v[160:163], a[108:111], a[36:39], v[160:163]
    v_mfma_f32_16x16x32_bf16 v[192:195], a[112:115], a[32:35], v[192:195]
    ds_read_b64_tr_b16 a[104:105], v26 offset:0
    v_mfma_f32_16x16x32_bf16 v[192:195], a[116:119], a[36:39], v[192:195]
    v_mfma_f32_16x16x32_bf16 v[196:199], a[112:115], a[40:43], v[196:199]
    ds_read_b64_tr_b16 a[106:107], v26 offset:256
    v_mfma_f32_16x16x32_bf16 v[196:199], a[116:119], a[44:47], v[196:199]
    v_mfma_f32_16x16x32_bf16 v[200:203], a[112:115], a[48:51], v[200:203]
    ds_read_b64_tr_b16 a[108:109], v26 offset:20480
    buffer_load_dwordx4 v19, s[64:67], s84 offen offset:3072 lds
    v_mfma_f32_16x16x32_bf16 v[200:203], a[116:119], a[52:55], v[200:203]
    v_mfma_f32_16x16x32_bf16 v[204:207], a[112:115], a[56:59], v[204:207]
    ds_read_b64_tr_b16 a[110:111], v26 offset:20736
    v_mfma_f32_16x16x32_bf16 v[204:207], a[116:119], a[60:63], v[204:207]
    v_mfma_f32_16x16x32_bf16 v[208:211], a[112:115], a[64:67], v[208:211]
    ds_read_b128 a[16:19], v23 offset:4096
    v_mfma_f32_16x16x32_bf16 v[208:211], a[116:119], a[68:71], v[208:211]
    v_mfma_f32_16x16x32_bf16 v[212:215], a[112:115], a[72:75], v[212:215]
    ds_read_b128 a[20:23], v24 offset:4096
    s_add_u32 m0, s91, 110592
    v_mfma_f32_16x16x32_bf16 v[212:215], a[116:119], a[76:79], v[212:215]
    buffer_load_dwordx4 v20, s[64:67], s84 offen offset:0 lds
    v_mfma_f32_16x16x32_bf16 v[216:219], a[112:115], a[80:83], v[216:219]
    ds_read_b128 a[24:27], v23 offset:6144
    v_mfma_f32_16x16x32_bf16 v[216:219], a[116:119], a[84:87], v[216:219]
    v_mfma_f32_16x16x32_bf16 v[220:223], a[112:115], a[88:91], v[220:223]
    ds_read_b128 a[28:31], v24 offset:6144
    v_mfma_f32_16x16x32_bf16 v[220:223], a[116:119], a[92:95], v[220:223]
    v_mfma_f32_16x16x32_bf16 v[252:255], a[120:123], a[88:91], v[252:255]
    ds_read_b64_tr_b16 a[112:113], v27 offset:0
    v_mfma_f32_16x16x32_bf16 v[252:255], a[124:127], a[92:95], v[252:255]
    buffer_load_dwordx4 v21, s[64:67], s84 offen offset:1024 lds
    v_mfma_f32_16x16x32_bf16 v[248:251], a[120:123], a[80:83], v[248:251]
    ds_read_b128 a[88:91], v23 offset:14336
    v_mfma_f32_16x16x32_bf16 v[248:251], a[124:127], a[84:87], v[248:251]
    ds_read_b128 a[92:95], v24 offset:14336
    v_mfma_f32_16x16x32_bf16 v[244:247], a[120:123], a[72:75], v[244:247]
    ds_read_b128 a[80:83], v23 offset:12288
    v_mfma_f32_16x16x32_bf16 v[244:247], a[124:127], a[76:79], v[244:247]
    ds_read_b128 a[84:87], v24 offset:12288
    v_mfma_f32_16x16x32_bf16 v[240:243], a[120:123], a[64:67], v[240:243]
    v_mfma_f32_16x16x32_bf16 v[240:243], a[124:127], a[68:71], v[240:243]
    ds_read_b128 a[72:75], v23 offset:10240
    v_mfma_f32_16x16x32_bf16 v[236:239], a[120:123], a[56:59], v[236:239]
    ds_read_b128 a[76:79], v24 offset:10240
    buffer_load_dwordx4 v22, s[64:67], s84 offen offset:2048 lds
    v_mfma_f32_16x16x32_bf16 v[236:239], a[124:127], a[60:63], v[236:239]
    ds_read_b128 a[64:67], v23 offset:8192
    v_mfma_f32_16x16x32_bf16 v[232:235], a[120:123], a[48:51], v[232:235]
    ds_read_b128 a[68:71], v24 offset:8192
    v_mfma_f32_16x16x32_bf16 v[232:235], a[124:127], a[52:55], v[232:235]
    ds_read_b64_tr_b16 a[114:115], v27 offset:1792
    v_mfma_f32_16x16x32_bf16 v[228:231], a[120:123], a[40:43], v[228:231]
    v_mfma_f32_16x16x32_bf16 v[228:231], a[124:127], a[44:47], v[228:231]
    ds_read_b64_tr_b16 a[116:117], v27 offset:10240
    v_mfma_f32_16x16x32_bf16 v[224:227], a[120:123], a[32:35], v[224:227]
    buffer_load_dwordx4 v14, s[60:63], s83 offen offset:3072 lds
    v_mfma_f32_16x16x32_bf16 v[224:227], a[124:127], a[36:39], v[224:227]
    ds_read_b64_tr_b16 a[118:119], v27 offset:12032
    s_waitcnt lgkmcnt(15)
    v_mfma_f32_16x16x32_bf16 v[64:67], a[0:3], a[96:99], v[64:67]
    ds_read_b64_tr_b16 a[120:121], v28 offset:0
    v_mfma_f32_16x16x32_bf16 v[64:67], a[4:7], a[100:103], v[64:67]
    s_waitcnt vmcnt(11)
    v_lshlrev_b32 v60, 16, v36
    v_lshlrev_b32 v61, 16, v52
    v_mfma_f32_16x16x32_bf16 v[68:71], a[8:11], a[96:99], v[68:71]
    ds_read_b64_tr_b16 a[122:123], v28 offset:1792
    v_and_b32 v62, s92, v36
    v_mfma_f32_16x16x32_bf16 v[68:71], a[12:15], a[100:103], v[68:71]
    v_and_b32 v63, s92, v52
    v_mul_f32 v60, v60, v61
    v_mfma_f32_16x16x32_bf16 v[72:75], a[16:19], a[96:99], v[72:75]
    ds_read_b64_tr_b16 a[124:125], v28 offset:10240
    v_mul_f32 v62, v62, v63
    s_waitcnt lgkmcnt(15)
    v_mfma_f32_16x16x32_bf16 v[72:75], a[20:23], a[100:103], v[72:75]
    s_add_u32 m0, s91, 114688
    v_cvt_pk_bf16_f32 v60, v60, v62
    v_mfma_f32_16x16x32_bf16 v[76:79], a[24:27], a[96:99], v[76:79]
    ds_read_b64_tr_b16 a[126:127], v28 offset:12032
    buffer_load_dwordx4 v15, s[60:63], s83 offen offset:0 lds
    v_mfma_f32_16x16x32_bf16 v[76:79], a[28:31], a[100:103], v[76:79]
    v_lshlrev_b32 v61, 16, v60
    v_and_b32 v62, s92, v60
    s_waitcnt lgkmcnt(8)
    v_mfma_f32_16x16x32_bf16 v[80:83], a[64:67], a[96:99], v[80:83]
    v_add_f32 v29, v61, v62
    v_lshlrev_b32 v60, 16, v37
    s_waitcnt lgkmcnt(7)
    v_mfma_f32_16x16x32_bf16 v[80:83], a[68:71], a[100:103], v[80:83]
    v_lshlrev_b32 v61, 16, v53
    v_and_b32 v62, s92, v37
    v_mfma_f32_16x16x32_bf16 v[84:87], a[72:75], a[96:99], v[84:87]
    v_and_b32 v63, s92, v53
    v_mul_f32 v60, v60, v61
    v_mfma_f32_16x16x32_bf16 v[84:87], a[76:79], a[100:103], v[84:87]
    v_mul_f32 v62, v62, v63
    v_cvt_pk_bf16_f32 v60, v60, v62
    v_mfma_f32_16x16x32_bf16 v[88:91], a[80:83], a[96:99], v[88:91]
    v_lshlrev_b32 v61, 16, v60
    v_and_b32 v62, s92, v60
    v_mfma_f32_16x16x32_bf16 v[88:91], a[84:87], a[100:103], v[88:91]
    v_add_f32 v61, v61, v62
    v_add_f32 v29, v29, v61
    v_mfma_f32_16x16x32_bf16 v[92:95], a[88:91], a[96:99], v[92:95]
    buffer_load_dwordx4 v14, s[60:63], s83 offen offset:1024 lds
    v_lshlrev_b32 v60, 16, v38
    v_mfma_f32_16x16x32_bf16 v[92:95], a[92:95], a[100:103], v[92:95]
    v_lshlrev_b32 v61, 16, v54
    v_and_b32 v62, s92, v38
    v_mfma_f32_16x16x32_bf16 v[124:127], a[88:91], a[104:107], v[124:127]
    ds_read_b64_tr_b16 a[96:97], v27 offset:32
    v_and_b32 v63, s92, v54
    v_mfma_f32_16x16x32_bf16 v[124:127], a[92:95], a[108:111], v[124:127]
    v_mul_f32 v60, v60, v61
    v_mul_f32 v62, v62, v63
    v_mfma_f32_16x16x32_bf16 v[120:123], a[80:83], a[104:107], v[120:123]
    ds_read_b64_tr_b16 a[98:99], v27 offset:1824
    v_cvt_pk_bf16_f32 v60, v60, v62
    v_mfma_f32_16x16x32_bf16 v[120:123], a[84:87], a[108:111], v[120:123]
    v_lshlrev_b32 v61, 16, v60
    v_and_b32 v62, s92, v60
    v_mfma_f32_16x16x32_bf16 v[116:119], a[72:75], a[104:107], v[116:119]
    ds_read_b64_tr_b16 a[100:101], v27 offset:10272
    v_add_f32 v61, v61, v62
    v_mfma_f32_16x16x32_bf16 v[116:119], a[76:79], a[108:111], v[116:119]
    s_add_u32 m0, s90, 32768
    v_add_f32 v29, v29, v61
    v_mfma_f32_16x16x32_bf16 v[112:115], a[64:67], a[104:107], v[112:115]
    ds_read_b64_tr_b16 a[102:103], v27 offset:12064
    buffer_load_dwordx4 v6, s[56:59], s82 offen offset:0 lds
    v_mfma_f32_16x16x32_bf16 v[112:115], a[68:71], a[108:111], v[112:115]
    v_lshlrev_b32 v60, 16, v39
    v_lshlrev_b32 v61, 16, v55
    v_mfma_f32_16x16x32_bf16 v[108:111], a[24:27], a[104:107], v[108:111]
    v_and_b32 v62, s92, v39
    v_and_b32 v63, s92, v55
    v_mfma_f32_16x16x32_bf16 v[108:111], a[28:31], a[108:111], v[108:111]
    v_mul_f32 v60, v60, v61
    v_mul_f32 v62, v62, v63
    v_mfma_f32_16x16x32_bf16 v[104:107], a[16:19], a[104:107], v[104:107]
    buffer_load_dwordx4 v7, s[56:59], s82 offen offset:1024 lds
    v_cvt_pk_bf16_f32 v60, v60, v62
    v_mfma_f32_16x16x32_bf16 v[104:107], a[20:23], a[108:111], v[104:107]
    v_lshlrev_b32 v61, 16, v60
    v_and_b32 v62, s92, v60
    v_mfma_f32_16x16x32_bf16 v[100:103], a[8:11], a[104:107], v[100:103]
    v_add_f32 v61, v61, v62
    v_add_f32 v29, v29, v61
    v_mfma_f32_16x16x32_bf16 v[100:103], a[12:15], a[108:111], v[100:103]
    s_waitcnt vmcnt(14)
    v_lshlrev_b32 v60, 16, v40
    v_lshlrev_b32 v61, 16, v56
    v_mfma_f32_16x16x32_bf16 v[96:99], a[0:3], a[104:107], v[96:99]
    buffer_load_dwordx4 v8, s[56:59], s82 offen offset:2048 lds
    v_and_b32 v62, s92, v40
    v_mfma_f32_16x16x32_bf16 v[96:99], a[4:7], a[108:111], v[96:99]
    v_and_b32 v63, s92, v56
    v_mul_f32 v60, v60, v61
    s_waitcnt lgkmcnt(10)
    v_mfma_f32_16x16x32_bf16 a[128:131], a[112:115], a[0:3], a[128:131]
    ds_read_b64_tr_b16 a[104:105], v28 offset:32
    v_mul_f32 v62, v62, v63
    s_waitcnt lgkmcnt(9)
    v_mfma_f32_16x16x32_bf16 a[128:131], a[116:119], a[4:7], a[128:131]
    v_cvt_pk_bf16_f32 v60, v60, v62
    v_lshlrev_b32 v61, 16, v60
    v_mfma_f32_16x16x32_bf16 a[132:135], a[112:115], a[8:11], a[132:135]
    ds_read_b64_tr_b16 a[106:107], v28 offset:1824
    buffer_load_dwordx4 v9, s[56:59], s82 offen offset:3072 lds
    v_mfma_f32_16x16x32_bf16 a[132:135], a[116:119], a[12:15], a[132:135]
    v_and_b32 v62, s92, v60
    v_add_f32 v61, v61, v62
    v_mfma_f32_16x16x32_bf16 a[136:139], a[112:115], a[16:19], a[136:139]
    ds_read_b64_tr_b16 a[108:109], v28 offset:10272
    v_add_f32 v29, v29, v61
    v_mfma_f32_16x16x32_bf16 a[136:139], a[116:119], a[20:23], a[136:139]
    s_add_u32 m0, s90, 36864
    v_lshlrev_b32 v60, 16, v41
    v_mfma_f32_16x16x32_bf16 a[140:143], a[112:115], a[24:27], a[140:143]
    ds_read_b64_tr_b16 a[110:111], v28 offset:12064
    buffer_load_dwordx4 v10, s[56:59], s82 offen offset:0 lds
    v_mfma_f32_16x16x32_bf16 a[140:143], a[116:119], a[28:31], a[140:143]
    v_lshlrev_b32 v61, 16, v57
    v_and_b32 v62, s92, v41
    v_mfma_f32_16x16x32_bf16 a[144:147], a[112:115], a[64:67], a[144:147]
    v_and_b32 v63, s92, v57
    v_mul_f32 v60, v60, v61
    v_mfma_f32_16x16x32_bf16 a[144:147], a[116:119], a[68:71], a[144:147]
    v_mul_f32 v62, v62, v63
    v_cvt_pk_bf16_f32 v60, v60, v62
    v_mfma_f32_16x16x32_bf16 a[148:151], a[112:115], a[72:75], a[148:151]
    buffer_load_dwordx4 v11, s[56:59], s82 offen offset:1024 lds
    v_lshlrev_b32 v61, 16, v60
    v_mfma_f32_16x16x32_bf16 a[148:151], a[116:119], a[76:79], a[148:151]
    v_and_b32 v62, s92, v60
    v_add_f32 v61, v61, v62
    v_mfma_f32_16x16x32_bf16 a[152:155], a[112:115], a[80:83], a[152:155]
    v_add_f32 v29, v29, v61
    v_lshlrev_b32 v60, 16, v42
    v_mfma_f32_16x16x32_bf16 a[152:155], a[116:119], a[84:87], a[152:155]
    v_lshlrev_b32 v61, 16, v58
    v_and_b32 v62, s92, v42
    v_mfma_f32_16x16x32_bf16 a[156:159], a[112:115], a[88:91], a[156:159]
    buffer_load_dwordx4 v12, s[56:59], s82 offen offset:2048 lds
    v_and_b32 v63, s92, v58
    v_mfma_f32_16x16x32_bf16 a[156:159], a[116:119], a[92:95], a[156:159]
    v_mul_f32 v60, v60, v61
    v_mul_f32 v62, v62, v63
    s_waitcnt lgkmcnt(10)
    v_mfma_f32_16x16x32_bf16 a[188:191], a[120:123], a[88:91], a[188:191]
    ds_read_b64_tr_b16 a[112:113], v27 offset:64
    v_cvt_pk_bf16_f32 v60, v60, v62
    s_waitcnt lgkmcnt(9)
    v_mfma_f32_16x16x32_bf16 a[188:191], a[124:127], a[92:95], a[188:191]
    v_lshlrev_b32 v61, 16, v60
    v_and_b32 v62, s92, v60
    v_mfma_f32_16x16x32_bf16 a[184:187], a[120:123], a[80:83], a[184:187]
    ds_read_b64_tr_b16 a[114:115], v27 offset:1856
    buffer_load_dwordx4 v13, s[56:59], s82 offen offset:3072 lds
    v_mfma_f32_16x16x32_bf16 a[184:187], a[124:127], a[84:87], a[184:187]
    v_add_f32 v61, v61, v62
    v_add_f32 v29, v29, v61
    v_mfma_f32_16x16x32_bf16 a[180:183], a[120:123], a[72:75], a[180:183]
    ds_read_b64_tr_b16 a[116:117], v27 offset:10304
    s_add_u32 s83, s83, 393216
    v_mfma_f32_16x16x32_bf16 a[180:183], a[124:127], a[76:79], a[180:183]
    s_add_u32 s84, s84, 458752
    v_lshlrev_b32 v60, 16, v43
    v_mfma_f32_16x16x32_bf16 a[176:179], a[120:123], a[64:67], a[176:179]
    ds_read_b64_tr_b16 a[118:119], v27 offset:12096
    s_add_u32 s82, s82, 128
    v_mfma_f32_16x16x32_bf16 a[176:179], a[124:127], a[68:71], a[176:179]
    buffer_load_dword v2, v32, s[72:75], s81 offen
    v_lshlrev_b32 v61, 16, v59
    v_mfma_f32_16x16x32_bf16 a[172:175], a[120:123], a[24:27], a[172:175]
    s_add_u32 s81, s81, 786432
    v_and_b32 v62, s92, v43
    v_mfma_f32_16x16x32_bf16 a[172:175], a[124:127], a[28:31], a[172:175]
    v_and_b32 v63, s92, v59
    v_mul_f32 v60, v60, v61
    v_mfma_f32_16x16x32_bf16 a[168:171], a[120:123], a[16:19], a[168:171]
    v_mul_f32 v62, v62, v63
    v_cvt_pk_bf16_f32 v60, v60, v62
    v_mfma_f32_16x16x32_bf16 a[168:171], a[124:127], a[20:23], a[168:171]
    v_lshlrev_b32 v61, 16, v60
    v_and_b32 v62, s92, v60
    v_mfma_f32_16x16x32_bf16 a[164:167], a[120:123], a[8:11], a[164:167]
    v_add_f32 v61, v61, v62
    v_add_f32 v29, v29, v61
    v_mfma_f32_16x16x32_bf16 a[164:167], a[124:127], a[12:15], a[164:167]
    s_waitcnt vmcnt(20)
    v_lshlrev_b32 v60, 16, v44
    v_lshlrev_b32 v61, 16, v52
    v_mfma_f32_16x16x32_bf16 a[160:163], a[120:123], a[0:3], a[160:163]
    v_and_b32 v62, s92, v44
    v_and_b32 v63, s92, v52
    v_mfma_f32_16x16x32_bf16 a[160:163], a[124:127], a[4:7], a[160:163]
    v_mul_f32 v60, v60, v61
    v_mul_f32 v62, v62, v63
    s_waitcnt lgkmcnt(10)
    v_mfma_f32_16x16x32_bf16 a[192:195], a[96:99], a[0:3], a[192:195]
    ds_read_b64_tr_b16 a[120:121], v28 offset:64
    v_cvt_pk_bf16_f32 v60, v60, v62
    s_waitcnt lgkmcnt(9)
    v_mfma_f32_16x16x32_bf16 a[192:195], a[100:103], a[4:7], a[192:195]
    v_lshlrev_b32 v61, 16, v60
    v_and_b32 v62, s92, v60
    v_mfma_f32_16x16x32_bf16 a[196:199], a[96:99], a[8:11], a[196:199]
    ds_read_b64_tr_b16 a[122:123], v28 offset:1856
    v_add_f32 v30, v61, v62
    v_mfma_f32_16x16x32_bf16 a[196:199], a[100:103], a[12:15], a[196:199]
    v_lshlrev_b32 v60, 16, v45
    v_lshlrev_b32 v61, 16, v53
    v_mfma_f32_16x16x32_bf16 a[200:203], a[96:99], a[16:19], a[200:203]
    ds_read_b64_tr_b16 a[124:125], v28 offset:10304
    v_and_b32 v62, s92, v45
    v_mfma_f32_16x16x32_bf16 a[200:203], a[100:103], a[20:23], a[200:203]
    v_and_b32 v63, s92, v53
    v_mul_f32 v60, v60, v61
    v_mfma_f32_16x16x32_bf16 a[204:207], a[96:99], a[24:27], a[204:207]
    ds_read_b64_tr_b16 a[126:127], v28 offset:12096
    v_mul_f32 v62, v62, v63
    v_mfma_f32_16x16x32_bf16 a[204:207], a[100:103], a[28:31], a[204:207]
    v_cvt_pk_bf16_f32 v60, v60, v62
    v_lshlrev_b32 v61, 16, v60
    v_mfma_f32_16x16x32_bf16 a[208:211], a[96:99], a[64:67], a[208:211]
    v_and_b32 v62, s92, v60
    v_add_f32 v61, v61, v62
    v_mfma_f32_16x16x32_bf16 a[208:211], a[100:103], a[68:71], a[208:211]
    v_add_f32 v30, v30, v61
    v_lshlrev_b32 v60, 16, v46
    v_mfma_f32_16x16x32_bf16 a[212:215], a[96:99], a[72:75], a[212:215]
    v_lshlrev_b32 v61, 16, v54
    v_and_b32 v62, s92, v46
    v_mfma_f32_16x16x32_bf16 a[212:215], a[100:103], a[76:79], a[212:215]
    v_and_b32 v63, s92, v54
    v_mul_f32 v60, v60, v61
    v_mfma_f32_16x16x32_bf16 a[216:219], a[96:99], a[80:83], a[216:219]
    v_mul_f32 v62, v62, v63
    v_cvt_pk_bf16_f32 v60, v60, v62
    v_mfma_f32_16x16x32_bf16 a[216:219], a[100:103], a[84:87], a[216:219]
    v_lshlrev_b32 v61, 16, v60
    v_and_b32 v62, s92, v60
    v_mfma_f32_16x16x32_bf16 a[220:223], a[96:99], a[88:91], a[220:223]
    v_add_f32 v61, v61, v62
    v_add_f32 v30, v30, v61
    v_mfma_f32_16x16x32_bf16 a[220:223], a[100:103], a[92:95], a[220:223]
    v_lshlrev_b32 v60, 16, v47
    v_lshlrev_b32 v61, 16, v55
    s_waitcnt lgkmcnt(10)
    v_mfma_f32_16x16x32_bf16 a[252:255], a[104:107], a[88:91], a[252:255]
    ds_read_b64_tr_b16 a[96:97], v27 offset:96
    v_and_b32 v62, s92, v47
    s_waitcnt lgkmcnt(9)
    v_mfma_f32_16x16x32_bf16 a[252:255], a[108:111], a[92:95], a[252:255]
    v_and_b32 v63, s92, v55
    v_mul_f32 v60, v60, v61
    v_mfma_f32_16x16x32_bf16 a[248:251], a[104:107], a[80:83], a[248:251]
    ds_read_b64_tr_b16 a[98:99], v27 offset:1888
    v_mul_f32 v62, v62, v63
    v_mfma_f32_16x16x32_bf16 a[248:251], a[108:111], a[84:87], a[248:251]
    v_cvt_pk_bf16_f32 v60, v60, v62
    v_lshlrev_b32 v61, 16, v60
    v_mfma_f32_16x16x32_bf16 a[244:247], a[104:107], a[72:75], a[244:247]
    ds_read_b64_tr_b16 a[100:101], v27 offset:10336
    v_and_b32 v62, s92, v60
    v_mfma_f32_16x16x32_bf16 a[244:247], a[108:111], a[76:79], a[244:247]
    v_add_f32 v61, v61, v62
    v_add_f32 v30, v30, v61
    v_mfma_f32_16x16x32_bf16 a[240:243], a[104:107], a[64:67], a[240:243]
    ds_read_b64_tr_b16 a[102:103], v27 offset:12128
    s_waitcnt vmcnt(19)
    v_lshlrev_b32 v60, 16, v48
    v_mfma_f32_16x16x32_bf16 a[240:243], a[108:111], a[68:71], a[240:243]
    v_lshlrev_b32 v61, 16, v56
    v_and_b32 v62, s92, v48
    v_mfma_f32_16x16x32_bf16 a[236:239], a[104:107], a[24:27], a[236:239]
    v_and_b32 v63, s92, v56
    v_mul_f32 v60, v60, v61
    v_mfma_f32_16x16x32_bf16 a[236:239], a[108:111], a[28:31], a[236:239]
    v_mul_f32 v62, v62, v63
    v_cvt_pk_bf16_f32 v60, v60, v62
    v_mfma_f32_16x16x32_bf16 a[232:235], a[104:107], a[16:19], a[232:235]
    v_lshlrev_b32 v61, 16, v60
    v_and_b32 v62, s92, v60
    v_mfma_f32_16x16x32_bf16 a[232:235], a[108:111], a[20:23], a[232:235]
    v_add_f32 v61, v61, v62
    v_add_f32 v30, v30, v61
    v_mfma_f32_16x16x32_bf16 a[228:231], a[104:107], a[8:11], a[228:231]
    v_lshlrev_b32 v60, 16, v49
    v_lshlrev_b32 v61, 16, v57
    v_mfma_f32_16x16x32_bf16 a[228:231], a[108:111], a[12:15], a[228:231]
    v_and_b32 v62, s92, v49
    v_and_b32 v63, s92, v57
    v_mfma_f32_16x16x32_bf16 a[224:227], a[104:107], a[0:3], a[224:227]
    v_mul_f32 v60, v60, v61
    v_mul_f32 v62, v62, v63
    v_mfma_f32_16x16x32_bf16 a[224:227], a[108:111], a[4:7], a[224:227]
    v_cvt_pk_bf16_f32 v60, v60, v62
    v_lshlrev_b32 v61, 16, v60
    s_waitcnt lgkmcnt(10)
    v_mfma_f32_16x16x32_bf16 v[128:131], a[112:115], a[0:3], v[128:131]
    ds_read_b64_tr_b16 a[104:105], v28 offset:96
    v_and_b32 v62, s92, v60
    s_waitcnt lgkmcnt(9)
    v_mfma_f32_16x16x32_bf16 v[128:131], a[116:119], a[4:7], v[128:131]
    v_add_f32 v61, v61, v62
    v_add_f32 v30, v30, v61
    v_mfma_f32_16x16x32_bf16 v[132:135], a[112:115], a[8:11], v[132:135]
    ds_read_b64_tr_b16 a[106:107], v28 offset:1888
    v_lshlrev_b32 v60, 16, v50
    v_mfma_f32_16x16x32_bf16 v[132:135], a[116:119], a[12:15], v[132:135]
    v_lshlrev_b32 v61, 16, v58
    v_and_b32 v62, s92, v50
    v_mfma_f32_16x16x32_bf16 v[136:139], a[112:115], a[16:19], v[136:139]
    ds_read_b64_tr_b16 a[108:109], v28 offset:10336
    v_and_b32 v63, s92, v58
    v_mfma_f32_16x16x32_bf16 v[136:139], a[116:119], a[20:23], v[136:139]
    v_mul_f32 v60, v60, v61
    v_mul_f32 v62, v62, v63
    v_mfma_f32_16x16x32_bf16 v[140:143], a[112:115], a[24:27], v[140:143]
    ds_read_b64_tr_b16 a[110:111], v28 offset:12128
    v_cvt_pk_bf16_f32 v60, v60, v62
    v_mfma_f32_16x16x32_bf16 v[140:143], a[116:119], a[28:31], v[140:143]
    v_lshlrev_b32 v61, 16, v60
    v_and_b32 v62, s92, v60
    v_mfma_f32_16x16x32_bf16 v[144:147], a[112:115], a[64:67], v[144:147]
    v_add_f32 v61, v61, v62
    v_add_f32 v30, v30, v61
    v_mfma_f32_16x16x32_bf16 v[144:147], a[116:119], a[68:71], v[144:147]
    v_lshlrev_b32 v60, 16, v51
    v_lshlrev_b32 v61, 16, v59
    v_mfma_f32_16x16x32_bf16 v[148:151], a[112:115], a[72:75], v[148:151]
    v_and_b32 v62, s92, v51
    v_and_b32 v63, s92, v59
    v_mfma_f32_16x16x32_bf16 v[148:151], a[116:119], a[76:79], v[148:151]
    v_mul_f32 v60, v60, v61
    v_mul_f32 v62, v62, v63
    v_mfma_f32_16x16x32_bf16 v[152:155], a[112:115], a[80:83], v[152:155]
    v_cvt_pk_bf16_f32 v60, v60, v62
    v_lshlrev_b32 v61, 16, v60
    v_mfma_f32_16x16x32_bf16 v[152:155], a[116:119], a[84:87], v[152:155]
    v_and_b32 v62, s92, v60
    v_add_f32 v61, v61, v62
    v_mfma_f32_16x16x32_bf16 v[156:159], a[112:115], a[88:91], v[156:159]
    v_add_f32 v30, v30, v61
    v_add_f32_dpp v29, v29, v29 quad_perm:[1,0,3,2] row_mask:0xf bank_mask:0xf
    v_mfma_f32_16x16x32_bf16 v[156:159], a[116:119], a[92:95], v[156:159]
    v_add_f32_dpp v30, v30, v30 quad_perm:[1,0,3,2] row_mask:0xf bank_mask:0xf
    v_add_f32_dpp v29, v29, v29 quad_perm:[2,3,0,1] row_mask:0xf bank_mask:0xf
    s_waitcnt vmcnt(1) lgkmcnt(0)
    s_barrier
    v_mfma_f32_16x16x32_bf16 v[188:191], a[120:123], a[88:91], v[188:191]
    ds_read_b64_tr_b16 a[112:113], v25 offset:40960
    v_add_f32_dpp v30, v30, v30 quad_perm:[2,3,0,1] row_mask:0xf bank_mask:0xf
    v_mfma_f32_16x16x32_bf16 v[188:191], a[124:127], a[92:95], v[188:191]
    v_add_f32_dpp v29, v29, v29 row_half_mirror row_mask:0xf bank_mask:0xf
    v_add_f32_dpp v30, v30, v30 row_half_mirror row_mask:0xf bank_mask:0xf
    v_mfma_f32_16x16x32_bf16 v[184:187], a[120:123], a[80:83], v[184:187]
    ds_read_b64_tr_b16 a[114:115], v25 offset:41216
    v_add_f32_dpp v29, v29, v29 row_mirror row_mask:0xf bank_mask:0xf
    v_mfma_f32_16x16x32_bf16 v[184:187], a[124:127], a[84:87], v[184:187]
    v_add_f32_dpp v30, v30, v30 row_mirror row_mask:0xf bank_mask:0xf
    v_mov_b32 v60, v29
    v_mfma_f32_16x16x32_bf16 v[180:183], a[120:123], a[72:75], v[180:183]
    ds_read_b64_tr_b16 a[116:117], v25 offset:61440
    v_mov_b32 v61, v30
    v_mfma_f32_16x16x32_bf16 v[180:183], a[124:127], a[76:79], v[180:183]
    v_permlane16_swap_b32 v60, v29
    v_permlane16_swap_b32 v61, v30
    v_mfma_f32_16x16x32_bf16 v[176:179], a[120:123], a[64:67], v[176:179]
    ds_read_b64_tr_b16 a[118:119], v25 offset:61696
    v_add_f32 v29, v29, v60
    v_mfma_f32_16x16x32_bf16 v[176:179], a[124:127], a[68:71], v[176:179]
    v_add_f32 v30, v30, v61
    v_mov_b32 v60, v29
    v_mfma_f32_16x16x32_bf16 v[172:175], a[120:123], a[24:27], v[172:175]
    ds_read_b128 a[32:35], v23 offset:32768
    v_mov_b32 v61, v30
    v_mfma_f32_16x16x32_bf16 v[172:175], a[124:127], a[28:31], v[172:175]
    v_permlane32_swap_b32 v60, v29
    v_permlane32_swap_b32 v61, v30
    v_mfma_f32_16x16x32_bf16 v[168:171], a[120:123], a[16:19], v[168:171]
    ds_read_b128 a[36:39], v24 offset:32768
    v_add_f32 v29, v29, v60
    v_mfma_f32_16x16x32_bf16 v[168:171], a[124:127], a[20:23], v[168:171]
    v_add_f32 v30, v30, v61
    v_and_b32 v61, 1, v1
    v_mfma_f32_16x16x32_bf16 v[164:167], a[120:123], a[8:11], v[164:167]
    ds_read_b128 a[40:43], v23 offset:34816
    v_cmp_eq_u32 vcc, 1, v61
    v_mfma_f32_16x16x32_bf16 v[164:167], a[124:127], a[12:15], v[164:167]
    v_and_b32 v63, 2, v1
    v_cndmask_b32 v60, v29, v30, vcc
    v_mfma_f32_16x16x32_bf16 v[160:163], a[120:123], a[0:3], v[160:163]
    ds_read_b128 a[44:47], v24 offset:34816
    v_cvt_pk_bf16_f32 v60, v60, v60
    v_mfma_f32_16x16x32_bf16 v[160:163], a[124:127], a[4:7], v[160:163]
    v_and_b32 v60, s92, v60
    v_mul_f32 v60, 0xbfb8aa3b, v60
    v_mfma_f32_16x16x32_bf16 v[192:195], a[96:99], a[0:3], v[192:195]
    ds_read_b64_tr_b16 a[120:121], v26 offset:40960
    v_exp_f32 v60, v60
    v_mfma_f32_16x16x32_bf16 v[192:195], a[100:103], a[4:7], v[192:195]
    v_cmp_eq_u32 vcc, 2, v63
    v_add_f32 v60, 1.0, v60
    v_mfma_f32_16x16x32_bf16 v[196:199], a[96:99], a[8:11], v[196:199]
    ds_read_b64_tr_b16 a[122:123], v26 offset:41216
    v_rcp_f32 v60, v60
    v_mfma_f32_16x16x32_bf16 v[196:199], a[100:103], a[12:15], v[196:199]
    v_lshlrev_b32 v63, 4, v63
    v_cvt_pk_bf16_f32 v60, v60, v60
    v_mfma_f32_16x16x32_bf16 v[200:203], a[96:99], a[16:19], v[200:203]
    ds_read_b64_tr_b16 a[124:125], v26 offset:61440
    v_and_b32 v60, s92, v60
    v_mfma_f32_16x16x32_bf16 v[200:203], a[100:103], a[20:23], v[200:203]
    v_sub_f32 v62, 1.0, v60
    v_cvt_pk_bf16_f32 v62, v62, v62
    v_mfma_f32_16x16x32_bf16 v[204:207], a[96:99], a[24:27], v[204:207]
    ds_read_b64_tr_b16 a[126:127], v26 offset:61696
    v_and_b32 v62, s92, v62
    v_mfma_f32_16x16x32_bf16 v[204:207], a[100:103], a[28:31], v[204:207]
    v_cndmask_b32 v60, v60, v62, vcc
    v_lshl_add_u32 v63, v61, 2, v63
    v_mfma_f32_16x16x32_bf16 v[208:211], a[96:99], a[64:67], v[208:211]
    ds_read_b128 a[48:51], v23 offset:36864
    v_cmp_gt_u32 vcc, 4, v1
    v_mfma_f32_16x16x32_bf16 v[208:211], a[100:103], a[68:71], v[208:211]
    s_nop 0
    v_cndmask_b32 v63, 2.0, v63, vcc
    buffer_store_dword v60, v63, s[28:31], s87 offen sc1
    v_mfma_f32_16x16x32_bf16 v[212:215], a[96:99], a[72:75], v[212:215]
    ds_read_b128 a[52:55], v24 offset:36864
    v_mfma_f32_16x16x32_bf16 v[212:215], a[100:103], a[76:79], v[212:215]
    v_mfma_f32_16x16x32_bf16 v[216:219], a[96:99], a[80:83], v[216:219]
    ds_read_b128 a[56:59], v23 offset:38912
    v_mfma_f32_16x16x32_bf16 v[216:219], a[100:103], a[84:87], v[216:219]
    v_mfma_f32_16x16x32_bf16 v[220:223], a[96:99], a[88:91], v[220:223]
    ds_read_b128 a[60:63], v24 offset:38912
    v_mfma_f32_16x16x32_bf16 v[220:223], a[100:103], a[92:95], v[220:223]
    v_mfma_f32_16x16x32_bf16 v[252:255], a[104:107], a[88:91], v[252:255]
    ds_read_b64_tr_b16 a[96:97], v27 offset:40960
    v_mfma_f32_16x16x32_bf16 v[252:255], a[108:111], a[92:95], v[252:255]
    v_mfma_f32_16x16x32_bf16 v[248:251], a[104:107], a[80:83], v[248:251]
    ds_read_b128 a[88:91], v23 offset:47104
    v_mfma_f32_16x16x32_bf16 v[248:251], a[108:111], a[84:87], v[248:251]
    ds_read_b128 a[92:95], v24 offset:47104
    v_mfma_f32_16x16x32_bf16 v[244:247], a[104:107], a[72:75], v[244:247]
    ds_read_b128 a[80:83], v23 offset:45056
    v_mfma_f32_16x16x32_bf16 v[244:247], a[108:111], a[76:79], v[244:247]
    ds_read_b128 a[84:87], v24 offset:45056
    v_mfma_f32_16x16x32_bf16 v[240:243], a[104:107], a[64:67], v[240:243]
    v_mfma_f32_16x16x32_bf16 v[240:243], a[108:111], a[68:71], v[240:243]
    ds_read_b128 a[72:75], v23 offset:43008
    v_mfma_f32_16x16x32_bf16 v[236:239], a[104:107], a[24:27], v[236:239]
    ds_read_b128 a[76:79], v24 offset:43008
    v_mfma_f32_16x16x32_bf16 v[236:239], a[108:111], a[28:31], v[236:239]
    ds_read_b128 a[64:67], v23 offset:40960
    v_mfma_f32_16x16x32_bf16 v[232:235], a[104:107], a[16:19], v[232:235]
    ds_read_b128 a[68:71], v24 offset:40960
    v_mfma_f32_16x16x32_bf16 v[232:235], a[108:111], a[20:23], v[232:235]
    ds_read_b64_tr_b16 a[98:99], v27 offset:42752
    v_mfma_f32_16x16x32_bf16 v[228:231], a[104:107], a[8:11], v[228:231]
    v_mfma_f32_16x16x32_bf16 v[228:231], a[108:111], a[12:15], v[228:231]
    ds_read_b64_tr_b16 a[100:101], v27 offset:51200
    v_mfma_f32_16x16x32_bf16 v[224:227], a[104:107], a[0:3], v[224:227]
    v_mfma_f32_16x16x32_bf16 v[224:227], a[108:111], a[4:7], v[224:227]
    ds_read_b64_tr_b16 a[102:103], v27 offset:52992
    s_waitcnt lgkmcnt(15)
    v_mfma_f32_16x16x32_bf16 v[64:67], a[32:35], a[112:115], v[64:67]
    ds_read_b64_tr_b16 a[104:105], v28 offset:40960
    v_mfma_f32_16x16x32_bf16 v[64:67], a[36:39], a[116:119], v[64:67]
    v_and_b32 v33, 7, v1
    v_lshlrev_b32 v33, 2, v33
    v_mfma_f32_16x16x32_bf16 v[68:71], a[40:43], a[112:115], v[68:71]
    ds_read_b64_tr_b16 a[106:107], v28 offset:42752
    buffer_load_dword v34, v33, s[36:39], 0 offen offset:64 sc1
    v_mfma_f32_16x16x32_bf16 v[68:71], a[44:47], a[116:119], v[68:71]
    v_and_b32 v29, 15, v1
    v_lshrrev_b32 v30, 4, v1
    v_mfma_f32_16x16x32_bf16 v[72:75], a[48:51], a[112:115], v[72:75]
    ds_read_b64_tr_b16 a[108:109], v28 offset:51200
    v_lshlrev_b32 v6, 9, v30
    s_waitcnt lgkmcnt(15)
    v_mfma_f32_16x16x32_bf16 v[72:75], a[52:55], a[116:119], v[72:75]
    v_lshlrev_b32 v7, 4, v1
    s_lshl_b32 s45, s41, 6
    v_mfma_f32_16x16x32_bf16 v[76:79], a[56:59], a[112:115], v[76:79]
    ds_read_b64_tr_b16 a[110:111], v28 offset:52992
    s_lshl_b32 s46, s40, 3
    v_mfma_f32_16x16x32_bf16 v[76:79], a[60:63], a[116:119], v[76:79]
    s_add_u32 s45, s45, s46
    s_lshl_b32 s46, s43, 2
    s_waitcnt lgkmcnt(8)
    v_mfma_f32_16x16x32_bf16 v[80:83], a[64:67], a[112:115], v[80:83]
    s_add_u32 s45, s45, s46
    s_lshl_b32 s83, s45, 12
    s_waitcnt lgkmcnt(7)
    v_mfma_f32_16x16x32_bf16 v[80:83], a[68:71], a[116:119], v[80:83]
    s_add_u32 s83, s83, 4194304
    s_add_u32 s84, s83, 4096
    v_mfma_f32_16x16x32_bf16 v[84:87], a[72:75], a[112:115], v[84:87]
    s_add_u32 s82, s83, 8192
    s_add_u32 s80, s83, 12288
    v_mfma_f32_16x16x32_bf16 v[84:87], a[76:79], a[116:119], v[84:87]
    s_lshl_b32 s45, s40, 1
    s_add_u32 s45, s45, s43
    v_mfma_f32_16x16x32_bf16 v[88:91], a[80:83], a[112:115], v[88:91]
    s_mul_i32 s45, s45, 288
    s_mul_i32 s46, s41, 7
    v_mfma_f32_16x16x32_bf16 v[88:91], a[84:87], a[116:119], v[88:91]
    s_add_u32 s45, s45, s46
    s_lshl_b32 s45, s45, 12
    v_mfma_f32_16x16x32_bf16 v[92:95], a[88:91], a[112:115], v[92:95]
    s_add_u32 s50, s45, 12599296
    s_sub_u32 s81, s50, 4096
    v_mfma_f32_16x16x32_bf16 v[92:95], a[92:95], a[116:119], v[92:95]
    s_lshl_b32 s46, s43, 14
    v_lshl_add_u32 v6, v29, 4, v6
    v_mfma_f32_16x16x32_bf16 v[124:127], a[88:91], a[120:123], v[124:127]
    ds_read_b64_tr_b16 a[112:113], v27 offset:40992
    v_add_u32 v8, s46, v6
    v_mfma_f32_16x16x32_bf16 v[124:127], a[92:95], a[124:127], v[124:127]
    v_cvt_pk_bf16_f32 v64, v64, v65
    v_cvt_pk_bf16_f32 v65, v66, v67
    v_mfma_f32_16x16x32_bf16 v[120:123], a[80:83], a[120:123], v[120:123]
    ds_read_b64_tr_b16 a[114:115], v27 offset:42784
    v_cvt_pk_bf16_f32 v66, v68, v69
    v_mfma_f32_16x16x32_bf16 v[120:123], a[84:87], a[124:127], v[120:123]
    v_cvt_pk_bf16_f32 v67, v70, v71
    buffer_store_dwordx4 v[64:67], v6, s[28:31], s83 offen offset:2048 sc1
    v_mfma_f32_16x16x32_bf16 v[116:119], a[72:75], a[120:123], v[116:119]
    ds_read_b64_tr_b16 a[116:117], v27 offset:51232
    ds_write_b128 v8, v[64:67] offset:2048
    v_mfma_f32_16x16x32_bf16 v[116:119], a[76:79], a[124:127], v[116:119]
    v_cvt_pk_bf16_f32 v72, v72, v73
    v_cvt_pk_bf16_f32 v73, v74, v75
    v_mfma_f32_16x16x32_bf16 v[112:115], a[64:67], a[120:123], v[112:115]
    ds_read_b64_tr_b16 a[118:119], v27 offset:53024
    v_cvt_pk_bf16_f32 v74, v76, v77
    v_mfma_f32_16x16x32_bf16 v[112:115], a[68:71], a[124:127], v[112:115]
    v_cvt_pk_bf16_f32 v75, v78, v79
    buffer_store_dwordx4 v[72:75], v6, s[28:31], s84 offen offset:2048 sc1
    v_mfma_f32_16x16x32_bf16 v[108:111], a[56:59], a[120:123], v[108:111]
    ds_write_b128 v8, v[72:75] offset:6144
    v_cvt_pk_bf16_f32 v80, v80, v81
    v_mfma_f32_16x16x32_bf16 v[108:111], a[60:63], a[124:127], v[108:111]
    v_cvt_pk_bf16_f32 v81, v82, v83
    v_cvt_pk_bf16_f32 v82, v84, v85
    v_mfma_f32_16x16x32_bf16 v[104:107], a[48:51], a[120:123], v[104:107]
    v_cvt_pk_bf16_f32 v83, v86, v87
    buffer_store_dwordx4 v[80:83], v6, s[28:31], s82 offen offset:2048 sc1
    v_mfma_f32_16x16x32_bf16 v[104:107], a[52:55], a[124:127], v[104:107]
    ds_write_b128 v8, v[80:83] offset:10240
    v_cvt_pk_bf16_f32 v88, v88, v89
    v_mfma_f32_16x16x32_bf16 v[100:103], a[40:43], a[120:123], v[100:103]
    v_cvt_pk_bf16_f32 v89, v90, v91
    v_cvt_pk_bf16_f32 v90, v92, v93
    v_mfma_f32_16x16x32_bf16 v[100:103], a[44:47], a[124:127], v[100:103]
    v_cvt_pk_bf16_f32 v91, v94, v95
    buffer_store_dwordx4 v[88:91], v6, s[28:31], s80 offen offset:2048 sc1
    v_mfma_f32_16x16x32_bf16 v[96:99], a[32:35], a[120:123], v[96:99]
    ds_write_b128 v8, v[88:91] offset:14336
    v_cvt_pk_bf16_f32 v120, v120, v121
    v_mfma_f32_16x16x32_bf16 v[96:99], a[36:39], a[124:127], v[96:99]
    v_cvt_pk_bf16_f32 v121, v122, v123
    v_cvt_pk_bf16_f32 v122, v124, v125
    s_waitcnt lgkmcnt(14)
    v_mfma_f32_16x16x32_bf16 a[128:131], a[96:99], a[32:35], a[128:131]
    ds_read_b64_tr_b16 a[120:121], v28 offset:40992
    v_cvt_pk_bf16_f32 v123, v126, v127
    s_waitcnt lgkmcnt(13)
    v_mfma_f32_16x16x32_bf16 a[128:131], a[100:103], a[36:39], a[128:131]
    buffer_store_dwordx4 v[120:123], v6, s[28:31], s80 offen offset:2304 sc1
    ds_write_b128 v8, v[120:123] offset:14592
    v_mfma_f32_16x16x32_bf16 a[132:135], a[96:99], a[40:43], a[132:135]
    ds_read_b64_tr_b16 a[122:123], v28 offset:42784
    v_cvt_pk_bf16_f32 v112, v112, v113
    v_mfma_f32_16x16x32_bf16 a[132:135], a[100:103], a[44:47], a[132:135]
    v_cvt_pk_bf16_f32 v113, v114, v115
    v_cvt_pk_bf16_f32 v114, v116, v117
    v_mfma_f32_16x16x32_bf16 a[136:139], a[96:99], a[48:51], a[136:139]
    ds_read_b64_tr_b16 a[124:125], v28 offset:51232
    v_cvt_pk_bf16_f32 v115, v118, v119
    v_mfma_f32_16x16x32_bf16 a[136:139], a[100:103], a[52:55], a[136:139]
    buffer_store_dwordx4 v[112:115], v6, s[28:31], s82 offen offset:2304 sc1
    ds_write_b128 v8, v[112:115] offset:10496
    v_mfma_f32_16x16x32_bf16 a[140:143], a[96:99], a[56:59], a[140:143]
    ds_read_b64_tr_b16 a[126:127], v28 offset:53024
    v_cvt_pk_bf16_f32 v104, v104, v105
    v_mfma_f32_16x16x32_bf16 a[140:143], a[100:103], a[60:63], a[140:143]
    v_cvt_pk_bf16_f32 v105, v106, v107
    v_cvt_pk_bf16_f32 v106, v108, v109
    v_mfma_f32_16x16x32_bf16 a[144:147], a[96:99], a[64:67], a[144:147]
    v_cvt_pk_bf16_f32 v107, v110, v111
    buffer_store_dwordx4 v[104:107], v6, s[28:31], s84 offen offset:2304 sc1
    v_mfma_f32_16x16x32_bf16 a[144:147], a[100:103], a[68:71], a[144:147]
    ds_write_b128 v8, v[104:107] offset:6400
    v_cvt_pk_bf16_f32 v96, v96, v97
    v_mfma_f32_16x16x32_bf16 a[148:151], a[96:99], a[72:75], a[148:151]
    v_cvt_pk_bf16_f32 v97, v98, v99
    v_cvt_pk_bf16_f32 v98, v100, v101
    v_mfma_f32_16x16x32_bf16 a[148:151], a[100:103], a[76:79], a[148:151]
    v_cvt_pk_bf16_f32 v99, v102, v103
    buffer_store_dwordx4 v[96:99], v6, s[28:31], s83 offen offset:2304 sc1
    v_mfma_f32_16x16x32_bf16 a[152:155], a[96:99], a[80:83], a[152:155]
    ds_write_b128 v8, v[96:99] offset:2304
    v_mfma_f32_16x16x32_bf16 a[152:155], a[100:103], a[84:87], a[152:155]
    v_mfma_f32_16x16x32_bf16 a[156:159], a[96:99], a[88:91], a[156:159]
    v_mfma_f32_16x16x32_bf16 a[156:159], a[100:103], a[92:95], a[156:159]
    s_waitcnt lgkmcnt(15)
    v_mfma_f32_16x16x32_bf16 a[188:191], a[104:107], a[88:91], a[188:191]
    ds_read_b64_tr_b16 a[96:97], v27 offset:41024
    v_mfma_f32_16x16x32_bf16 a[188:191], a[108:111], a[92:95], a[188:191]
    v_mfma_f32_16x16x32_bf16 a[184:187], a[104:107], a[80:83], a[184:187]
    ds_read_b64_tr_b16 a[98:99], v27 offset:42816
    v_mfma_f32_16x16x32_bf16 a[184:187], a[108:111], a[84:87], a[184:187]
    v_mfma_f32_16x16x32_bf16 a[180:183], a[104:107], a[72:75], a[180:183]
    ds_read_b64_tr_b16 a[100:101], v27 offset:51264
    v_mfma_f32_16x16x32_bf16 a[180:183], a[108:111], a[76:79], a[180:183]
    v_mfma_f32_16x16x32_bf16 a[176:179], a[104:107], a[64:67], a[176:179]
    ds_read_b64_tr_b16 a[102:103], v27 offset:53056
    v_mfma_f32_16x16x32_bf16 a[176:179], a[108:111], a[68:71], a[176:179]
    v_accvgpr_read_b32 v36, a152
    v_accvgpr_read_b32 v37, a153
    v_mfma_f32_16x16x32_bf16 a[172:175], a[104:107], a[56:59], a[172:175]
    v_accvgpr_read_b32 v38, a154
    v_accvgpr_read_b32 v39, a155
    v_mfma_f32_16x16x32_bf16 a[172:175], a[108:111], a[60:63], a[172:175]
    v_accvgpr_read_b32 v40, a184
    v_accvgpr_read_b32 v41, a185
    v_mfma_f32_16x16x32_bf16 a[168:171], a[104:107], a[48:51], a[168:171]
    v_accvgpr_read_b32 v42, a186
    v_accvgpr_read_b32 v43, a187
    v_mfma_f32_16x16x32_bf16 a[168:171], a[108:111], a[52:55], a[168:171]
    v_mul_f32 v36, v40, v36
    v_mul_f32 v37, v41, v37
    v_mfma_f32_16x16x32_bf16 a[164:167], a[104:107], a[40:43], a[164:167]
    v_mul_f32 v38, v42, v38
    v_mul_f32 v39, v43, v39
    v_mfma_f32_16x16x32_bf16 a[164:167], a[108:111], a[44:47], a[164:167]
    v_accvgpr_read_b32 v44, a156
    v_accvgpr_read_b32 v45, a157
    v_mfma_f32_16x16x32_bf16 a[160:163], a[104:107], a[32:35], a[160:163]
    v_accvgpr_read_b32 v46, a158
    v_accvgpr_read_b32 v47, a159
    v_mfma_f32_16x16x32_bf16 a[160:163], a[108:111], a[36:39], a[160:163]
    v_accvgpr_read_b32 v48, a188
    v_accvgpr_read_b32 v49, a189
    s_waitcnt lgkmcnt(15)
    v_mfma_f32_16x16x32_bf16 a[192:195], a[112:115], a[32:35], a[192:195]
    ds_read_b64_tr_b16 a[104:105], v28 offset:41024
    v_accvgpr_read_b32 v50, a190
    v_mfma_f32_16x16x32_bf16 a[192:195], a[116:119], a[36:39], a[192:195]
    v_accvgpr_read_b32 v51, a191
    v_mul_f32 v44, v48, v44
    v_mfma_f32_16x16x32_bf16 a[196:199], a[112:115], a[40:43], a[196:199]
    ds_read_b64_tr_b16 a[106:107], v28 offset:42816
    v_mul_f32 v45, v49, v45
    v_mfma_f32_16x16x32_bf16 a[196:199], a[116:119], a[44:47], a[196:199]
    v_mul_f32 v46, v50, v46
    v_mul_f32 v47, v51, v47
    v_mfma_f32_16x16x32_bf16 a[200:203], a[112:115], a[48:51], a[200:203]
    ds_read_b64_tr_b16 a[108:109], v28 offset:51264
    v_cvt_pk_bf16_f32 v52, v36, v37
    v_mfma_f32_16x16x32_bf16 a[200:203], a[116:119], a[52:55], a[200:203]
    v_cvt_pk_bf16_f32 v53, v38, v39
    v_cvt_pk_bf16_f32 v54, v44, v45
    v_mfma_f32_16x16x32_bf16 a[204:207], a[112:115], a[56:59], a[204:207]
    ds_read_b64_tr_b16 a[110:111], v28 offset:53056
    v_cvt_pk_bf16_f32 v55, v46, v47
    v_mfma_f32_16x16x32_bf16 a[204:207], a[116:119], a[60:63], a[204:207]
    v_permlane16_swap_b32 v52, v54
    v_permlane16_swap_b32 v53, v55
    v_mfma_f32_16x16x32_bf16 a[208:211], a[112:115], a[64:67], a[208:211]
    buffer_store_dwordx4 v[52:55], v7, s[28:31], s81 offen offset:3072 sc1
    v_accvgpr_read_b32 v36, a144
    v_mfma_f32_16x16x32_bf16 a[208:211], a[116:119], a[68:71], a[208:211]
    v_accvgpr_read_b32 v37, a145
    v_accvgpr_read_b32 v38, a146
    v_mfma_f32_16x16x32_bf16 a[212:215], a[112:115], a[72:75], a[212:215]
    v_accvgpr_read_b32 v39, a147
    v_accvgpr_read_b32 v40, a176
    v_mfma_f32_16x16x32_bf16 a[212:215], a[116:119], a[76:79], a[212:215]
    v_accvgpr_read_b32 v41, a177
    v_accvgpr_read_b32 v42, a178
    v_mfma_f32_16x16x32_bf16 a[216:219], a[112:115], a[80:83], a[216:219]
    v_accvgpr_read_b32 v43, a179
    v_mul_f32 v36, v40, v36
    v_mfma_f32_16x16x32_bf16 a[216:219], a[116:119], a[84:87], a[216:219]
    v_mul_f32 v37, v41, v37
    v_mul_f32 v38, v42, v38
    v_mfma_f32_16x16x32_bf16 a[220:223], a[112:115], a[88:91], a[220:223]
    v_mul_f32 v39, v43, v39
    v_accvgpr_read_b32 v44, a148
    v_mfma_f32_16x16x32_bf16 a[220:223], a[116:119], a[92:95], a[220:223]
    v_accvgpr_read_b32 v45, a149
    v_accvgpr_read_b32 v46, a150
    s_waitcnt lgkmcnt(13)
    v_mfma_f32_16x16x32_bf16 a[252:255], a[120:123], a[88:91], a[252:255]
    ds_read_b64_tr_b16 a[112:113], v27 offset:41056
    v_accvgpr_read_b32 v47, a151
    s_waitcnt lgkmcnt(11)
    v_mfma_f32_16x16x32_bf16 a[252:255], a[124:127], a[92:95], a[252:255]
    v_accvgpr_read_b32 v48, a180
    v_accvgpr_read_b32 v49, a181
    v_mfma_f32_16x16x32_bf16 a[248:251], a[120:123], a[80:83], a[248:251]
    ds_read_b64_tr_b16 a[114:115], v27 offset:42848
    v_accvgpr_read_b32 v50, a182
    v_mfma_f32_16x16x32_bf16 a[248:251], a[124:127], a[84:87], a[248:251]
    v_accvgpr_read_b32 v51, a183
    v_mul_f32 v44, v48, v44
    v_mfma_f32_16x16x32_bf16 a[244:247], a[120:123], a[72:75], a[244:247]
    ds_read_b64_tr_b16 a[116:117], v27 offset:51296
    v_mul_f32 v45, v49, v45
    v_mfma_f32_16x16x32_bf16 a[244:247], a[124:127], a[76:79], a[244:247]
    v_mul_f32 v46, v50, v46
    v_mul_f32 v47, v51, v47
    v_mfma_f32_16x16x32_bf16 a[240:243], a[120:123], a[64:67], a[240:243]
    ds_read_b64_tr_b16 a[118:119], v27 offset:53088
    v_cvt_pk_bf16_f32 v56, v36, v37
    v_mfma_f32_16x16x32_bf16 a[240:243], a[124:127], a[68:71], a[240:243]
    v_cvt_pk_bf16_f32 v57, v38, v39
    v_cvt_pk_bf16_f32 v58, v44, v45
    v_mfma_f32_16x16x32_bf16 a[236:239], a[120:123], a[56:59], a[236:239]
    v_cvt_pk_bf16_f32 v59, v46, v47
    v_permlane16_swap_b32 v56, v58
    v_mfma_f32_16x16x32_bf16 a[236:239], a[124:127], a[60:63], a[236:239]
    v_permlane16_swap_b32 v57, v59
    buffer_store_dwordx4 v[56:59], v7, s[28:31], s81 offen offset:2048 sc1
    v_mfma_f32_16x16x32_bf16 a[232:235], a[120:123], a[48:51], a[232:235]
    v_accvgpr_read_b32 v36, a136
    v_accvgpr_read_b32 v37, a137
    v_mfma_f32_16x16x32_bf16 a[232:235], a[124:127], a[52:55], a[232:235]
    v_accvgpr_read_b32 v38, a138
    v_accvgpr_read_b32 v39, a139
    v_mfma_f32_16x16x32_bf16 a[228:231], a[120:123], a[40:43], a[228:231]
    v_accvgpr_read_b32 v40, a168
    v_accvgpr_read_b32 v41, a169
    v_mfma_f32_16x16x32_bf16 a[228:231], a[124:127], a[44:47], a[228:231]
    v_accvgpr_read_b32 v42, a170
    v_accvgpr_read_b32 v43, a171
    v_mfma_f32_16x16x32_bf16 a[224:227], a[120:123], a[32:35], a[224:227]
    v_mul_f32 v36, v40, v36
    v_mul_f32 v37, v41, v37
    v_mfma_f32_16x16x32_bf16 a[224:227], a[124:127], a[36:39], a[224:227]
    v_mul_f32 v38, v42, v38
    v_mul_f32 v39, v43, v39
    s_waitcnt lgkmcnt(10)
    v_mfma_f32_16x16x32_bf16 v[128:131], a[96:99], a[32:35], v[128:131]
    ds_read_b64_tr_b16 a[120:121], v28 offset:41056
    v_accvgpr_read_b32 v44, a140
    s_waitcnt lgkmcnt(9)
    v_mfma_f32_16x16x32_bf16 v[128:131], a[100:103], a[36:39], v[128:131]
    v_accvgpr_read_b32 v45, a141
    v_accvgpr_read_b32 v46, a142
    v_mfma_f32_16x16x32_bf16 v[132:135], a[96:99], a[40:43], v[132:135]
    ds_read_b64_tr_b16 a[122:123], v28 offset:42848
    v_accvgpr_read_b32 v47, a143
    v_mfma_f32_16x16x32_bf16 v[132:135], a[100:103], a[44:47], v[132:135]
    v_accvgpr_read_b32 v48, a172
    v_accvgpr_read_b32 v49, a173
    v_mfma_f32_16x16x32_bf16 v[136:139], a[96:99], a[48:51], v[136:139]
    ds_read_b64_tr_b16 a[124:125], v28 offset:51296
    v_accvgpr_read_b32 v50, a174
    v_mfma_f32_16x16x32_bf16 v[136:139], a[100:103], a[52:55], v[136:139]
    v_accvgpr_read_b32 v51, a175
    v_mul_f32 v44, v48, v44
    v_mfma_f32_16x16x32_bf16 v[140:143], a[96:99], a[56:59], v[140:143]
    ds_read_b64_tr_b16 a[126:127], v28 offset:53088
    v_mul_f32 v45, v49, v45
    v_mfma_f32_16x16x32_bf16 v[140:143], a[100:103], a[60:63], v[140:143]
    v_mul_f32 v46, v50, v46
    v_mul_f32 v47, v51, v47
    v_mfma_f32_16x16x32_bf16 v[144:147], a[96:99], a[64:67], v[144:147]
    v_cvt_pk_bf16_f32 v60, v36, v37
    v_cvt_pk_bf16_f32 v61, v38, v39
    v_mfma_f32_16x16x32_bf16 v[144:147], a[100:103], a[68:71], v[144:147]
    v_cvt_pk_bf16_f32 v62, v44, v45
    v_cvt_pk_bf16_f32 v63, v46, v47
    v_mfma_f32_16x16x32_bf16 v[148:151], a[96:99], a[72:75], v[148:151]
    v_permlane16_swap_b32 v60, v62
    v_permlane16_swap_b32 v61, v63
    v_mfma_f32_16x16x32_bf16 v[148:151], a[100:103], a[76:79], v[148:151]
    buffer_store_dwordx4 v[60:63], v7, s[28:31], s81 offen offset:1024 sc1
    v_accvgpr_read_b32 v36, a128
    v_mfma_f32_16x16x32_bf16 v[152:155], a[96:99], a[80:83], v[152:155]
    v_accvgpr_read_b32 v37, a129
    v_accvgpr_read_b32 v38, a130
    v_mfma_f32_16x16x32_bf16 v[152:155], a[100:103], a[84:87], v[152:155]
    v_accvgpr_read_b32 v39, a131
    v_accvgpr_read_b32 v40, a160
    v_mfma_f32_16x16x32_bf16 v[156:159], a[96:99], a[88:91], v[156:159]
    v_mov_b32 v29, 1
    s_waitcnt vmcnt(3)
    buffer_store_dword v29, v5, s[32:35], 0 offen sc1
    v_accvgpr_read_b32 v41, a161
    v_mfma_f32_16x16x32_bf16 v[156:159], a[100:103], a[92:95], v[156:159]
    v_accvgpr_read_b32 v42, a162
    v_accvgpr_read_b32 v43, a163
    s_waitcnt lgkmcnt(10)
    v_mfma_f32_16x16x32_bf16 v[188:191], a[104:107], a[88:91], v[188:191]
    v_mul_f32 v36, v40, v36
    v_mul_f32 v37, v41, v37
    s_waitcnt lgkmcnt(8)
    v_mfma_f32_16x16x32_bf16 v[188:191], a[108:111], a[92:95], v[188:191]
    v_mul_f32 v38, v42, v38
    v_mul_f32 v39, v43, v39
    v_mfma_f32_16x16x32_bf16 v[184:187], a[104:107], a[80:83], v[184:187]
    v_accvgpr_read_b32 v44, a132
    v_accvgpr_read_b32 v45, a133
    v_mfma_f32_16x16x32_bf16 v[184:187], a[108:111], a[84:87], v[184:187]
    v_accvgpr_read_b32 v46, a134
    v_accvgpr_read_b32 v47, a135
    v_mfma_f32_16x16x32_bf16 v[180:183], a[104:107], a[72:75], v[180:183]
    v_accvgpr_read_b32 v48, a164
    v_accvgpr_read_b32 v49, a165
    v_mfma_f32_16x16x32_bf16 v[180:183], a[108:111], a[76:79], v[180:183]
    v_accvgpr_read_b32 v50, a166
    v_accvgpr_read_b32 v51, a167
    v_mfma_f32_16x16x32_bf16 v[176:179], a[104:107], a[64:67], v[176:179]
    v_mul_f32 v44, v48, v44
    v_mul_f32 v45, v49, v45
    v_mfma_f32_16x16x32_bf16 v[176:179], a[108:111], a[68:71], v[176:179]
    v_mul_f32 v46, v50, v46
    v_mul_f32 v47, v51, v47
    v_mfma_f32_16x16x32_bf16 v[172:175], a[104:107], a[56:59], v[172:175]
    v_cvt_pk_bf16_f32 v52, v36, v37
    v_cvt_pk_bf16_f32 v53, v38, v39
    v_mfma_f32_16x16x32_bf16 v[172:175], a[108:111], a[60:63], v[172:175]
    v_cvt_pk_bf16_f32 v54, v44, v45
    v_cvt_pk_bf16_f32 v55, v46, v47
    v_mfma_f32_16x16x32_bf16 v[168:171], a[104:107], a[48:51], v[168:171]
    v_permlane16_swap_b32 v52, v54
    v_permlane16_swap_b32 v53, v55
    v_mfma_f32_16x16x32_bf16 v[168:171], a[108:111], a[52:55], v[168:171]
    buffer_store_dwordx4 v[52:55], v7, s[28:31], s81 offen offset:0 sc1
    v_mul_f32 v152, v184, v152
    v_mfma_f32_16x16x32_bf16 v[164:167], a[104:107], a[40:43], v[164:167]
    v_mul_f32 v153, v185, v153
    v_mul_f32 v154, v186, v154
    v_mfma_f32_16x16x32_bf16 v[164:167], a[108:111], a[44:47], v[164:167]
    v_mul_f32 v155, v187, v155
    v_mul_f32 v156, v188, v156
    v_mfma_f32_16x16x32_bf16 v[160:163], a[104:107], a[32:35], v[160:163]
    v_mul_f32 v157, v189, v157
    v_mul_f32 v158, v190, v158
    v_mfma_f32_16x16x32_bf16 v[160:163], a[108:111], a[36:39], v[160:163]
    v_mul_f32 v159, v191, v159
    v_cvt_pk_bf16_f32 v152, v152, v153
    s_waitcnt lgkmcnt(6)
    v_mfma_f32_16x16x32_bf16 v[192:195], a[112:115], a[32:35], v[192:195]
    v_cvt_pk_bf16_f32 v153, v154, v155
    v_cvt_pk_bf16_f32 v154, v156, v157
    s_waitcnt lgkmcnt(4)
    v_mfma_f32_16x16x32_bf16 v[192:195], a[116:119], a[36:39], v[192:195]
    v_cvt_pk_bf16_f32 v155, v158, v159
    v_permlane16_swap_b32 v152, v154
    v_mfma_f32_16x16x32_bf16 v[196:199], a[112:115], a[40:43], v[196:199]
    v_permlane16_swap_b32 v153, v155
    v_accvgpr_read_b32 v36, a216
    v_mfma_f32_16x16x32_bf16 v[196:199], a[116:119], a[44:47], v[196:199]
    v_accvgpr_read_b32 v37, a217
    v_accvgpr_read_b32 v38, a218
    v_mfma_f32_16x16x32_bf16 v[200:203], a[112:115], a[48:51], v[200:203]
    v_accvgpr_read_b32 v39, a219
    v_accvgpr_read_b32 v40, a248
    v_mfma_f32_16x16x32_bf16 v[200:203], a[116:119], a[52:55], v[200:203]
    v_accvgpr_read_b32 v41, a249
    v_accvgpr_read_b32 v42, a250
    v_mfma_f32_16x16x32_bf16 v[204:207], a[112:115], a[56:59], v[204:207]
    v_accvgpr_read_b32 v43, a251
    v_mul_f32 v36, v40, v36
    v_mfma_f32_16x16x32_bf16 v[204:207], a[116:119], a[60:63], v[204:207]
    v_mul_f32 v37, v41, v37
    v_mul_f32 v38, v42, v38
    v_mfma_f32_16x16x32_bf16 v[208:211], a[112:115], a[64:67], v[208:211]
    v_mul_f32 v39, v43, v39
    v_accvgpr_read_b32 v44, a220
    v_mfma_f32_16x16x32_bf16 v[208:211], a[116:119], a[68:71], v[208:211]
    v_accvgpr_read_b32 v45, a221
    v_accvgpr_read_b32 v46, a222
    v_mfma_f32_16x16x32_bf16 v[212:215], a[112:115], a[72:75], v[212:215]
    v_accvgpr_read_b32 v47, a223
    v_accvgpr_read_b32 v48, a252
    v_mfma_f32_16x16x32_bf16 v[212:215], a[116:119], a[76:79], v[212:215]
    v_accvgpr_read_b32 v49, a253
    v_accvgpr_read_b32 v50, a254
    v_mfma_f32_16x16x32_bf16 v[216:219], a[112:115], a[80:83], v[216:219]
    v_accvgpr_read_b32 v51, a255
    v_mul_f32 v44, v48, v44
    v_mfma_f32_16x16x32_bf16 v[216:219], a[116:119], a[84:87], v[216:219]
    v_mul_f32 v45, v49, v45
    v_mul_f32 v46, v50, v46
    v_mfma_f32_16x16x32_bf16 v[220:223], a[112:115], a[88:91], v[220:223]
    v_mul_f32 v47, v51, v47
    v_cvt_pk_bf16_f32 v184, v36, v37
    v_mfma_f32_16x16x32_bf16 v[220:223], a[116:119], a[92:95], v[220:223]
    v_cvt_pk_bf16_f32 v185, v38, v39
    v_cvt_pk_bf16_f32 v186, v44, v45
    s_waitcnt lgkmcnt(2)
    v_mfma_f32_16x16x32_bf16 v[252:255], a[120:123], a[88:91], v[252:255]
    v_cvt_pk_bf16_f32 v187, v46, v47
    v_permlane16_swap_b32 v184, v186
    s_waitcnt lgkmcnt(0)
    v_mfma_f32_16x16x32_bf16 v[252:255], a[124:127], a[92:95], v[252:255]
    v_permlane16_swap_b32 v185, v187
    v_mul_f32 v144, v176, v144
    v_mfma_f32_16x16x32_bf16 v[248:251], a[120:123], a[80:83], v[248:251]
    v_mul_f32 v145, v177, v145
    v_mul_f32 v146, v178, v146
    v_mfma_f32_16x16x32_bf16 v[248:251], a[124:127], a[84:87], v[248:251]
    v_mul_f32 v147, v179, v147
    v_mul_f32 v148, v180, v148
    v_mfma_f32_16x16x32_bf16 v[244:247], a[120:123], a[72:75], v[244:247]
    v_mul_f32 v149, v181, v149
    v_mul_f32 v150, v182, v150
    v_mfma_f32_16x16x32_bf16 v[244:247], a[124:127], a[76:79], v[244:247]
    v_mul_f32 v151, v183, v151
    v_cvt_pk_bf16_f32 v144, v144, v145
    v_mfma_f32_16x16x32_bf16 v[240:243], a[120:123], a[64:67], v[240:243]
    v_cvt_pk_bf16_f32 v145, v146, v147
    v_cvt_pk_bf16_f32 v146, v148, v149
    v_mfma_f32_16x16x32_bf16 v[240:243], a[124:127], a[68:71], v[240:243]
    v_cvt_pk_bf16_f32 v147, v150, v151
    v_permlane16_swap_b32 v144, v146
    v_mfma_f32_16x16x32_bf16 v[236:239], a[120:123], a[56:59], v[236:239]
    v_permlane16_swap_b32 v145, v147
    v_accvgpr_read_b32 v36, a208
    v_mfma_f32_16x16x32_bf16 v[236:239], a[124:127], a[60:63], v[236:239]
    v_accvgpr_read_b32 v37, a209
    v_accvgpr_read_b32 v38, a210
    v_mfma_f32_16x16x32_bf16 v[232:235], a[120:123], a[48:51], v[232:235]
    v_accvgpr_read_b32 v39, a211
    v_accvgpr_read_b32 v40, a240
    v_mfma_f32_16x16x32_bf16 v[232:235], a[124:127], a[52:55], v[232:235]
    v_accvgpr_read_b32 v41, a241
    v_accvgpr_read_b32 v42, a242
    v_mfma_f32_16x16x32_bf16 v[228:231], a[120:123], a[40:43], v[228:231]
    v_accvgpr_read_b32 v43, a243
    v_mul_f32 v36, v40, v36
    v_mfma_f32_16x16x32_bf16 v[228:231], a[124:127], a[44:47], v[228:231]
    v_mul_f32 v37, v41, v37
    v_mul_f32 v38, v42, v38
    v_mfma_f32_16x16x32_bf16 v[224:227], a[120:123], a[32:35], v[224:227]
    v_mul_f32 v39, v43, v39
    v_accvgpr_read_b32 v44, a212
    v_mfma_f32_16x16x32_bf16 v[224:227], a[124:127], a[36:39], v[224:227]
    v_accvgpr_read_b32 v45, a213
    v_accvgpr_read_b32 v46, a214
    v_lshlrev_b32 v16, 4, v1
    s_lshl_b32 s45, s42, 12
    s_add_u32 s45, s45, 147456
    v_add_u32 v17, s45, v16
    s_waitcnt lgkmcnt(0)
    s_barrier
    ds_read_b128 a[40:43], v17 offset:0
    ds_read_b128 a[44:47], v17 offset:1024
    ds_read_b128 a[48:51], v17 offset:2048
    ds_read_b128 a[52:55], v17 offset:3072
    ds_read_b128 a[56:59], v16 offset:0
    ds_read_b128 a[60:63], v16 offset:1024
    ds_read_b128 a[64:67], v16 offset:4096
    ds_read_b128 a[68:71], v16 offset:5120
    v_accvgpr_read_b32 v47, a215
    v_accvgpr_read_b32 v48, a244
    v_accvgpr_read_b32 v49, a245
    v_accvgpr_read_b32 v50, a246
    v_accvgpr_read_b32 v51, a247
    v_pk_mul_f32 v[44:45], v[48:49], v[44:45]
    v_pk_mul_f32 v[46:47], v[50:51], v[46:47]
    v_cvt_pk_bf16_f32 v176, v36, v37
    v_cvt_pk_bf16_f32 v177, v38, v39
    v_cvt_pk_bf16_f32 v178, v44, v45
    v_cvt_pk_bf16_f32 v179, v46, v47
    s_nop 0
    v_permlane16_swap_b32 v176, v178
    v_permlane16_swap_b32 v177, v179
    v_pk_mul_f32 v[136:137], v[168:169], v[136:137]
    v_pk_mul_f32 v[138:139], v[170:171], v[138:139]
    v_pk_mul_f32 v[140:141], v[172:173], v[140:141]
    v_pk_mul_f32 v[142:143], v[174:175], v[142:143]
    v_cvt_pk_bf16_f32 v136, v136, v137
    v_cvt_pk_bf16_f32 v137, v138, v139
    v_cvt_pk_bf16_f32 v138, v140, v141
    v_cvt_pk_bf16_f32 v139, v142, v143
    s_nop 0
    v_permlane16_swap_b32 v136, v138
    v_permlane16_swap_b32 v137, v139
    v_accvgpr_read_b32 v36, a200
    v_accvgpr_read_b32 v37, a201
    s_waitcnt lgkmcnt(3)
    v_mfma_f32_32x32x16_bf16 v[64:79], a[56:59], a[40:43], 0
    v_accvgpr_read_b32 v38, a202
    v_accvgpr_read_b32 v39, a203
    v_accvgpr_read_b32 v40, a232
    v_accvgpr_read_b32 v41, a233
    v_accvgpr_read_b32 v42, a234
    v_accvgpr_read_b32 v43, a235
    v_pk_mul_f32 v[36:37], v[40:41], v[36:37]
    s_waitcnt lgkmcnt(2)
    v_mfma_f32_32x32x16_bf16 v[64:79], a[60:63], a[44:47], v[64:79]
    v_pk_mul_f32 v[38:39], v[42:43], v[38:39]
    v_accvgpr_read_b32 v44, a204
    v_accvgpr_read_b32 v45, a205
    v_accvgpr_read_b32 v46, a206
    v_accvgpr_read_b32 v47, a207
    v_accvgpr_read_b32 v48, a236
    v_accvgpr_read_b32 v49, a237
    v_mfma_f32_32x32x16_bf16 v[80:95], a[56:59], a[48:51], 0
    v_accvgpr_read_b32 v50, a238
    v_accvgpr_read_b32 v51, a239
    v_pk_mul_f32 v[44:45], v[48:49], v[44:45]
    v_pk_mul_f32 v[46:47], v[50:51], v[46:47]
    v_cvt_pk_bf16_f32 v168, v36, v37
    v_cvt_pk_bf16_f32 v169, v38, v39
    v_cvt_pk_bf16_f32 v170, v44, v45
    v_mfma_f32_32x32x16_bf16 v[80:95], a[60:63], a[52:55], v[80:95]
    v_cvt_pk_bf16_f32 v171, v46, v47
    v_permlane16_swap_b32 v168, v170
    s_nop 0
    v_permlane16_swap_b32 v169, v171
    v_pk_mul_f32 v[128:129], v[160:161], v[128:129]
    v_pk_mul_f32 v[130:131], v[162:163], v[130:131]
    v_pk_mul_f32 v[132:133], v[164:165], v[132:133]
    v_pk_mul_f32 v[134:135], v[166:167], v[134:135]
    v_cvt_pk_bf16_f32 v128, v128, v129
    v_cvt_pk_bf16_f32 v129, v130, v131
    v_cvt_pk_bf16_f32 v130, v132, v133
    v_cvt_pk_bf16_f32 v131, v134, v135
    s_nop 0
    v_permlane16_swap_b32 v128, v130
    v_permlane16_swap_b32 v129, v131
    v_accvgpr_read_b32 v36, a192
    v_accvgpr_read_b32 v37, a193
    v_accvgpr_read_b32 v38, a194
    v_accvgpr_read_b32 v39, a195
    v_accvgpr_read_b32 v40, a224
    v_accvgpr_read_b32 v41, a225
    v_accvgpr_read_b32 v42, a226
    v_accvgpr_read_b32 v43, a227
    v_pk_mul_f32 v[36:37], v[40:41], v[36:37]
    v_pk_mul_f32 v[38:39], v[42:43], v[38:39]
    v_accvgpr_read_b32 v44, a196
    v_accvgpr_read_b32 v45, a197
    v_accvgpr_read_b32 v46, a198
    v_accvgpr_read_b32 v47, a199
    v_accvgpr_read_b32 v48, a228
    v_accvgpr_read_b32 v49, a229
    v_accvgpr_read_b32 v50, a230
    v_accvgpr_read_b32 v51, a231
    v_pk_mul_f32 v[44:45], v[48:49], v[44:45]
    v_pk_mul_f32 v[46:47], v[50:51], v[46:47]
    v_cvt_pk_bf16_f32 v160, v36, v37
    v_cvt_pk_bf16_f32 v161, v38, v39
    v_cvt_pk_bf16_f32 v162, v44, v45
    v_cvt_pk_bf16_f32 v163, v46, v47
    s_nop 0
    v_permlane16_swap_b32 v160, v162
    v_permlane16_swap_b32 v161, v163
    v_pk_mul_f32 v[216:217], v[216:217], v[248:249]
    v_pk_mul_f32 v[218:219], v[218:219], v[250:251]
    v_pk_mul_f32 v[220:221], v[220:221], v[252:253]
    v_pk_mul_f32 v[222:223], v[222:223], v[254:255]
    v_cvt_pk_bf16_f32 v216, v216, v217
    v_cvt_pk_bf16_f32 v217, v218, v219
    v_cvt_pk_bf16_f32 v218, v220, v221
    v_cvt_pk_bf16_f32 v219, v222, v223
    s_nop 0
    v_permlane16_swap_b32 v216, v218
    v_permlane16_swap_b32 v217, v219
    v_pk_mul_f32 v[208:209], v[208:209], v[240:241]
    v_pk_mul_f32 v[210:211], v[210:211], v[242:243]
    v_pk_mul_f32 v[212:213], v[212:213], v[244:245]
    v_pk_mul_f32 v[214:215], v[214:215], v[246:247]
    v_cvt_pk_bf16_f32 v208, v208, v209
    v_cvt_pk_bf16_f32 v209, v210, v211
    v_cvt_pk_bf16_f32 v210, v212, v213
    v_cvt_pk_bf16_f32 v211, v214, v215
    s_nop 0
    v_permlane16_swap_b32 v208, v210
    v_permlane16_swap_b32 v209, v211
    v_pk_mul_f32 v[200:201], v[200:201], v[232:233]
    v_pk_mul_f32 v[202:203], v[202:203], v[234:235]
    v_pk_mul_f32 v[204:205], v[204:205], v[236:237]
    v_pk_mul_f32 v[206:207], v[206:207], v[238:239]
    v_cvt_pk_bf16_f32 v200, v200, v201
    v_cvt_pk_bf16_f32 v201, v202, v203
    v_cvt_pk_bf16_f32 v202, v204, v205
    v_cvt_pk_bf16_f32 v203, v206, v207
    s_nop 0
    v_permlane16_swap_b32 v200, v202
    v_permlane16_swap_b32 v201, v203
    v_pk_mul_f32 v[192:193], v[192:193], v[224:225]
    v_pk_mul_f32 v[194:195], v[194:195], v[226:227]
    v_pk_mul_f32 v[196:197], v[196:197], v[228:229]
    v_pk_mul_f32 v[198:199], v[198:199], v[230:231]
    v_cvt_pk_bf16_f32 v192, v192, v193
    v_cvt_pk_bf16_f32 v193, v194, v195
    v_cvt_pk_bf16_f32 v194, v196, v197
    v_cvt_pk_bf16_f32 v195, v198, v199
    s_nop 0
    v_permlane16_swap_b32 v192, v194
    v_permlane16_swap_b32 v193, v195
gated_mix__softmax_full_mha__glu_gated_bilinear__prompt_kernel_join:
    v_cmp_gt_u32 vcc, 32, v34
    s_nop 1
    s_cbranch_vccnz gated_mix__softmax_full_mha__glu_gated_bilinear__prompt_kernel_cnt_spin
gated_mix__softmax_full_mha__glu_gated_bilinear__prompt_kernel_cnt_ok:
    v_lshlrev_b32 v6, 4, v1
    s_lshl_b32 s78, s42, 12
    v_max3_f32 v12, v64, v65, v66
    v_max3_f32 v12, v12, v67, v68
    v_max3_f32 v12, v12, v69, v70
    v_max3_f32 v12, v12, v71, v72
    v_max3_f32 v12, v12, v73, v74
    v_max3_f32 v12, v12, v75, v76
    v_max3_f32 v12, v12, v77, v78
    v_max_f32 v12, v12, v79
    v_max3_f32 v13, v80, v81, v82
    v_max3_f32 v13, v13, v83, v84
    v_max3_f32 v13, v13, v85, v86
    v_max3_f32 v13, v13, v87, v88
    v_max3_f32 v13, v13, v89, v90
    v_max3_f32 v13, v13, v91, v92
    v_max3_f32 v13, v13, v93, v94
    v_max_f32 v13, v13, v95
    v_mov_b32 v14, v12
    s_nop 1
    v_permlane32_swap_b32 v14, v12
    v_max_f32 v12, v12, v14
    v_sub_f32 v96, 0, v12
    v_sub_f32 v97, 0, v12
    v_sub_f32 v98, 0, v12
    v_sub_f32 v99, 0, v12
    v_sub_f32 v100, 0, v12
    v_sub_f32 v101, 0, v12
    v_sub_f32 v102, 0, v12
    v_sub_f32 v103, 0, v12
    v_sub_f32 v104, 0, v12
    v_sub_f32 v105, 0, v12
    v_sub_f32 v106, 0, v12
    v_sub_f32 v107, 0, v12
    v_sub_f32 v108, 0, v12
    v_sub_f32 v109, 0, v12
    v_sub_f32 v110, 0, v12
    v_sub_f32 v111, 0, v12
    s_nop 1
    v_mfma_f32_32x32x16_bf16 v[48:63], a[56:59], a[40:43], v[96:111]
    v_mfma_f32_32x32x16_bf16 v[48:63], a[60:63], a[44:47], v[48:63]
    v_mov_b32 v14, v13
    s_nop 1
    v_permlane32_swap_b32 v14, v13
    v_max_f32 v13, v13, v14
    v_sub_f32 v112, 0, v13
    v_sub_f32 v113, 0, v13
    v_sub_f32 v114, 0, v13
    v_sub_f32 v115, 0, v13
    v_sub_f32 v116, 0, v13
    v_sub_f32 v117, 0, v13
    v_sub_f32 v118, 0, v13
    v_sub_f32 v119, 0, v13
    v_sub_f32 v120, 0, v13
    v_sub_f32 v121, 0, v13
    v_sub_f32 v122, 0, v13
    v_sub_f32 v123, 0, v13
    v_sub_f32 v124, 0, v13
    v_sub_f32 v125, 0, v13
    v_sub_f32 v126, 0, v13
    v_sub_f32 v127, 0, v13
    v_bfe_u32 v12, v1, 2, 1
    v_bfe_u32 v13, v1, 1, 1
    v_mov_b32 v14, 0x3f803f80
    v_or_b32 v11, v12, v13
    v_cmp_eq_u32 vcc, 0, v11
    v_xor_b32 v12, 1, v12
    v_or_b32 v11, v12, v13
    v_cndmask_b32 v32, 0, v14, vcc
    v_cndmask_b32 v33, 0, v14, vcc
    v_cmp_eq_u32 vcc, 0, v11
    v_and_b32 v12, 1, v1
    v_mov_b32 v13, 0xeeeeeeee
    v_cndmask_b32 v34, 0, v14, vcc
    v_cndmask_b32 v35, 0, v14, vcc
    v_cmp_eq_u32 vcc, 0, v12
    v_mov_b32 v14, 0x44444444
    v_add_u32 v9, s78, v6
    v_cndmask_b32 v11, v13, v14, vcc
    v_accvgpr_write_b32 a32, 0
    v_accvgpr_write_b32 a33, 0
    v_accvgpr_write_b32 a36, 0
    v_accvgpr_write_b32 a37, 0
    s_lshl_b32 s45, s41, 18
    s_add_u32 s56, s24, s45
    s_addc_u32 s57, s25, 0
    s_add_u32 s56, s56, 4194304
    s_addc_u32 s57, s57, 0
    s_mov_b32 s58, 262144
    s_mov_b32 s59, 0x00020000
    v_exp_f32 v48, v48
    v_mfma_f32_32x32x16_bf16 v[64:79], a[56:59], a[48:51], v[112:127]
    ds_read_b128 a[72:75], v6 offset:2048
    ds_read_b128 a[76:79], v6 offset:3072
    s_lshl_b32 s76, s40, 15
    s_add_u32 s76, s76, 32768
    s_and_b32 s76, s76, 0x3ffff
    s_movk_i32 s77, 7
    v_and_b32 v13, 31, v1
    v_lshlrev_b32 v15, 2, v13
    s_lshl_b32 s47, s41, 7
    s_add_u32 s47, s47, 4096
    s_add_u32 s89, s50, 4096
    s_add_u32 s90, s50, 8192
    v_exp_f32 v49, v49
    v_exp_f32 v50, v50
    v_cvt_pk_bf16_f32 v80, v48, v49
    v_exp_f32 v51, v51
    v_exp_f32 v52, v52
    v_cvt_pk_bf16_f32 v81, v50, v51
    v_exp_f32 v53, v53
    v_exp_f32 v54, v54
    v_mfma_f32_32x32x16_bf16 v[64:79], a[60:63], a[52:55], v[64:79]
    v_cvt_pk_bf16_f32 v82, v52, v53
    v_exp_f32 v55, v55
    v_exp_f32 v56, v56
    v_cvt_pk_bf16_f32 v83, v54, v55
    v_exp_f32 v57, v57
    v_exp_f32 v58, v58
    v_cvt_pk_bf16_f32 v84, v56, v57
    v_exp_f32 v59, v59
    v_exp_f32 v60, v60
    v_cvt_pk_bf16_f32 v85, v58, v59
    v_exp_f32 v61, v61
    v_exp_f32 v62, v62
    v_cvt_pk_bf16_f32 v86, v60, v61
    v_exp_f32 v63, v63
    v_exp_f32 v64, v64
    v_cvt_pk_bf16_f32 v87, v62, v63
    s_waitcnt lgkmcnt(0)
    v_mfma_f32_32x32x16_bf16 v[48:63], a[64:67], a[40:43], v[96:111]
    ds_read_b128 a[56:59], v6 offset:8192
    ds_read_b128 a[60:63], v6 offset:9216
    buffer_load_dword v28, v15, s[32:35], s47 offen sc1
    s_and_b32 s45, s2, 7
    s_lshr_b32 s46, s2, 3
    s_lshr_b32 s85, s45, 1
    s_lshl_b32 s85, s85, 2
    s_and_b32 s86, s45, 1
    s_lshl_b32 s86, s86, 3
    s_and_b32 s45, s46, 3
    s_add_u32 s85, s85, s45
    s_lshr_b32 s45, s46, 2
    s_add_u32 s86, s86, s45
    v_mfma_f32_32x32x16_bf16 v[48:63], a[68:71], a[44:47], v[48:63]
    s_lshl_b32 s45, s86, 7
    s_lshl_b32 s46, s42, 19
    s_add_u32 s46, s46, s45
    s_add_u32 s68, s8, s46
    s_addc_u32 s69, s9, 0
    s_sub_u32 s70, 2097152, s46
    s_mov_b32 s71, 0x00020000
    s_add_u32 s64, s16, s45
    s_addc_u32 s65, s17, 0
    s_sub_u32 s66, 7340032, s45
    v_exp_f32 v65, v65
    v_exp_f32 v66, v66
    v_mfma_f32_32x32x16_bf16 a[0:15], a[72:75], v[80:83], 0
    s_mov_b32 s67, 0x00020000
    v_cvt_pk_bf16_f32 v88, v64, v65
    v_exp_f32 v67, v67
    v_exp_f32 v68, v68
    v_cvt_pk_bf16_f32 v89, v66, v67
    v_exp_f32 v69, v69
    v_exp_f32 v70, v70
    v_cvt_pk_bf16_f32 v90, v68, v69
    v_exp_f32 v71, v71
    v_mfma_f32_32x32x16_bf16 a[0:15], a[76:79], v[84:87], a[0:15]
    v_exp_f32 v72, v72
    v_cvt_pk_bf16_f32 v91, v70, v71
    v_exp_f32 v73, v73
    v_exp_f32 v74, v74
    v_cvt_pk_bf16_f32 v92, v72, v73
    v_exp_f32 v75, v75
    v_exp_f32 v76, v76
    v_cvt_pk_bf16_f32 v93, v74, v75
    v_exp_f32 v77, v77
    v_smfmac_f32_16x16x64_bf16 a[32:35], v[32:35], v[80:87], v11
    v_exp_f32 v78, v78
    v_cvt_pk_bf16_f32 v94, v76, v77
    v_exp_f32 v79, v79
    v_exp_f32 v48, v48
    v_cvt_pk_bf16_f32 v95, v78, v79
    v_mfma_f32_32x32x16_bf16 v[64:79], a[64:67], a[48:51], v[112:127]
    ds_read_b128 a[80:83], v6 offset:6144
    ds_read_b128 a[84:87], v6 offset:7168
    s_mul_i32 s45, s85, 1179648
    s_add_u32 s45, s45, 12582912
    s_add_u32 s60, s24, s45
    s_addc_u32 s61, s25, 0
    s_mov_b32 s62, 1179648
    s_mov_b32 s63, 0x00020000
    s_mul_i32 s79, s42, 229376
    s_lshl_b32 s80, s79, 3
    s_mov_b32 s87, 0
    s_mul_i32 s81, s42, 20480
    s_add_u32 s81, s81, 65536
    v_lshrrev_b32 v13, 3, v1
    v_mfma_f32_32x32x16_bf16 v[64:79], a[68:71], a[52:55], v[64:79]
    v_and_b32 v14, 2, v13
    v_lshlrev_b32 v14, 1, v14
    v_and_b32 v17, 7, v1
    v_xor_b32 v14, v14, v17
    v_lshlrev_b32 v14, 4, v14
    buffer_store_dwordx4 v[160:163], v6, s[28:31], s50 offen offset:0 sc1
    v_exp_f32 v49, v49
    v_exp_f32 v50, v50
    v_cvt_pk_bf16_f32 v80, v48, v49
    v_exp_f32 v51, v51
    v_mfma_f32_32x32x16_bf16 a[16:31], a[72:75], v[88:91], 0
    v_exp_f32 v52, v52
    v_cvt_pk_bf16_f32 v81, v50, v51
    v_exp_f32 v53, v53
    v_exp_f32 v54, v54
    v_cvt_pk_bf16_f32 v82, v52, v53
    v_exp_f32 v55, v55
    v_exp_f32 v56, v56
    v_cvt_pk_bf16_f32 v83, v54, v55
    v_mfma_f32_32x32x16_bf16 a[16:31], a[76:79], v[92:95], a[16:31]
    v_exp_f32 v57, v57
    v_exp_f32 v58, v58
    v_cvt_pk_bf16_f32 v84, v56, v57
    v_exp_f32 v59, v59
    v_exp_f32 v60, v60
    v_cvt_pk_bf16_f32 v85, v58, v59
    v_exp_f32 v61, v61
    v_exp_f32 v62, v62
    v_smfmac_f32_16x16x64_bf16 a[36:39], v[32:35], v[88:95], v11
    v_cvt_pk_bf16_f32 v86, v60, v61
    v_exp_f32 v63, v63
    v_exp_f32 v64, v64
    v_cvt_pk_bf16_f32 v87, v62, v63
    s_waitcnt lgkmcnt(0)
    v_mfma_f32_32x32x16_bf16 v[48:63], a[56:59], a[40:43], v[96:111]
    ds_read_b128 a[64:67], v6 offset:12288
    ds_read_b128 a[68:71], v6 offset:13312
    v_lshl_add_u32 v16, v13, 11, v14
    v_add_u32 v17, 15360, v16
    v_lshrrev_b32 v13, 5, v1
    v_lshl_add_u32 v18, v13, 13, v16
    v_add_u32 v19, 7168, v18
    v_lshl_add_u32 v20, v13, 10, s81
    v_bfe_u32 v13, v1, 2, 2
    v_lshl_add_u32 v20, v13, 7, v20
    v_bfe_u32 v13, v1, 3, 1
    v_lshl_add_u32 v20, v13, 6, v20
    v_bfe_u32 v13, v1, 4, 1
    v_mfma_f32_32x32x16_bf16 v[48:63], a[60:63], a[44:47], v[48:63]
    v_lshl_add_u32 v20, v13, 5, v20
    v_and_b32 v13, 3, v1
    v_lshl_add_u32 v20, v13, 3, v20
    v_xor_b32 v21, 64, v20
    v_mov_b32 v8, v6
    v_add_u32 v7, 32768, v6
    buffer_store_dwordx4 v[168:171], v6, s[28:31], s50 offen offset:1024 sc1
    v_exp_f32 v65, v65
    v_exp_f32 v66, v66
    v_cvt_pk_bf16_f32 v88, v64, v65
    v_mfma_f32_32x32x16_bf16 a[0:15], a[80:83], v[80:83], a[0:15]
    v_exp_f32 v67, v67
    v_exp_f32 v68, v68
    v_cvt_pk_bf16_f32 v89, v66, v67
    v_exp_f32 v69, v69
    v_exp_f32 v70, v70
    v_cvt_pk_bf16_f32 v90, v68, v69
    v_exp_f32 v71, v71
    v_exp_f32 v72, v72
    v_mfma_f32_32x32x16_bf16 a[0:15], a[84:87], v[84:87], a[0:15]
    v_cvt_pk_bf16_f32 v91, v70, v71
    v_exp_f32 v73, v73
    v_exp_f32 v74, v74
    v_cvt_pk_bf16_f32 v92, v72, v73
    v_exp_f32 v75, v75
    v_exp_f32 v76, v76
    v_cvt_pk_bf16_f32 v93, v74, v75
    v_exp_f32 v77, v77
    v_smfmac_f32_16x16x64_bf16 a[32:35], v[32:35], v[80:87], v11
    v_exp_f32 v78, v78
    v_cvt_pk_bf16_f32 v94, v76, v77
    v_exp_f32 v79, v79
    v_exp_f32 v48, v48
    v_cvt_pk_bf16_f32 v95, v78, v79
    v_mfma_f32_32x32x16_bf16 v[64:79], a[56:59], a[48:51], v[112:127]
    ds_read_b128 a[72:75], v6 offset:10240
    ds_read_b128 a[76:79], v6 offset:11264
    s_add_u32 s45, s42, 1
    s_and_b32 s45, s45, 3
    s_lshl_b32 s45, s45, 10
    v_add_u32 v36, s45, v6
    s_add_u32 s45, s42, 2
    s_and_b32 s45, s45, 3
    s_lshl_b32 s45, s45, 10
    v_add_u32 v37, s45, v6
    s_add_u32 s45, s42, 3
    s_and_b32 s45, s45, 3
    s_lshl_b32 s45, s45, 10
    v_add_u32 v38, s45, v6
    v_mfma_f32_32x32x16_bf16 v[64:79], a[60:63], a[52:55], v[64:79]
    s_add_u32 s45, s42, 4
    s_and_b32 s45, s45, 3
    s_lshl_b32 s45, s45, 10
    v_add_u32 v39, s45, v6
    buffer_store_dwordx4 v[176:179], v6, s[28:31], s50 offen offset:2048 sc1
    v_exp_f32 v49, v49
    v_exp_f32 v50, v50
    v_cvt_pk_bf16_f32 v80, v48, v49
    v_exp_f32 v51, v51
    v_mfma_f32_32x32x16_bf16 a[16:31], a[80:83], v[88:91], a[16:31]
    v_exp_f32 v52, v52
    v_cvt_pk_bf16_f32 v81, v50, v51
    v_exp_f32 v53, v53
    v_exp_f32 v54, v54
    v_cvt_pk_bf16_f32 v82, v52, v53
    v_exp_f32 v55, v55
    v_exp_f32 v56, v56
    v_cvt_pk_bf16_f32 v83, v54, v55
    v_mfma_f32_32x32x16_bf16 a[16:31], a[84:87], v[92:95], a[16:31]
    v_exp_f32 v57, v57
    v_exp_f32 v58, v58
    v_cvt_pk_bf16_f32 v84, v56, v57
    v_exp_f32 v59, v59
    v_exp_f32 v60, v60
    v_cvt_pk_bf16_f32 v85, v58, v59
    v_exp_f32 v61, v61
    v_exp_f32 v62, v62
    v_smfmac_f32_16x16x64_bf16 a[36:39], v[32:35], v[88:95], v11
    v_cvt_pk_bf16_f32 v86, v60, v61
    v_exp_f32 v63, v63
    v_exp_f32 v64, v64
    v_cvt_pk_bf16_f32 v87, v62, v63
    s_waitcnt lgkmcnt(0)
    v_mfma_f32_32x32x16_bf16 v[48:63], a[64:67], a[40:43], v[96:111]
    ds_read_b128 a[56:59], v6 offset:16384
    ds_read_b128 a[60:63], v6 offset:17408
    s_add_u32 m0, s78, 32768
    s_waitcnt vmcnt(3)
    v_cmp_gt_u32 vcc, 1, v28
    s_nop 1
    s_cbranch_vccnz gated_mix__softmax_full_mha__glu_gated_bilinear__prompt_kernel_kv_spin
gated_mix__softmax_full_mha__glu_gated_bilinear__prompt_kernel_kv_ok:
    buffer_load_dwordx4 v9, s[56:59], s76 offen offset:0 lds
    v_exp_f32 v65, v65
    v_exp_f32 v66, v66
    v_mfma_f32_32x32x16_bf16 v[48:63], a[68:71], a[44:47], v[48:63]
    v_cvt_pk_bf16_f32 v88, v64, v65
    v_exp_f32 v67, v67
    v_exp_f32 v68, v68
    v_cvt_pk_bf16_f32 v89, v66, v67
    v_exp_f32 v69, v69
    v_exp_f32 v70, v70
    v_cvt_pk_bf16_f32 v90, v68, v69
    v_mfma_f32_32x32x16_bf16 a[0:15], a[72:75], v[80:83], a[0:15]
    buffer_load_dwordx4 v9, s[56:59], s76 offen offset:1024 lds
    v_exp_f32 v71, v71
    v_exp_f32 v72, v72
    v_cvt_pk_bf16_f32 v91, v70, v71
    v_exp_f32 v73, v73
    v_exp_f32 v74, v74
    v_cvt_pk_bf16_f32 v92, v72, v73
    v_mfma_f32_32x32x16_bf16 a[0:15], a[76:79], v[84:87], a[0:15]
    v_exp_f32 v75, v75
    v_exp_f32 v76, v76
    v_cvt_pk_bf16_f32 v93, v74, v75
    v_exp_f32 v77, v77
    v_exp_f32 v78, v78
    v_cvt_pk_bf16_f32 v94, v76, v77
    v_exp_f32 v79, v79
    v_smfmac_f32_16x16x64_bf16 a[32:35], v[32:35], v[80:87], v11
    buffer_store_dwordx4 v[184:187], v6, s[28:31], s50 offen offset:3072 sc1
    v_exp_f32 v48, v48
    v_cvt_pk_bf16_f32 v95, v78, v79
    v_mfma_f32_32x32x16_bf16 v[64:79], a[64:67], a[48:51], v[112:127]
    ds_read_b128 a[80:83], v6 offset:14336
    ds_read_b128 a[84:87], v6 offset:15360
    buffer_load_dwordx4 v9, s[56:59], s76 offen offset:2048 lds
    v_exp_f32 v49, v49
    v_exp_f32 v50, v50
    v_cvt_pk_bf16_f32 v80, v48, v49
    v_exp_f32 v51, v51
    v_mfma_f32_32x32x16_bf16 v[64:79], a[68:71], a[52:55], v[64:79]
    v_exp_f32 v52, v52
    v_cvt_pk_bf16_f32 v81, v50, v51
    v_exp_f32 v53, v53
    v_exp_f32 v54, v54
    v_cvt_pk_bf16_f32 v82, v52, v53
    v_exp_f32 v55, v55
    v_mfma_f32_32x32x16_bf16 a[16:31], a[72:75], v[88:91], a[16:31]
    buffer_load_dwordx4 v9, s[56:59], s76 offen offset:3072 lds
    s_add_u32 s76, s76, 16384
    s_and_b32 s76, s76, 0x3ffff
    v_exp_f32 v56, v56
    v_cvt_pk_bf16_f32 v83, v54, v55
    v_exp_f32 v57, v57
    v_exp_f32 v58, v58
    v_mfma_f32_32x32x16_bf16 a[16:31], a[76:79], v[92:95], a[16:31]
    v_cvt_pk_bf16_f32 v84, v56, v57
    v_exp_f32 v59, v59
    v_exp_f32 v60, v60
    v_cvt_pk_bf16_f32 v85, v58, v59
    v_exp_f32 v61, v61
    v_exp_f32 v62, v62
    v_cvt_pk_bf16_f32 v86, v60, v61
    v_smfmac_f32_16x16x64_bf16 a[36:39], v[32:35], v[88:95], v11
    v_exp_f32 v63, v63
    v_exp_f32 v64, v64
    v_cvt_pk_bf16_f32 v87, v62, v63
    s_waitcnt lgkmcnt(0)
    v_mfma_f32_32x32x16_bf16 v[48:63], a[56:59], a[40:43], v[96:111]
    ds_read_b128 a[64:67], v6 offset:20480
    ds_read_b128 a[68:71], v6 offset:21504
    s_add_u32 m0, s78, 49152
    s_nop 0
    buffer_load_dwordx4 v9, s[56:59], s76 offen offset:0 lds
    v_exp_f32 v65, v65
    v_exp_f32 v66, v66
    v_cvt_pk_bf16_f32 v88, v64, v65
    v_mfma_f32_32x32x16_bf16 v[48:63], a[60:63], a[44:47], v[48:63]
    v_exp_f32 v67, v67
    v_exp_f32 v68, v68
    v_cvt_pk_bf16_f32 v89, v66, v67
    v_exp_f32 v69, v69
    v_exp_f32 v70, v70
    v_cvt_pk_bf16_f32 v90, v68, v69
    v_mfma_f32_32x32x16_bf16 a[0:15], a[80:83], v[80:83], a[0:15]
    buffer_load_dwordx4 v9, s[56:59], s76 offen offset:1024 lds
    v_exp_f32 v71, v71
    v_exp_f32 v72, v72
    v_cvt_pk_bf16_f32 v91, v70, v71
    v_exp_f32 v73, v73
    v_exp_f32 v74, v74
    v_cvt_pk_bf16_f32 v92, v72, v73
    v_mfma_f32_32x32x16_bf16 a[0:15], a[84:87], v[84:87], a[0:15]
    v_exp_f32 v75, v75
    v_exp_f32 v76, v76
    v_cvt_pk_bf16_f32 v93, v74, v75
    v_exp_f32 v77, v77
    v_exp_f32 v78, v78
    v_cvt_pk_bf16_f32 v94, v76, v77
    v_exp_f32 v79, v79
    v_smfmac_f32_16x16x64_bf16 a[32:35], v[32:35], v[80:87], v11
    buffer_store_dwordx4 v[128:131], v6, s[28:31], s89 offen offset:0 sc1
    v_exp_f32 v48, v48
    v_cvt_pk_bf16_f32 v95, v78, v79
    v_mfma_f32_32x32x16_bf16 v[64:79], a[56:59], a[48:51], v[112:127]
    ds_read_b128 a[72:75], v6 offset:18432
    ds_read_b128 a[76:79], v6 offset:19456
    buffer_load_dwordx4 v9, s[56:59], s76 offen offset:2048 lds
    v_exp_f32 v49, v49
    v_exp_f32 v50, v50
    v_cvt_pk_bf16_f32 v80, v48, v49
    v_exp_f32 v51, v51
    v_mfma_f32_32x32x16_bf16 v[64:79], a[60:63], a[52:55], v[64:79]
    v_exp_f32 v52, v52
    v_cvt_pk_bf16_f32 v81, v50, v51
    v_exp_f32 v53, v53
    v_exp_f32 v54, v54
    v_cvt_pk_bf16_f32 v82, v52, v53
    v_exp_f32 v55, v55
    v_exp_f32 v56, v56
    v_mfma_f32_32x32x16_bf16 a[16:31], a[80:83], v[88:91], a[16:31]
    buffer_load_dwordx4 v9, s[56:59], s76 offen offset:3072 lds
    s_add_u32 s76, s76, 16384
    v_cvt_pk_bf16_f32 v83, v54, v55
    v_exp_f32 v57, v57
    v_exp_f32 v58, v58
    v_cvt_pk_bf16_f32 v84, v56, v57
    v_exp_f32 v59, v59
    v_mfma_f32_32x32x16_bf16 a[16:31], a[84:87], v[92:95], a[16:31]
    s_and_b32 s76, s76, 0x3ffff
    v_exp_f32 v60, v60
    v_cvt_pk_bf16_f32 v85, v58, v59
    v_exp_f32 v61, v61
    v_exp_f32 v62, v62
    v_cvt_pk_bf16_f32 v86, v60, v61
    v_exp_f32 v63, v63
    v_smfmac_f32_16x16x64_bf16 a[36:39], v[32:35], v[88:95], v11
    buffer_store_dwordx4 v[136:139], v6, s[28:31], s89 offen offset:1024 sc1
    v_exp_f32 v64, v64
    v_cvt_pk_bf16_f32 v87, v62, v63
    s_waitcnt lgkmcnt(0)
    v_mfma_f32_32x32x16_bf16 v[48:63], a[64:67], a[40:43], v[96:111]
    ds_read_b128 a[56:59], v6 offset:24576
    ds_read_b128 a[60:63], v6 offset:25600
    buffer_store_dwordx4 v[144:147], v6, s[28:31], s89 offen offset:2048 sc1
    v_exp_f32 v65, v65
    v_exp_f32 v66, v66
    v_cvt_pk_bf16_f32 v88, v64, v65
    v_mfma_f32_32x32x16_bf16 v[48:63], a[68:71], a[44:47], v[48:63]
    v_exp_f32 v67, v67
    v_exp_f32 v68, v68
    v_cvt_pk_bf16_f32 v89, v66, v67
    v_exp_f32 v69, v69
    v_exp_f32 v70, v70
    v_cvt_pk_bf16_f32 v90, v68, v69
    v_mfma_f32_32x32x16_bf16 a[0:15], a[72:75], v[80:83], a[0:15]
    v_exp_f32 v71, v71
    v_exp_f32 v72, v72
    v_cvt_pk_bf16_f32 v91, v70, v71
    v_exp_f32 v73, v73
    v_exp_f32 v74, v74
    v_cvt_pk_bf16_f32 v92, v72, v73
    v_mfma_f32_32x32x16_bf16 a[0:15], a[76:79], v[84:87], a[0:15]
    v_exp_f32 v75, v75
    v_exp_f32 v76, v76
    v_cvt_pk_bf16_f32 v93, v74, v75
    v_exp_f32 v77, v77
    v_exp_f32 v78, v78
    v_cvt_pk_bf16_f32 v94, v76, v77
    v_smfmac_f32_16x16x64_bf16 a[32:35], v[32:35], v[80:87], v11
    v_exp_f32 v79, v79
    v_exp_f32 v48, v48
    v_cvt_pk_bf16_f32 v95, v78, v79
    v_mfma_f32_32x32x16_bf16 v[64:79], a[64:67], a[48:51], v[112:127]
    ds_read_b128 a[80:83], v6 offset:22528
    ds_read_b128 a[84:87], v6 offset:23552
    buffer_store_dwordx4 v[152:155], v6, s[28:31], s89 offen offset:3072 sc1
    v_and_b32 v13, 7, v1
    v_bfe_u32 v14, v1, 4, 1
    v_lshl_add_u32 v10, v14, 3, v13
    v_bfe_u32 v14, v1, 3, 1
    v_lshl_add_u32 v10, v14, 4, v10
    v_lshrrev_b32 v14, 3, v10
    v_lshlrev_b32 v14, 7, v14
    v_lshl_add_u32 v30, v13, 2, v14
    v_mfma_f32_32x32x16_bf16 v[64:79], a[68:71], a[52:55], v[64:79]
    v_lshlrev_b32 v10, 4, v10
    v_lshrrev_b32 v14, 5, v1
    v_exp_f32 v49, v49
    v_exp_f32 v50, v50
    v_cvt_pk_bf16_f32 v80, v48, v49
    v_exp_f32 v51, v51
    v_exp_f32 v52, v52
    v_cvt_pk_bf16_f32 v81, v50, v51
    v_mfma_f32_32x32x16_bf16 a[16:31], a[72:75], v[88:91], a[16:31]
    v_exp_f32 v53, v53
    v_exp_f32 v54, v54
    v_cvt_pk_bf16_f32 v82, v52, v53
    v_exp_f32 v55, v55
    v_exp_f32 v56, v56
    v_cvt_pk_bf16_f32 v83, v54, v55
    v_exp_f32 v57, v57
    v_mfma_f32_32x32x16_bf16 a[16:31], a[76:79], v[92:95], a[16:31]
    v_exp_f32 v58, v58
    v_cvt_pk_bf16_f32 v84, v56, v57
    v_exp_f32 v59, v59
    v_exp_f32 v60, v60
    v_cvt_pk_bf16_f32 v85, v58, v59
    v_exp_f32 v61, v61
    v_exp_f32 v62, v62
    v_smfmac_f32_16x16x64_bf16 a[36:39], v[32:35], v[88:95], v11
    v_cvt_pk_bf16_f32 v86, v60, v61
    v_exp_f32 v63, v63
    v_exp_f32 v64, v64
    v_cvt_pk_bf16_f32 v87, v62, v63
    s_waitcnt lgkmcnt(0)
    v_mfma_f32_32x32x16_bf16 v[48:63], a[56:59], a[40:43], v[96:111]
    ds_read_b128 a[64:67], v6 offset:28672
    ds_read_b128 a[68:71], v6 offset:29696
    v_lshl_add_u32 v10, v14, 9, v10
    v_bfe_u32 v14, v1, 3, 2
    v_lshlrev_b32 v14, 7, v14
    v_lshl_add_u32 v31, v13, 2, v14
    s_lshl_b32 s45, s40, 1
    s_add_u32 s45, s45, s43
    s_mul_i32 s45, s45, 288
    s_lshl_b32 s46, s41, 1
    s_add_u32 s45, s45, s46
    s_add_u32 s45, s45, 224
    v_mfma_f32_32x32x16_bf16 v[48:63], a[60:63], a[44:47], v[48:63]
    v_exp_f32 v65, v65
    v_exp_f32 v66, v66
    v_cvt_pk_bf16_f32 v88, v64, v65
    v_exp_f32 v67, v67
    v_exp_f32 v68, v68
    v_cvt_pk_bf16_f32 v89, v66, v67
    v_exp_f32 v69, v69
    v_mfma_f32_32x32x16_bf16 a[0:15], a[80:83], v[80:83], a[0:15]
    v_exp_f32 v70, v70
    v_cvt_pk_bf16_f32 v90, v68, v69
    v_exp_f32 v71, v71
    v_exp_f32 v72, v72
    v_cvt_pk_bf16_f32 v91, v70, v71
    v_exp_f32 v73, v73
    v_exp_f32 v74, v74
    v_mfma_f32_32x32x16_bf16 a[0:15], a[84:87], v[84:87], a[0:15]
    v_cvt_pk_bf16_f32 v92, v72, v73
    v_exp_f32 v75, v75
    v_exp_f32 v76, v76
    v_cvt_pk_bf16_f32 v93, v74, v75
    v_exp_f32 v77, v77
    v_exp_f32 v78, v78
    v_cvt_pk_bf16_f32 v94, v76, v77
    v_smfmac_f32_16x16x64_bf16 a[32:35], v[32:35], v[80:87], v11
    v_exp_f32 v79, v79
    v_exp_f32 v48, v48
    v_cvt_pk_bf16_f32 v95, v78, v79
    v_mfma_f32_32x32x16_bf16 v[64:79], a[56:59], a[48:51], v[112:127]
    ds_read_b128 a[72:75], v6 offset:26624
    ds_read_b128 a[76:79], v6 offset:27648
    s_add_u32 m0, s81, 8192
    buffer_store_dwordx4 v[192:195], v6, s[28:31], s90 offen offset:0 sc1
    s_lshl_b32 s45, s45, 12
    s_lshl_b32 s46, s44, 11
    s_add_u32 s45, s45, s46
    s_add_u32 s82, s45, 12582912
    s_add_u32 s83, s82, 4096
    s_mov_b32 s84, 0x53800000
    v_lshlrev_b32 v15, 3, v1
    s_lshr_b32 s47, s85, 1
    s_lshl_b32 s47, s47, 9
    s_add_u32 s45, s78, 147456
    s_sub_u32 s45, s45, s81
    v_mfma_f32_32x32x16_bf16 v[64:79], a[60:63], a[52:55], v[64:79]
    v_add_u32 v40, s45, v20
    v_add_u32 v41, s45, v21
    buffer_load_dwordx4 v18, s[68:71], s87 offen offset:0 lds
    buffer_load_dwordx4 v19, s[68:71], s87 offen offset:1024 lds
    s_add_u32 m0, s81, 10240
    s_add_u32 s87, s87, 32768
    v_exp_f32 v49, v49
    v_exp_f32 v50, v50
    v_cvt_pk_bf16_f32 v80, v48, v49
    v_exp_f32 v51, v51
    v_mfma_f32_32x32x16_bf16 a[16:31], a[80:83], v[88:91], a[16:31]
    buffer_load_dwordx4 v18, s[68:71], s87 offen offset:0 lds
    v_exp_f32 v52, v52
    v_cvt_pk_bf16_f32 v81, v50, v51
    v_exp_f32 v53, v53
    v_exp_f32 v54, v54
    v_cvt_pk_bf16_f32 v82, v52, v53
    v_exp_f32 v55, v55
    v_exp_f32 v56, v56
    v_cvt_pk_bf16_f32 v83, v54, v55
    v_mfma_f32_32x32x16_bf16 a[16:31], a[84:87], v[92:95], a[16:31]
    v_exp_f32 v57, v57
    v_exp_f32 v58, v58
    v_cvt_pk_bf16_f32 v84, v56, v57
    v_exp_f32 v59, v59
    v_exp_f32 v60, v60
    v_cvt_pk_bf16_f32 v85, v58, v59
    v_exp_f32 v61, v61
    v_exp_f32 v62, v62
    v_cvt_pk_bf16_f32 v86, v60, v61
    v_smfmac_f32_16x16x64_bf16 a[36:39], v[32:35], v[88:95], v11
    buffer_load_dwordx4 v19, s[68:71], s87 offen offset:1024 lds
    s_add_u32 s87, s87, 32768
    v_exp_f32 v63, v63
    v_exp_f32 v64, v64
    v_cvt_pk_bf16_f32 v87, v62, v63
    s_waitcnt lgkmcnt(0)
    v_mfma_f32_32x32x16_bf16 v[48:63], a[64:67], a[40:43], v[96:111]
    s_waitcnt vmcnt(13)
    s_barrier
    ds_read_b128 a[56:59], v6 offset:32768
    ds_read_b128 a[60:63], v6 offset:33792
    s_add_u32 m0, s78, 0
    s_nop 0
    buffer_load_dwordx4 v9, s[56:59], s76 offen offset:0 lds
    v_exp_f32 v65, v65
    v_exp_f32 v66, v66
    v_cvt_pk_bf16_f32 v88, v64, v65
    v_mfma_f32_32x32x16_bf16 v[48:63], a[68:71], a[44:47], v[48:63]
    buffer_load_dwordx4 v9, s[56:59], s76 offen offset:1024 lds
    v_exp_f32 v67, v67
    v_exp_f32 v68, v68
    v_cvt_pk_bf16_f32 v89, v66, v67
    v_exp_f32 v69, v69
    v_exp_f32 v70, v70
    v_cvt_pk_bf16_f32 v90, v68, v69
    v_mfma_f32_32x32x16_bf16 a[0:15], a[72:75], v[80:83], a[0:15]
    buffer_load_dwordx4 v9, s[56:59], s76 offen offset:2048 lds
    v_exp_f32 v71, v71
    v_exp_f32 v72, v72
    v_cvt_pk_bf16_f32 v91, v70, v71
    v_exp_f32 v73, v73
    v_exp_f32 v74, v74
    v_cvt_pk_bf16_f32 v92, v72, v73
    v_mfma_f32_32x32x16_bf16 a[0:15], a[76:79], v[84:87], a[0:15]
    v_exp_f32 v75, v75
    v_exp_f32 v76, v76
    v_cvt_pk_bf16_f32 v93, v74, v75
    v_exp_f32 v77, v77
    v_exp_f32 v78, v78
    v_cvt_pk_bf16_f32 v94, v76, v77
    v_exp_f32 v79, v79
    v_smfmac_f32_16x16x64_bf16 a[32:35], v[32:35], v[80:87], v11
    buffer_load_dwordx4 v9, s[56:59], s76 offen offset:3072 lds
    v_exp_f32 v48, v48
    v_cvt_pk_bf16_f32 v95, v78, v79
    v_mfma_f32_32x32x16_bf16 v[64:79], a[64:67], a[48:51], v[112:127]
    ds_read_b128 a[80:83], v6 offset:30720
    ds_read_b128 a[84:87], v6 offset:31744
    s_add_u32 m0, s81, 12288
    s_add_u32 s76, s76, 16384
    s_and_b32 s76, s76, 0x3ffff
    buffer_store_dwordx4 v[200:203], v6, s[28:31], s90 offen offset:1024 sc1
    buffer_load_dwordx4 v18, s[68:71], s87 offen offset:0 lds
    buffer_load_dwordx4 v19, s[68:71], s87 offen offset:1024 lds
    v_exp_f32 v49, v49
    v_mfma_f32_32x32x16_bf16 v[64:79], a[68:71], a[52:55], v[64:79]
    s_add_u32 m0, s81, 14336
    v_exp_f32 v50, v50
    v_cvt_pk_bf16_f32 v80, v48, v49
    v_exp_f32 v51, v51
    v_exp_f32 v52, v52
    v_cvt_pk_bf16_f32 v81, v50, v51
    v_exp_f32 v53, v53
    v_exp_f32 v54, v54
    v_mfma_f32_32x32x16_bf16 a[16:31], a[72:75], v[88:91], a[16:31]
    s_add_u32 s87, s87, 32768
    buffer_load_dwordx4 v18, s[68:71], s87 offen offset:0 lds
    v_cvt_pk_bf16_f32 v82, v52, v53
    v_exp_f32 v55, v55
    v_exp_f32 v56, v56
    v_cvt_pk_bf16_f32 v83, v54, v55
    v_exp_f32 v57, v57
    v_exp_f32 v58, v58
    v_mfma_f32_32x32x16_bf16 a[16:31], a[76:79], v[92:95], a[16:31]
    v_cvt_pk_bf16_f32 v84, v56, v57
    v_exp_f32 v59, v59
    v_exp_f32 v60, v60
    v_cvt_pk_bf16_f32 v85, v58, v59
    v_exp_f32 v61, v61
    v_exp_f32 v62, v62
    v_cvt_pk_bf16_f32 v86, v60, v61
    v_exp_f32 v63, v63
    v_smfmac_f32_16x16x64_bf16 a[36:39], v[32:35], v[88:95], v11
    buffer_load_dwordx4 v19, s[68:71], s87 offen offset:1024 lds
    s_add_u32 s87, s87, 32768
    v_exp_f32 v64, v64
    v_cvt_pk_bf16_f32 v87, v62, v63
    s_waitcnt lgkmcnt(0)
    v_mfma_f32_32x32x16_bf16 v[48:63], a[56:59], a[40:43], v[96:111]
    ds_read_b128 a[64:67], v6 offset:36864
    ds_read_b128 a[68:71], v6 offset:37888
    buffer_store_dwordx4 v[208:211], v6, s[28:31], s90 offen offset:2048 sc1
    v_exp_f32 v65, v65
    v_exp_f32 v66, v66
    v_cvt_pk_bf16_f32 v88, v64, v65
    v_mfma_f32_32x32x16_bf16 v[48:63], a[60:63], a[44:47], v[48:63]
    v_exp_f32 v67, v67
    v_exp_f32 v68, v68
    v_cvt_pk_bf16_f32 v89, v66, v67
    v_exp_f32 v69, v69
    v_exp_f32 v70, v70
    v_cvt_pk_bf16_f32 v90, v68, v69
    v_mfma_f32_32x32x16_bf16 a[0:15], a[80:83], v[80:83], a[0:15]
    v_exp_f32 v71, v71
    v_exp_f32 v72, v72
    v_cvt_pk_bf16_f32 v91, v70, v71
    v_exp_f32 v73, v73
    v_exp_f32 v74, v74
    v_cvt_pk_bf16_f32 v92, v72, v73
    v_mfma_f32_32x32x16_bf16 a[0:15], a[84:87], v[84:87], a[0:15]
    v_exp_f32 v75, v75
    v_exp_f32 v76, v76
    v_cvt_pk_bf16_f32 v93, v74, v75
    v_exp_f32 v77, v77
    v_exp_f32 v78, v78
    v_cvt_pk_bf16_f32 v94, v76, v77
    v_smfmac_f32_16x16x64_bf16 a[32:35], v[32:35], v[80:87], v11
    v_exp_f32 v79, v79
    v_exp_f32 v48, v48
    v_cvt_pk_bf16_f32 v95, v78, v79
    v_mfma_f32_32x32x16_bf16 v[64:79], a[56:59], a[48:51], v[112:127]
    ds_read_b128 a[72:75], v6 offset:34816
    ds_read_b128 a[76:79], v6 offset:35840
    buffer_store_dwordx4 v[216:219], v6, s[28:31], s90 offen offset:3072 sc1
    v_exp_f32 v49, v49
    v_exp_f32 v50, v50
    v_cvt_pk_bf16_f32 v80, v48, v49
    v_exp_f32 v51, v51
    v_mfma_f32_32x32x16_bf16 v[64:79], a[60:63], a[52:55], v[64:79]
    v_exp_f32 v52, v52
    v_cvt_pk_bf16_f32 v81, v50, v51
    v_exp_f32 v53, v53
    v_exp_f32 v54, v54
    v_cvt_pk_bf16_f32 v82, v52, v53
    v_exp_f32 v55, v55
    v_mfma_f32_32x32x16_bf16 a[16:31], a[80:83], v[88:91], a[16:31]
    v_exp_f32 v56, v56
    v_cvt_pk_bf16_f32 v83, v54, v55
    v_exp_f32 v57, v57
    v_exp_f32 v58, v58
    v_cvt_pk_bf16_f32 v84, v56, v57
    v_exp_f32 v59, v59
    v_mfma_f32_32x32x16_bf16 a[16:31], a[84:87], v[92:95], a[16:31]
    v_exp_f32 v60, v60
    v_cvt_pk_bf16_f32 v85, v58, v59
    v_exp_f32 v61, v61
    v_exp_f32 v62, v62
    v_cvt_pk_bf16_f32 v86, v60, v61
    v_exp_f32 v63, v63
    v_smfmac_f32_16x16x64_bf16 a[36:39], v[32:35], v[88:95], v11
    v_exp_f32 v64, v64
    v_cvt_pk_bf16_f32 v87, v62, v63
    s_waitcnt lgkmcnt(0)
    v_mfma_f32_32x32x16_bf16 v[48:63], a[64:67], a[40:43], v[96:111]
    ds_read_b128 a[56:59], v6 offset:40960
    ds_read_b128 a[60:63], v6 offset:41984
    s_waitcnt vmcnt(2)
    ds_read_b64_tr_b16 a[224:225], v20 offset:8192
    ds_read_b64_tr_b16 a[226:227], v20 offset:8704
    ds_read_b64_tr_b16 a[228:229], v21 offset:8192
    ds_read_b64_tr_b16 a[230:231], v21 offset:8704
    v_exp_f32 v65, v65
    v_exp_f32 v66, v66
    v_mfma_f32_32x32x16_bf16 v[48:63], a[68:71], a[44:47], v[48:63]
    v_cvt_pk_bf16_f32 v88, v64, v65
    v_exp_f32 v67, v67
    v_exp_f32 v68, v68
    v_cvt_pk_bf16_f32 v89, v66, v67
    v_exp_f32 v69, v69
    v_exp_f32 v70, v70
    v_mfma_f32_32x32x16_bf16 a[0:15], a[72:75], v[80:83], a[0:15]
    v_cvt_pk_bf16_f32 v90, v68, v69
    v_exp_f32 v71, v71
    v_exp_f32 v72, v72
    v_cvt_pk_bf16_f32 v91, v70, v71
    v_exp_f32 v73, v73
    v_exp_f32 v74, v74
    v_mfma_f32_32x32x16_bf16 a[0:15], a[76:79], v[84:87], a[0:15]
    v_cvt_pk_bf16_f32 v92, v72, v73
    v_exp_f32 v75, v75
    v_exp_f32 v76, v76
    v_cvt_pk_bf16_f32 v93, v74, v75
    v_exp_f32 v77, v77
    v_exp_f32 v78, v78
    v_cvt_pk_bf16_f32 v94, v76, v77
    v_smfmac_f32_16x16x64_bf16 a[32:35], v[32:35], v[80:87], v11
    v_exp_f32 v79, v79
    v_exp_f32 v48, v48
    v_cvt_pk_bf16_f32 v95, v78, v79
    v_mfma_f32_32x32x16_bf16 v[64:79], a[64:67], a[48:51], v[112:127]
    ds_read_b128 a[80:83], v6 offset:38912
    ds_read_b128 a[84:87], v6 offset:39936
    ds_read_b64_tr_b16 a[232:233], v20 offset:10240
    ds_read_b64_tr_b16 a[234:235], v20 offset:10752
    v_exp_f32 v49, v49
    v_exp_f32 v50, v50
    v_cvt_pk_bf16_f32 v80, v48, v49
    v_exp_f32 v51, v51
    v_mfma_f32_32x32x16_bf16 v[64:79], a[68:71], a[52:55], v[64:79]
    ds_read_b64_tr_b16 a[236:237], v21 offset:10240
    v_exp_f32 v52, v52
    v_cvt_pk_bf16_f32 v81, v50, v51
    v_exp_f32 v53, v53
    v_exp_f32 v54, v54
    v_cvt_pk_bf16_f32 v82, v52, v53
    v_exp_f32 v55, v55
    v_mfma_f32_32x32x16_bf16 a[16:31], a[72:75], v[88:91], a[16:31]
    ds_read_b64_tr_b16 a[238:239], v21 offset:10752
    v_exp_f32 v56, v56
    v_cvt_pk_bf16_f32 v83, v54, v55
    v_exp_f32 v57, v57
    v_exp_f32 v58, v58
    v_cvt_pk_bf16_f32 v84, v56, v57
    v_exp_f32 v59, v59
    v_mfma_f32_32x32x16_bf16 a[16:31], a[76:79], v[92:95], a[16:31]
    v_exp_f32 v60, v60
    v_cvt_pk_bf16_f32 v85, v58, v59
    v_exp_f32 v61, v61
    v_exp_f32 v62, v62
    v_cvt_pk_bf16_f32 v86, v60, v61
    v_exp_f32 v63, v63
    v_smfmac_f32_16x16x64_bf16 a[36:39], v[32:35], v[88:95], v11
    v_exp_f32 v64, v64
    v_cvt_pk_bf16_f32 v87, v62, v63
    s_waitcnt lgkmcnt(0)
    v_mfma_f32_32x32x16_bf16 v[48:63], a[56:59], a[40:43], v[96:111]
    ds_read_b128 a[64:67], v6 offset:45056
    ds_read_b128 a[68:71], v6 offset:46080
    v_mov_b32 v12, 2
    s_waitcnt vmcnt(0)
    buffer_store_dword v12, v3, s[32:35], 0 offen sc1
    ds_read_b64_tr_b16 a[240:241], v20 offset:12288
    ds_read_b64_tr_b16 a[242:243], v20 offset:12800
    ds_read_b64_tr_b16 a[244:245], v21 offset:12288
    v_exp_f32 v65, v65
    v_mfma_f32_32x32x16_bf16 v[48:63], a[60:63], a[44:47], v[48:63]
    ds_read_b64_tr_b16 a[246:247], v21 offset:12800
    v_exp_f32 v66, v66
    v_cvt_pk_bf16_f32 v88, v64, v65
    v_exp_f32 v67, v67
    v_exp_f32 v68, v68
    v_cvt_pk_bf16_f32 v89, v66, v67
    v_exp_f32 v69, v69
    v_mfma_f32_32x32x16_bf16 a[0:15], a[80:83], v[80:83], a[0:15]
    v_exp_f32 v70, v70
    v_cvt_pk_bf16_f32 v90, v68, v69
    v_exp_f32 v71, v71
    v_exp_f32 v72, v72
    v_cvt_pk_bf16_f32 v91, v70, v71
    v_exp_f32 v73, v73
    v_exp_f32 v74, v74
    v_mfma_f32_32x32x16_bf16 a[0:15], a[84:87], v[84:87], a[0:15]
    v_cvt_pk_bf16_f32 v92, v72, v73
    v_exp_f32 v75, v75
    v_exp_f32 v76, v76
    v_cvt_pk_bf16_f32 v93, v74, v75
    v_exp_f32 v77, v77
    v_exp_f32 v78, v78
    v_cvt_pk_bf16_f32 v94, v76, v77
    v_smfmac_f32_16x16x64_bf16 a[32:35], v[32:35], v[80:87], v11
    v_exp_f32 v79, v79
    v_exp_f32 v48, v48
    v_cvt_pk_bf16_f32 v95, v78, v79
    v_mfma_f32_32x32x16_bf16 v[64:79], a[56:59], a[48:51], v[112:127]
    ds_read_b128 a[72:75], v6 offset:43008
    ds_read_b128 a[76:79], v6 offset:44032
    ds_read_b64_tr_b16 a[248:249], v20 offset:14336
    ds_read_b64_tr_b16 a[250:251], v20 offset:14848
    v_exp_f32 v49, v49
    v_exp_f32 v50, v50
    v_cvt_pk_bf16_f32 v80, v48, v49
    v_exp_f32 v51, v51
    v_mfma_f32_32x32x16_bf16 v[64:79], a[60:63], a[52:55], v[64:79]
    ds_read_b64_tr_b16 a[252:253], v21 offset:14336
    v_exp_f32 v52, v52
    v_cvt_pk_bf16_f32 v81, v50, v51
    v_exp_f32 v53, v53
    v_exp_f32 v54, v54
    v_cvt_pk_bf16_f32 v82, v52, v53
    v_exp_f32 v55, v55
    v_mfma_f32_32x32x16_bf16 a[16:31], a[80:83], v[88:91], a[16:31]
    ds_read_b64_tr_b16 a[254:255], v21 offset:14848
    v_exp_f32 v56, v56
    v_cvt_pk_bf16_f32 v83, v54, v55
    v_exp_f32 v57, v57
    v_exp_f32 v58, v58
    v_cvt_pk_bf16_f32 v84, v56, v57
    v_exp_f32 v59, v59
    v_mfma_f32_32x32x16_bf16 a[16:31], a[84:87], v[92:95], a[16:31]
    v_exp_f32 v60, v60
    v_cvt_pk_bf16_f32 v85, v58, v59
    v_exp_f32 v61, v61
    v_exp_f32 v62, v62
    v_cvt_pk_bf16_f32 v86, v60, v61
    v_exp_f32 v63, v63
    v_smfmac_f32_16x16x64_bf16 a[36:39], v[32:35], v[88:95], v11
    v_exp_f32 v64, v64
    v_cvt_pk_bf16_f32 v87, v62, v63
    s_waitcnt lgkmcnt(0)
    v_mfma_f32_32x32x16_bf16 v[48:63], a[64:67], a[40:43], v[96:111]
    s_barrier
    ds_read_b128 a[56:59], v6 offset:49152
    ds_read_b128 a[60:63], v6 offset:50176
    s_add_u32 m0, s78, 16384
    s_nop 0
    buffer_load_dwordx4 v9, s[56:59], s76 offen offset:0 lds
    v_exp_f32 v65, v65
    v_exp_f32 v66, v66
    v_cvt_pk_bf16_f32 v88, v64, v65
    v_mfma_f32_32x32x16_bf16 v[48:63], a[68:71], a[44:47], v[48:63]
    buffer_load_dwordx4 v9, s[56:59], s76 offen offset:1024 lds
    v_exp_f32 v67, v67
    v_exp_f32 v68, v68
    v_cvt_pk_bf16_f32 v89, v66, v67
    v_exp_f32 v69, v69
    v_exp_f32 v70, v70
    v_cvt_pk_bf16_f32 v90, v68, v69
    v_mfma_f32_32x32x16_bf16 a[0:15], a[72:75], v[80:83], a[0:15]
    buffer_load_dwordx4 v9, s[56:59], s76 offen offset:2048 lds
    v_exp_f32 v71, v71
    v_exp_f32 v72, v72
    v_cvt_pk_bf16_f32 v91, v70, v71
    v_exp_f32 v73, v73
    v_exp_f32 v74, v74
    v_cvt_pk_bf16_f32 v92, v72, v73
    v_mfma_f32_32x32x16_bf16 a[0:15], a[76:79], v[84:87], a[0:15]
    v_exp_f32 v75, v75
    v_exp_f32 v76, v76
    v_cvt_pk_bf16_f32 v93, v74, v75
    v_exp_f32 v77, v77
    v_exp_f32 v78, v78
    v_cvt_pk_bf16_f32 v94, v76, v77
    v_exp_f32 v79, v79
    v_smfmac_f32_16x16x64_bf16 a[32:35], v[32:35], v[80:87], v11
    buffer_load_dwordx4 v9, s[56:59], s76 offen offset:3072 lds
    v_exp_f32 v48, v48
    v_cvt_pk_bf16_f32 v95, v78, v79
    v_mfma_f32_32x32x16_bf16 v[64:79], a[64:67], a[48:51], v[112:127]
    ds_read_b128 a[80:83], v6 offset:47104
    ds_read_b128 a[84:87], v6 offset:48128
    s_add_u32 m0, s81, 8192
    s_add_u32 s76, s76, 16384
    s_and_b32 s76, s76, 0x3ffff
    s_waitcnt lgkmcnt(0)
    buffer_load_dwordx4 v18, s[68:71], s87 offen offset:0 lds
    buffer_load_dwordx4 v19, s[68:71], s87 offen offset:1024 lds
    s_add_u32 m0, s81, 10240
    v_exp_f32 v49, v49
    v_mfma_f32_32x32x16_bf16 v[64:79], a[68:71], a[52:55], v[64:79]
    s_add_u32 s87, s87, 32768
    v_exp_f32 v50, v50
    v_cvt_pk_bf16_f32 v80, v48, v49
    v_exp_f32 v51, v51
    v_exp_f32 v52, v52
    v_cvt_pk_bf16_f32 v81, v50, v51
    v_exp_f32 v53, v53
    v_exp_f32 v54, v54
    v_mfma_f32_32x32x16_bf16 a[16:31], a[72:75], v[88:91], a[16:31]
    buffer_load_dwordx4 v18, s[68:71], s87 offen offset:0 lds
    v_cvt_pk_bf16_f32 v82, v52, v53
    v_exp_f32 v55, v55
    v_exp_f32 v56, v56
    v_cvt_pk_bf16_f32 v83, v54, v55
    v_exp_f32 v57, v57
    v_exp_f32 v58, v58
    v_mfma_f32_32x32x16_bf16 a[16:31], a[76:79], v[92:95], a[16:31]
    v_cvt_pk_bf16_f32 v84, v56, v57
    v_exp_f32 v59, v59
    v_exp_f32 v60, v60
    v_cvt_pk_bf16_f32 v85, v58, v59
    v_exp_f32 v61, v61
    v_exp_f32 v62, v62
    v_cvt_pk_bf16_f32 v86, v60, v61
    v_exp_f32 v63, v63
    v_smfmac_f32_16x16x64_bf16 a[36:39], v[32:35], v[88:95], v11
    buffer_load_dwordx4 v19, s[68:71], s87 offen offset:1024 lds
    s_add_u32 s87, s87, 32768
    v_exp_f32 v64, v64
    v_cvt_pk_bf16_f32 v87, v62, v63
    s_waitcnt lgkmcnt(0)
    v_mfma_f32_32x32x16_bf16 v[48:63], a[56:59], a[40:43], v[96:111]
    ds_read_b128 a[64:67], v6 offset:53248
    ds_read_b128 a[68:71], v6 offset:54272
    s_add_u32 m0, s81, 12288
    s_nop 0
    buffer_load_dwordx4 v18, s[68:71], s87 offen offset:0 lds
    buffer_load_dwordx4 v19, s[68:71], s87 offen offset:1024 lds
    s_add_u32 m0, s81, 14336
    v_exp_f32 v65, v65
    v_exp_f32 v66, v66
    v_mfma_f32_32x32x16_bf16 v[48:63], a[60:63], a[44:47], v[48:63]
    s_add_u32 s87, s87, 32768
    v_cvt_pk_bf16_f32 v88, v64, v65
    v_exp_f32 v67, v67
    v_exp_f32 v68, v68
    v_cvt_pk_bf16_f32 v89, v66, v67
    v_exp_f32 v69, v69
    v_exp_f32 v70, v70
    v_cvt_pk_bf16_f32 v90, v68, v69
    v_mfma_f32_32x32x16_bf16 a[0:15], a[80:83], v[80:83], a[0:15]
    buffer_load_dwordx4 v18, s[68:71], s87 offen offset:0 lds
    v_exp_f32 v71, v71
    v_exp_f32 v72, v72
    v_cvt_pk_bf16_f32 v91, v70, v71
    v_exp_f32 v73, v73
    v_exp_f32 v74, v74
    v_cvt_pk_bf16_f32 v92, v72, v73
    v_mfma_f32_32x32x16_bf16 a[0:15], a[84:87], v[84:87], a[0:15]
    v_exp_f32 v75, v75
    v_exp_f32 v76, v76
    v_cvt_pk_bf16_f32 v93, v74, v75
    v_exp_f32 v77, v77
    v_exp_f32 v78, v78
    v_cvt_pk_bf16_f32 v94, v76, v77
    v_exp_f32 v79, v79
    v_smfmac_f32_16x16x64_bf16 a[32:35], v[32:35], v[80:87], v11
    buffer_load_dwordx4 v19, s[68:71], s87 offen offset:1024 lds
    s_add_u32 s87, s87, 32768
    v_exp_f32 v48, v48
    v_cvt_pk_bf16_f32 v95, v78, v79
    v_mfma_f32_32x32x16_bf16 v[64:79], a[56:59], a[48:51], v[112:127]
    ds_read_b128 a[72:75], v6 offset:51200
    ds_read_b128 a[76:79], v6 offset:52224
    s_add_u32 m0, s81, 16384
    s_nop 0
    buffer_load_dwordx4 v18, s[68:71], s87 offen offset:0 lds
    buffer_load_dwordx4 v19, s[68:71], s87 offen offset:1024 lds
    s_add_u32 m0, s81, 18432
    v_exp_f32 v49, v49
    v_exp_f32 v50, v50
    v_mfma_f32_32x32x16_bf16 v[64:79], a[60:63], a[52:55], v[64:79]
    s_add_u32 s87, s87, 32768
    v_cvt_pk_bf16_f32 v80, v48, v49
    v_exp_f32 v51, v51
    v_exp_f32 v52, v52
    v_cvt_pk_bf16_f32 v81, v50, v51
    v_exp_f32 v53, v53
    v_exp_f32 v54, v54
    v_cvt_pk_bf16_f32 v82, v52, v53
    v_mfma_f32_32x32x16_bf16 a[16:31], a[80:83], v[88:91], a[16:31]
    buffer_load_dwordx4 v18, s[68:71], s87 offen offset:0 lds
    v_exp_f32 v55, v55
    v_exp_f32 v56, v56
    v_cvt_pk_bf16_f32 v83, v54, v55
    v_exp_f32 v57, v57
    v_exp_f32 v58, v58
    v_cvt_pk_bf16_f32 v84, v56, v57
    v_mfma_f32_32x32x16_bf16 a[16:31], a[84:87], v[92:95], a[16:31]
    v_exp_f32 v59, v59
    v_exp_f32 v60, v60
    v_cvt_pk_bf16_f32 v85, v58, v59
    v_exp_f32 v61, v61
    v_exp_f32 v62, v62
    v_cvt_pk_bf16_f32 v86, v60, v61
    v_exp_f32 v63, v63
    v_smfmac_f32_16x16x64_bf16 a[36:39], v[32:35], v[88:95], v11
    buffer_load_dwordx4 v19, s[68:71], s87 offen offset:1024 lds
    s_add_u32 s87, s87, 32768
    v_exp_f32 v64, v64
    v_cvt_pk_bf16_f32 v87, v62, v63
    s_waitcnt lgkmcnt(0)
    v_mfma_f32_32x32x16_bf16 v[48:63], a[64:67], a[40:43], v[96:111]
    ds_read_b128 a[56:59], v6 offset:57344
    ds_read_b128 a[60:63], v6 offset:58368
    s_add_u32 m0, s78, 147456
    s_nop 0
    buffer_load_dwordx4 v18, s[68:71], s87 offen offset:0 lds
    buffer_load_dwordx4 v19, s[68:71], s87 offen offset:1024 lds
    s_add_u32 m0, s78, 149504
    v_exp_f32 v65, v65
    v_exp_f32 v66, v66
    v_mfma_f32_32x32x16_bf16 v[48:63], a[68:71], a[44:47], v[48:63]
    s_add_u32 s87, s87, 32768
    v_cvt_pk_bf16_f32 v88, v64, v65
    v_exp_f32 v67, v67
    v_exp_f32 v68, v68
    v_cvt_pk_bf16_f32 v89, v66, v67
    v_exp_f32 v69, v69
    v_exp_f32 v70, v70
    v_cvt_pk_bf16_f32 v90, v68, v69
    v_mfma_f32_32x32x16_bf16 a[0:15], a[72:75], v[80:83], a[0:15]
    buffer_load_dwordx4 v18, s[68:71], s87 offen offset:0 lds
    v_exp_f32 v71, v71
    v_exp_f32 v72, v72
    v_cvt_pk_bf16_f32 v91, v70, v71
    v_exp_f32 v73, v73
    v_exp_f32 v74, v74
    v_cvt_pk_bf16_f32 v92, v72, v73
    v_mfma_f32_32x32x16_bf16 a[0:15], a[76:79], v[84:87], a[0:15]
    v_exp_f32 v75, v75
    v_exp_f32 v76, v76
    v_cvt_pk_bf16_f32 v93, v74, v75
    v_exp_f32 v77, v77
    v_exp_f32 v78, v78
    v_cvt_pk_bf16_f32 v94, v76, v77
    v_exp_f32 v79, v79
    v_smfmac_f32_16x16x64_bf16 a[32:35], v[32:35], v[80:87], v11
    buffer_load_dwordx4 v19, s[68:71], s87 offen offset:1024 lds
    s_add_u32 s87, s87, 32768
    v_exp_f32 v48, v48
    v_cvt_pk_bf16_f32 v95, v78, v79
    v_mfma_f32_32x32x16_bf16 v[64:79], a[64:67], a[48:51], v[112:127]
    ds_read_b128 a[80:83], v6 offset:55296
    ds_read_b128 a[84:87], v6 offset:56320
    v_exp_f32 v49, v49
    v_exp_f32 v50, v50
    v_cvt_pk_bf16_f32 v80, v48, v49
    v_exp_f32 v51, v51
    v_mfma_f32_32x32x16_bf16 v[64:79], a[68:71], a[52:55], v[64:79]
    v_exp_f32 v52, v52
    v_cvt_pk_bf16_f32 v81, v50, v51
    v_exp_f32 v53, v53
    v_exp_f32 v54, v54
    v_cvt_pk_bf16_f32 v82, v52, v53
    v_exp_f32 v55, v55
    v_mfma_f32_32x32x16_bf16 a[16:31], a[72:75], v[88:91], a[16:31]
    v_exp_f32 v56, v56
    v_cvt_pk_bf16_f32 v83, v54, v55
    v_exp_f32 v57, v57
    v_exp_f32 v58, v58
    v_cvt_pk_bf16_f32 v84, v56, v57
    v_exp_f32 v59, v59
    v_mfma_f32_32x32x16_bf16 a[16:31], a[76:79], v[92:95], a[16:31]
    v_exp_f32 v60, v60
    v_cvt_pk_bf16_f32 v85, v58, v59
    v_exp_f32 v61, v61
    v_exp_f32 v62, v62
    v_cvt_pk_bf16_f32 v86, v60, v61
    v_exp_f32 v63, v63
    v_smfmac_f32_16x16x64_bf16 a[36:39], v[32:35], v[88:95], v11
    v_exp_f32 v64, v64
    v_cvt_pk_bf16_f32 v87, v62, v63
    s_waitcnt lgkmcnt(0)
    v_mfma_f32_32x32x16_bf16 v[48:63], a[56:59], a[40:43], v[96:111]
    ds_read_b128 a[64:67], v6 offset:61440
    ds_read_b128 a[68:71], v6 offset:62464
    v_exp_f32 v65, v65
    v_exp_f32 v66, v66
    v_cvt_pk_bf16_f32 v88, v64, v65
    v_exp_f32 v67, v67
    v_mfma_f32_32x32x16_bf16 v[48:63], a[60:63], a[44:47], v[48:63]
    v_exp_f32 v68, v68
    v_cvt_pk_bf16_f32 v89, v66, v67
    v_exp_f32 v69, v69
    v_exp_f32 v70, v70
    v_cvt_pk_bf16_f32 v90, v68, v69
    v_exp_f32 v71, v71
    v_mfma_f32_32x32x16_bf16 a[0:15], a[80:83], v[80:83], a[0:15]
    v_exp_f32 v72, v72
    v_cvt_pk_bf16_f32 v91, v70, v71
    v_exp_f32 v73, v73
    v_exp_f32 v74, v74
    v_cvt_pk_bf16_f32 v92, v72, v73
    v_exp_f32 v75, v75
    v_mfma_f32_32x32x16_bf16 a[0:15], a[84:87], v[84:87], a[0:15]
    v_exp_f32 v76, v76
    v_cvt_pk_bf16_f32 v93, v74, v75
    v_exp_f32 v77, v77
    v_exp_f32 v78, v78
    v_cvt_pk_bf16_f32 v94, v76, v77
    v_exp_f32 v79, v79
    v_smfmac_f32_16x16x64_bf16 a[32:35], v[32:35], v[80:87], v11
    v_exp_f32 v48, v48
    v_cvt_pk_bf16_f32 v95, v78, v79
    v_mfma_f32_32x32x16_bf16 v[64:79], a[56:59], a[48:51], v[112:127]
    ds_read_b128 a[72:75], v6 offset:59392
    ds_read_b128 a[76:79], v6 offset:60416
    buffer_load_dwordx2 v[28:29], v15, s[32:35], s47 offen sc1
    v_exp_f32 v49, v49
    v_exp_f32 v50, v50
    v_cvt_pk_bf16_f32 v80, v48, v49
    v_exp_f32 v51, v51
    v_mfma_f32_32x32x16_bf16 v[64:79], a[60:63], a[52:55], v[64:79]
    v_exp_f32 v52, v52
    v_cvt_pk_bf16_f32 v81, v50, v51
    v_exp_f32 v53, v53
    v_exp_f32 v54, v54
    v_cvt_pk_bf16_f32 v82, v52, v53
    v_exp_f32 v55, v55
    v_mfma_f32_32x32x16_bf16 a[16:31], a[80:83], v[88:91], a[16:31]
    v_exp_f32 v56, v56
    v_cvt_pk_bf16_f32 v83, v54, v55
    v_exp_f32 v57, v57
    v_exp_f32 v58, v58
    v_cvt_pk_bf16_f32 v84, v56, v57
    v_exp_f32 v59, v59
    v_mfma_f32_32x32x16_bf16 a[16:31], a[84:87], v[92:95], a[16:31]
    v_exp_f32 v60, v60
    v_cvt_pk_bf16_f32 v85, v58, v59
    v_exp_f32 v61, v61
    v_exp_f32 v62, v62
    v_cvt_pk_bf16_f32 v86, v60, v61
    v_exp_f32 v63, v63
    v_smfmac_f32_16x16x64_bf16 a[36:39], v[32:35], v[88:95], v11
    v_exp_f32 v64, v64
    v_cvt_pk_bf16_f32 v87, v62, v63
    s_waitcnt lgkmcnt(0)
    v_mfma_f32_32x32x16_bf16 v[48:63], a[64:67], a[40:43], v[96:111]
    s_barrier
    ds_read_b128 a[56:59], v6 offset:0
    ds_read_b128 a[60:63], v6 offset:1024
    s_add_u32 m0, s78, 32768
    s_nop 0
    buffer_load_dwordx4 v9, s[56:59], s76 offen offset:0 lds
    v_exp_f32 v65, v65
    v_exp_f32 v66, v66
    v_cvt_pk_bf16_f32 v88, v64, v65
    v_mfma_f32_32x32x16_bf16 v[48:63], a[68:71], a[44:47], v[48:63]
    buffer_load_dwordx4 v9, s[56:59], s76 offen offset:1024 lds
    v_exp_f32 v67, v67
    v_exp_f32 v68, v68
    v_cvt_pk_bf16_f32 v89, v66, v67
    v_exp_f32 v69, v69
    v_exp_f32 v70, v70
    v_cvt_pk_bf16_f32 v90, v68, v69
    v_mfma_f32_32x32x16_bf16 a[0:15], a[72:75], v[80:83], a[0:15]
    buffer_load_dwordx4 v9, s[56:59], s76 offen offset:2048 lds
    v_exp_f32 v71, v71
    v_exp_f32 v72, v72
    v_cvt_pk_bf16_f32 v91, v70, v71
    v_exp_f32 v73, v73
    v_exp_f32 v74, v74
    v_cvt_pk_bf16_f32 v92, v72, v73
    v_mfma_f32_32x32x16_bf16 a[0:15], a[76:79], v[84:87], a[0:15]
    v_exp_f32 v75, v75
    v_exp_f32 v76, v76
    v_cvt_pk_bf16_f32 v93, v74, v75
    v_exp_f32 v77, v77
    v_exp_f32 v78, v78
    v_cvt_pk_bf16_f32 v94, v76, v77
    v_exp_f32 v79, v79
    v_smfmac_f32_16x16x64_bf16 a[32:35], v[32:35], v[80:87], v11
    buffer_load_dwordx4 v9, s[56:59], s76 offen offset:3072 lds
    v_exp_f32 v48, v48
    v_cvt_pk_bf16_f32 v95, v78, v79
    v_mfma_f32_32x32x16_bf16 v[64:79], a[64:67], a[48:51], v[112:127]
    ds_read_b128 a[80:83], v6 offset:63488
    ds_read_b128 a[84:87], v6 offset:64512
    s_add_u32 s76, s76, 16384
    s_and_b32 s76, s76, 0x3ffff
    v_exp_f32 v49, v49
    v_exp_f32 v50, v50
    v_cvt_pk_bf16_f32 v80, v48, v49
    v_exp_f32 v51, v51
    v_mfma_f32_32x32x16_bf16 v[64:79], a[68:71], a[52:55], v[64:79]
    v_exp_f32 v52, v52
    v_cvt_pk_bf16_f32 v81, v50, v51
    v_exp_f32 v53, v53
    v_exp_f32 v54, v54
    v_cvt_pk_bf16_f32 v82, v52, v53
    v_exp_f32 v55, v55
    v_mfma_f32_32x32x16_bf16 a[16:31], a[72:75], v[88:91], a[16:31]
    v_exp_f32 v56, v56
    v_cvt_pk_bf16_f32 v83, v54, v55
    v_exp_f32 v57, v57
    v_exp_f32 v58, v58
    v_cvt_pk_bf16_f32 v84, v56, v57
    v_exp_f32 v59, v59
    v_mfma_f32_32x32x16_bf16 a[16:31], a[76:79], v[92:95], a[16:31]
    v_exp_f32 v60, v60
    v_cvt_pk_bf16_f32 v85, v58, v59
    v_exp_f32 v61, v61
    v_exp_f32 v62, v62
    v_cvt_pk_bf16_f32 v86, v60, v61
    v_exp_f32 v63, v63
    v_smfmac_f32_16x16x64_bf16 a[36:39], v[32:35], v[88:95], v11
    v_exp_f32 v64, v64
    v_cvt_pk_bf16_f32 v87, v62, v63
    s_waitcnt lgkmcnt(0)
    v_mfma_f32_32x32x16_bf16 v[48:63], a[56:59], a[40:43], v[96:111]
    ds_read_b128 a[64:67], v6 offset:4096
    ds_read_b128 a[68:71], v6 offset:5120
    s_add_u32 m0, s81, 0
    s_waitcnt vmcnt(4)
    v_min_u32 v13, v28, v29
    v_cmp_gt_u32 vcc, 2, v13
    s_nop 1
    s_cbranch_vccnz gated_mix__softmax_full_mha__glu_gated_bilinear__prompt_kernel_h_spin
gated_mix__softmax_full_mha__glu_gated_bilinear__prompt_kernel_h_ok:
    s_lshl_b32 s47, s40, 9
    buffer_load_dwordx2 v[28:29], v15, s[32:35], s47 offen sc1
    buffer_load_dwordx4 v16, s[64:67], s80 offen offset:0 lds
    buffer_load_dwordx4 v17, s[64:67], s80 offen offset:1024 lds
    s_add_u32 s80, s80, 32768
    v_mfma_f32_32x32x16_bf16 v[48:63], a[60:63], a[44:47], v[48:63]
    buffer_load_dwordx4 a[96:99], v36, s[60:63], s79 offen
    buffer_load_dwordx4 a[100:103], v37, s[60:63], s79 offen
    v_exp_f32 v65, v65
    v_exp_f32 v66, v66
    v_cvt_pk_bf16_f32 v88, v64, v65
    v_exp_f32 v67, v67
    v_exp_f32 v68, v68
    v_cvt_pk_bf16_f32 v89, v66, v67
    v_mfma_f32_32x32x16_bf16 a[0:15], a[80:83], v[80:83], a[0:15]
    buffer_load_dwordx4 a[104:107], v38, s[60:63], s79 offen
    v_exp_f32 v69, v69
    v_exp_f32 v70, v70
    v_cvt_pk_bf16_f32 v90, v68, v69
    v_exp_f32 v71, v71
    v_exp_f32 v72, v72
    v_cvt_pk_bf16_f32 v91, v70, v71
    v_exp_f32 v73, v73
    v_mfma_f32_32x32x16_bf16 a[0:15], a[84:87], v[84:87], a[0:15]
    v_exp_f32 v74, v74
    v_cvt_pk_bf16_f32 v92, v72, v73
    v_exp_f32 v75, v75
    v_exp_f32 v76, v76
    v_cvt_pk_bf16_f32 v93, v74, v75
    v_exp_f32 v77, v77
    v_exp_f32 v78, v78
    v_cvt_pk_bf16_f32 v94, v76, v77
    v_smfmac_f32_16x16x64_bf16 a[32:35], v[32:35], v[80:87], v11
    buffer_load_dwordx4 a[108:111], v39, s[60:63], s79 offen
    s_add_u32 s79, s79, 4096
    v_exp_f32 v79, v79
    v_exp_f32 v48, v48
    v_cvt_pk_bf16_f32 v95, v78, v79
    v_mfma_f32_32x32x16_bf16 v[64:79], a[56:59], a[48:51], v[112:127]
    ds_read_b128 a[72:75], v6 offset:2048
    ds_read_b128 a[76:79], v6 offset:3072
    s_add_u32 m0, s81, 2048
    s_nop 0
    buffer_load_dwordx4 v16, s[64:67], s80 offen offset:0 lds
    buffer_load_dwordx4 v17, s[64:67], s80 offen offset:1024 lds
    s_add_u32 s80, s80, 32768
    v_exp_f32 v49, v49
    v_exp_f32 v50, v50
    v_cvt_pk_bf16_f32 v80, v48, v49
    v_mfma_f32_32x32x16_bf16 v[64:79], a[60:63], a[52:55], v[64:79]
    buffer_load_dwordx4 a[112:115], v36, s[60:63], s79 offen
    buffer_load_dwordx4 a[116:119], v37, s[60:63], s79 offen
    v_exp_f32 v51, v51
    v_exp_f32 v52, v52
    v_cvt_pk_bf16_f32 v81, v50, v51
    v_exp_f32 v53, v53
    v_exp_f32 v54, v54
    v_mfma_f32_32x32x16_bf16 a[16:31], a[80:83], v[88:91], a[16:31]
    buffer_load_dwordx4 a[120:123], v38, s[60:63], s79 offen
    v_cvt_pk_bf16_f32 v82, v52, v53
    v_exp_f32 v55, v55
    v_exp_f32 v56, v56
    v_cvt_pk_bf16_f32 v83, v54, v55
    v_exp_f32 v57, v57
    v_exp_f32 v58, v58
    v_cvt_pk_bf16_f32 v84, v56, v57
    v_mfma_f32_32x32x16_bf16 a[16:31], a[84:87], v[92:95], a[16:31]
    v_exp_f32 v59, v59
    v_exp_f32 v60, v60
    v_cvt_pk_bf16_f32 v85, v58, v59
    v_exp_f32 v61, v61
    v_exp_f32 v62, v62
    v_cvt_pk_bf16_f32 v86, v60, v61
    v_exp_f32 v63, v63
    v_smfmac_f32_16x16x64_bf16 a[36:39], v[32:35], v[88:95], v11
    buffer_load_dwordx4 a[124:127], v39, s[60:63], s79 offen
    s_add_u32 s79, s79, 4096
    v_exp_f32 v64, v64
    v_cvt_pk_bf16_f32 v87, v62, v63
    s_waitcnt lgkmcnt(0)
    v_mfma_f32_32x32x16_bf16 v[48:63], a[64:67], a[40:43], v[96:111]
    ds_read_b128 a[56:59], v6 offset:8192
    ds_read_b128 a[60:63], v6 offset:9216
    s_add_u32 m0, s81, 4096
    s_nop 0
    buffer_load_dwordx4 v16, s[64:67], s80 offen offset:0 lds
    buffer_load_dwordx4 v17, s[64:67], s80 offen offset:1024 lds
    s_add_u32 s80, s80, 32768
    v_exp_f32 v65, v65
    v_exp_f32 v66, v66
    v_cvt_pk_bf16_f32 v88, v64, v65
    v_mfma_f32_32x32x16_bf16 v[48:63], a[68:71], a[44:47], v[48:63]
    buffer_load_dwordx4 a[128:131], v36, s[60:63], s79 offen
    buffer_load_dwordx4 a[132:135], v37, s[60:63], s79 offen
    v_exp_f32 v67, v67
    v_exp_f32 v68, v68
    v_cvt_pk_bf16_f32 v89, v66, v67
    v_exp_f32 v69, v69
    v_exp_f32 v70, v70
    v_mfma_f32_32x32x16_bf16 a[0:15], a[72:75], v[80:83], a[0:15]
    buffer_load_dwordx4 a[136:139], v38, s[60:63], s79 offen
    v_cvt_pk_bf16_f32 v90, v68, v69
    v_exp_f32 v71, v71
    v_exp_f32 v72, v72
    v_cvt_pk_bf16_f32 v91, v70, v71
    v_exp_f32 v73, v73
    v_exp_f32 v74, v74
    v_mfma_f32_32x32x16_bf16 a[0:15], a[76:79], v[84:87], a[0:15]
    v_cvt_pk_bf16_f32 v92, v72, v73
    v_exp_f32 v75, v75
    v_exp_f32 v76, v76
    v_cvt_pk_bf16_f32 v93, v74, v75
    v_exp_f32 v77, v77
    v_exp_f32 v78, v78
    v_cvt_pk_bf16_f32 v94, v76, v77
    v_exp_f32 v79, v79
    v_smfmac_f32_16x16x64_bf16 a[32:35], v[32:35], v[80:87], v11
    buffer_load_dwordx4 a[140:143], v39, s[60:63], s79 offen
    s_add_u32 s79, s79, 4096
    v_exp_f32 v48, v48
    v_cvt_pk_bf16_f32 v95, v78, v79
    v_mfma_f32_32x32x16_bf16 v[64:79], a[64:67], a[48:51], v[112:127]
    ds_read_b128 a[80:83], v6 offset:6144
    ds_read_b128 a[84:87], v6 offset:7168
    buffer_load_dwordx4 a[144:147], v36, s[60:63], s79 offen
    buffer_load_dwordx4 a[148:151], v37, s[60:63], s79 offen
    v_exp_f32 v49, v49
    v_exp_f32 v50, v50
    v_mfma_f32_32x32x16_bf16 v[64:79], a[68:71], a[52:55], v[64:79]
    v_cvt_pk_bf16_f32 v80, v48, v49
    v_exp_f32 v51, v51
    v_exp_f32 v52, v52
    v_cvt_pk_bf16_f32 v81, v50, v51
    v_exp_f32 v53, v53
    v_exp_f32 v54, v54
    v_cvt_pk_bf16_f32 v82, v52, v53
    v_mfma_f32_32x32x16_bf16 a[16:31], a[72:75], v[88:91], a[16:31]
    buffer_load_dwordx4 a[152:155], v38, s[60:63], s79 offen
    v_exp_f32 v55, v55
    v_exp_f32 v56, v56
    v_cvt_pk_bf16_f32 v83, v54, v55
    v_exp_f32 v57, v57
    v_exp_f32 v58, v58
    v_cvt_pk_bf16_f32 v84, v56, v57
    v_mfma_f32_32x32x16_bf16 a[16:31], a[76:79], v[92:95], a[16:31]
    v_exp_f32 v59, v59
    v_exp_f32 v60, v60
    v_cvt_pk_bf16_f32 v85, v58, v59
    v_exp_f32 v61, v61
    v_exp_f32 v62, v62
    v_cvt_pk_bf16_f32 v86, v60, v61
    v_exp_f32 v63, v63
    v_smfmac_f32_16x16x64_bf16 a[36:39], v[32:35], v[88:95], v11
    buffer_load_dwordx4 a[156:159], v39, s[60:63], s79 offen
    s_add_u32 s79, s79, 4096
    v_exp_f32 v64, v64
    v_cvt_pk_bf16_f32 v87, v62, v63
    s_waitcnt lgkmcnt(0)
    v_mfma_f32_32x32x16_bf16 v[48:63], a[56:59], a[40:43], v[96:111]
    ds_read_b128 a[64:67], v6 offset:12288
    ds_read_b128 a[68:71], v6 offset:13312
    s_waitcnt vmcnt(16)
    ds_read_b64_tr_b16 a[88:89], v20 offset:0
    ds_read_b64_tr_b16 a[90:91], v20 offset:512
    v_exp_f32 v65, v65
    v_exp_f32 v66, v66
    v_cvt_pk_bf16_f32 v88, v64, v65
    v_mfma_f32_32x32x16_bf16 v[48:63], a[60:63], a[44:47], v[48:63]
    v_exp_f32 v67, v67
    v_exp_f32 v68, v68
    v_cvt_pk_bf16_f32 v89, v66, v67
    v_exp_f32 v69, v69
    v_exp_f32 v70, v70
    v_cvt_pk_bf16_f32 v90, v68, v69
    v_mfma_f32_32x32x16_bf16 a[0:15], a[80:83], v[80:83], a[0:15]
    v_exp_f32 v71, v71
    v_exp_f32 v72, v72
    v_cvt_pk_bf16_f32 v91, v70, v71
    v_exp_f32 v73, v73
    v_exp_f32 v74, v74
    v_cvt_pk_bf16_f32 v92, v72, v73
    v_mfma_f32_32x32x16_bf16 a[0:15], a[84:87], v[84:87], a[0:15]
    v_exp_f32 v75, v75
    v_exp_f32 v76, v76
    v_cvt_pk_bf16_f32 v93, v74, v75
    v_exp_f32 v77, v77
    v_exp_f32 v78, v78
    v_cvt_pk_bf16_f32 v94, v76, v77
    v_smfmac_f32_16x16x64_bf16 a[32:35], v[32:35], v[80:87], v11
    v_exp_f32 v79, v79
    s_waitcnt lgkmcnt(0)
    v_mfma_f32_32x32x16_bf16 v[128:143], a[88:91], a[96:99], 0
    ds_read_b128 a[72:75], v6 offset:10240
    ds_read_b128 a[76:79], v6 offset:11264
    s_add_u32 m0, s81, 6144
    ds_read_b64_tr_b16 a[92:93], v21 offset:0
    v_exp_f32 v48, v48
    v_cvt_pk_bf16_f32 v95, v78, v79
    v_mfma_f32_32x32x16_bf16 v[64:79], a[56:59], a[48:51], v[112:127]
    ds_read_b64_tr_b16 a[94:95], v21 offset:512
    buffer_load_dwordx4 v16, s[64:67], s80 offen offset:0 lds
    v_exp_f32 v49, v49
    v_exp_f32 v50, v50
    v_mfma_f32_32x32x16_bf16 v[144:159], a[88:91], a[100:103], 0
    v_cvt_pk_bf16_f32 v80, v48, v49
    v_exp_f32 v51, v51
    v_exp_f32 v52, v52
    v_cvt_pk_bf16_f32 v81, v50, v51
    v_mfma_f32_32x32x16_bf16 v[64:79], a[60:63], a[52:55], v[64:79]
    buffer_load_dwordx4 v17, s[64:67], s80 offen offset:1024 lds
    s_add_u32 s80, s80, 32768
    v_exp_f32 v53, v53
    v_exp_f32 v54, v54
    v_mfma_f32_32x32x16_bf16 v[160:175], a[88:91], a[104:107], 0
    v_cvt_pk_bf16_f32 v82, v52, v53
    v_exp_f32 v55, v55
    v_exp_f32 v56, v56
    v_cvt_pk_bf16_f32 v83, v54, v55
    v_mfma_f32_32x32x16_bf16 a[16:31], a[80:83], v[88:91], a[16:31]
    buffer_load_dwordx4 a[160:163], v36, s[60:63], s79 offen
    v_exp_f32 v57, v57
    v_exp_f32 v58, v58
    v_mfma_f32_32x32x16_bf16 v[176:191], a[88:91], a[108:111], 0
    v_cvt_pk_bf16_f32 v84, v56, v57
    v_exp_f32 v59, v59
    v_exp_f32 v60, v60
    v_cvt_pk_bf16_f32 v85, v58, v59
    v_mfma_f32_32x32x16_bf16 a[16:31], a[84:87], v[92:95], a[16:31]
    v_exp_f32 v61, v61
    v_exp_f32 v62, v62
    v_cvt_pk_bf16_f32 v86, v60, v61
    v_exp_f32 v63, v63
    v_smfmac_f32_16x16x64_bf16 a[36:39], v[32:35], v[88:95], v11
    s_waitcnt vmcnt(13) lgkmcnt(0)
    v_mfma_f32_32x32x16_bf16 v[240:255], a[92:95], a[108:111], 0
    s_barrier
    ds_read_b128 a[56:59], v6 offset:16384
    ds_read_b128 a[60:63], v6 offset:17408
    s_add_u32 m0, s78, 49152
    ds_read_b64_tr_b16 a[88:89], v20 offset:2048
    ds_read_b64_tr_b16 a[90:91], v20 offset:2560
    buffer_load_dwordx4 a[164:167], v37, s[60:63], s79 offen
    v_exp_f32 v64, v64
    v_cvt_pk_bf16_f32 v87, v62, v63
    v_mfma_f32_32x32x16_bf16 v[48:63], a[64:67], a[40:43], v[96:111]
    v_exp_f32 v65, v65
    v_exp_f32 v66, v66
    v_cvt_pk_bf16_f32 v88, v64, v65
    v_mfma_f32_32x32x16_bf16 v[224:239], a[92:95], a[104:107], 0
    buffer_load_dwordx4 a[168:171], v38, s[60:63], s79 offen
    v_exp_f32 v67, v67
    v_exp_f32 v68, v68
    v_mfma_f32_32x32x16_bf16 v[48:63], a[68:71], a[44:47], v[48:63]
    v_cvt_pk_bf16_f32 v89, v66, v67
    v_exp_f32 v69, v69
    v_exp_f32 v70, v70
    v_cvt_pk_bf16_f32 v90, v68, v69
    v_mfma_f32_32x32x16_bf16 v[208:223], a[92:95], a[100:103], 0
    buffer_load_dwordx4 a[172:175], v39, s[60:63], s79 offen
    s_add_u32 s79, s79, 4096
    v_exp_f32 v71, v71
    v_exp_f32 v72, v72
    v_mfma_f32_32x32x16_bf16 a[0:15], a[72:75], v[80:83], a[0:15]
    v_cvt_pk_bf16_f32 v91, v70, v71
    v_exp_f32 v73, v73
    v_exp_f32 v74, v74
    v_cvt_pk_bf16_f32 v92, v72, v73
    v_mfma_f32_32x32x16_bf16 v[192:207], a[92:95], a[96:99], 0
    buffer_load_dwordx4 v9, s[56:59], s76 offen offset:0 lds
    v_exp_f32 v75, v75
    v_exp_f32 v76, v76
    v_cvt_pk_bf16_f32 v93, v74, v75
    v_mfma_f32_32x32x16_bf16 a[0:15], a[76:79], v[84:87], a[0:15]
    v_exp_f32 v77, v77
    v_exp_f32 v78, v78
    v_cvt_pk_bf16_f32 v94, v76, v77
    v_exp_f32 v79, v79
    v_smfmac_f32_16x16x64_bf16 a[32:35], v[32:35], v[80:87], v11
    buffer_load_dwordx4 v9, s[56:59], s76 offen offset:1024 lds
    s_waitcnt lgkmcnt(0)
    v_mfma_f32_32x32x16_bf16 v[128:143], a[88:91], a[112:115], v[128:143]
    ds_read_b128 a[80:83], v6 offset:14336
    ds_read_b128 a[84:87], v6 offset:15360
    s_add_u32 m0, s81, 0
    ds_read_b64_tr_b16 a[92:93], v21 offset:2048
    ds_read_b64_tr_b16 a[94:95], v21 offset:2560
    buffer_load_dwordx4 v16, s[64:67], s80 offen offset:0 lds
    v_exp_f32 v48, v48
    v_cvt_pk_bf16_f32 v95, v78, v79
    v_mfma_f32_32x32x16_bf16 v[64:79], a[64:67], a[48:51], v[112:127]
    buffer_load_dwordx4 v17, s[64:67], s80 offen offset:1024 lds
    s_add_u32 s80, s80, 32768
    buffer_load_dwordx4 a[176:179], v36, s[60:63], s79 offen
    s_lshl_b32 s45, s85, 11
    s_add_u32 s45, s45, 33554464
    v_lshrrev_b32 v13, 10, v36
    v_lshl_add_u32 v13, v13, 9, v31
    v_mfma_f32_32x32x16_bf16 v[144:159], a[88:91], a[116:119], v[144:159]
    buffer_load_dword v24, v13, s[28:31], s45 offen
    v_lshrrev_b32 v13, 10, v37
    v_lshl_add_u32 v13, v13, 9, v31
    v_exp_f32 v49, v49
    v_exp_f32 v50, v50
    v_mfma_f32_32x32x16_bf16 v[64:79], a[68:71], a[52:55], v[64:79]
    v_cvt_pk_bf16_f32 v80, v48, v49
    v_exp_f32 v51, v51
    v_exp_f32 v52, v52
    v_cvt_pk_bf16_f32 v81, v50, v51
    v_exp_f32 v53, v53
    v_mfma_f32_32x32x16_bf16 v[160:175], a[88:91], a[120:123], v[160:175]
    buffer_load_dword v25, v13, s[28:31], s45 offen
    v_lshrrev_b32 v13, 10, v38
    v_lshl_add_u32 v13, v13, 9, v31
    v_exp_f32 v54, v54
    v_cvt_pk_bf16_f32 v82, v52, v53
    v_exp_f32 v55, v55
    v_mfma_f32_32x32x16_bf16 a[16:31], a[72:75], v[88:91], a[16:31]
    v_exp_f32 v56, v56
    v_cvt_pk_bf16_f32 v83, v54, v55
    v_exp_f32 v57, v57
    v_exp_f32 v58, v58
    v_cvt_pk_bf16_f32 v84, v56, v57
    v_mfma_f32_32x32x16_bf16 v[176:191], a[88:91], a[124:127], v[176:191]
    buffer_load_dword v26, v13, s[28:31], s45 offen
    v_lshrrev_b32 v13, 10, v39
    v_lshl_add_u32 v13, v13, 9, v31
    v_exp_f32 v59, v59
    v_exp_f32 v60, v60
    v_mfma_f32_32x32x16_bf16 a[16:31], a[76:79], v[92:95], a[16:31]
    v_cvt_pk_bf16_f32 v85, v58, v59
    v_exp_f32 v61, v61
    v_exp_f32 v62, v62
    v_cvt_pk_bf16_f32 v86, v60, v61
    v_exp_f32 v63, v63
    v_smfmac_f32_16x16x64_bf16 a[36:39], v[32:35], v[88:95], v11
    buffer_load_dword v27, v13, s[28:31], s45 offen
    s_waitcnt vmcnt(19) lgkmcnt(0)
    v_mfma_f32_32x32x16_bf16 v[240:255], a[92:95], a[124:127], v[240:255]
    ds_read_b128 a[64:67], v6 offset:20480
    ds_read_b128 a[68:71], v6 offset:21504
    s_add_u32 m0, s78, 49152
    ds_read_b64_tr_b16 a[88:89], v20 offset:4096
    ds_read_b64_tr_b16 a[90:91], v20 offset:4608
    buffer_load_dwordx4 a[180:183], v37, s[60:63], s79 offen
    v_exp_f32 v64, v64
    v_cvt_pk_bf16_f32 v87, v62, v63
    v_mfma_f32_32x32x16_bf16 v[48:63], a[56:59], a[40:43], v[96:111]
    v_exp_f32 v65, v65
    v_exp_f32 v66, v66
    v_cvt_pk_bf16_f32 v88, v64, v65
    v_mfma_f32_32x32x16_bf16 v[224:239], a[92:95], a[120:123], v[224:239]
    buffer_load_dwordx4 a[184:187], v38, s[60:63], s79 offen
    v_exp_f32 v67, v67
    v_exp_f32 v68, v68
    v_mfma_f32_32x32x16_bf16 v[48:63], a[60:63], a[44:47], v[48:63]
    v_cvt_pk_bf16_f32 v89, v66, v67
    v_exp_f32 v69, v69
    v_exp_f32 v70, v70
    v_cvt_pk_bf16_f32 v90, v68, v69
    v_mfma_f32_32x32x16_bf16 v[208:223], a[92:95], a[116:119], v[208:223]
    buffer_load_dwordx4 a[188:191], v39, s[60:63], s79 offen
    s_add_u32 s79, s79, 4096
    v_exp_f32 v71, v71
    v_exp_f32 v72, v72
    v_mfma_f32_32x32x16_bf16 a[0:15], a[80:83], v[80:83], a[0:15]
    v_cvt_pk_bf16_f32 v91, v70, v71
    v_exp_f32 v73, v73
    v_exp_f32 v74, v74
    v_cvt_pk_bf16_f32 v92, v72, v73
    v_mfma_f32_32x32x16_bf16 v[192:207], a[92:95], a[112:115], v[192:207]
    buffer_load_dwordx4 v9, s[56:59], s76 offen offset:2048 lds
    v_exp_f32 v75, v75
    v_exp_f32 v76, v76
    v_cvt_pk_bf16_f32 v93, v74, v75
    v_mfma_f32_32x32x16_bf16 a[0:15], a[84:87], v[84:87], a[0:15]
    v_exp_f32 v77, v77
    v_exp_f32 v78, v78
    v_cvt_pk_bf16_f32 v94, v76, v77
    v_exp_f32 v79, v79
    v_smfmac_f32_16x16x64_bf16 a[32:35], v[32:35], v[80:87], v11
    buffer_load_dwordx4 v9, s[56:59], s76 offen offset:3072 lds
    s_add_u32 s76, s76, 16384
    s_and_b32 s76, s76, 0x3ffff
    s_waitcnt lgkmcnt(0)
    v_mfma_f32_32x32x16_bf16 v[128:143], a[88:91], a[128:131], v[128:143]
    ds_read_b128 a[72:75], v6 offset:18432
    ds_read_b128 a[76:79], v6 offset:19456
    s_add_u32 m0, s81, 2048
    ds_read_b64_tr_b16 a[92:93], v21 offset:4096
    ds_read_b64_tr_b16 a[94:95], v21 offset:4608
    buffer_load_dwordx4 v16, s[64:67], s80 offen offset:0 lds
    v_exp_f32 v48, v48
    v_cvt_pk_bf16_f32 v95, v78, v79
    v_mfma_f32_32x32x16_bf16 v[64:79], a[56:59], a[48:51], v[112:127]
    v_exp_f32 v49, v49
    v_exp_f32 v50, v50
    v_cvt_pk_bf16_f32 v80, v48, v49
    v_exp_f32 v51, v51
    v_mfma_f32_32x32x16_bf16 v[144:159], a[88:91], a[132:135], v[144:159]
    buffer_load_dwordx4 v17, s[64:67], s80 offen offset:1024 lds
    s_add_u32 s80, s80, 32768
    v_exp_f32 v52, v52
    v_cvt_pk_bf16_f32 v81, v50, v51
    v_exp_f32 v53, v53
    v_mfma_f32_32x32x16_bf16 v[64:79], a[60:63], a[52:55], v[64:79]
    v_exp_f32 v54, v54
    v_cvt_pk_bf16_f32 v82, v52, v53
    v_exp_f32 v55, v55
    v_exp_f32 v56, v56
    v_mfma_f32_32x32x16_bf16 v[160:175], a[88:91], a[136:139], v[160:175]
    buffer_load_dwordx4 a[192:195], v36, s[60:63], s79 offen
    v_min_u32 v13, v28, v29
    v_cmp_gt_u32 vcc, 2, v13
    s_nop 1
    s_cbranch_vccnz gated_mix__softmax_full_mha__glu_gated_bilinear__prompt_kernel_g_spin
gated_mix__softmax_full_mha__glu_gated_bilinear__prompt_kernel_g_ok:
    s_lshl_b32 s45, s40, 2
    s_add_u32 s45, s45, s42
    s_lshl_b32 s45, s45, 10
    v_mfma_f32_32x32x16_bf16 a[16:31], a[80:83], v[88:91], a[16:31]
    s_add_u32 s45, s45, 33554432
    v_cvt_pk_bf16_f32 v83, v54, v55
    v_exp_f32 v57, v57
    v_exp_f32 v58, v58
    v_cvt_pk_bf16_f32 v84, v56, v57
    v_mfma_f32_32x32x16_bf16 v[176:191], a[88:91], a[140:143], v[176:191]
    buffer_load_dword v22, v30, s[28:31], s45 offen offset:0
    v_exp_f32 v59, v59
    v_exp_f32 v60, v60
    v_cvt_pk_bf16_f32 v85, v58, v59
    v_mfma_f32_32x32x16_bf16 a[16:31], a[84:87], v[92:95], a[16:31]
    v_exp_f32 v61, v61
    v_exp_f32 v62, v62
    v_cvt_pk_bf16_f32 v86, v60, v61
    v_exp_f32 v63, v63
    v_smfmac_f32_16x16x64_bf16 a[36:39], v[32:35], v[88:95], v11
    buffer_load_dword v23, v30, s[28:31], s45 offen offset:512
    s_waitcnt vmcnt(23) lgkmcnt(0)
    v_mfma_f32_32x32x16_bf16 v[240:255], a[92:95], a[140:143], v[240:255]
    ds_read_b128 a[56:59], v6 offset:24576
    ds_read_b128 a[60:63], v6 offset:25600
    ds_read_b64_tr_b16 a[88:89], v20 offset:6144
    ds_read_b64_tr_b16 a[90:91], v20 offset:6656
    v_exp_f32 v64, v64
    v_cvt_pk_bf16_f32 v87, v62, v63
    v_mfma_f32_32x32x16_bf16 v[48:63], a[64:67], a[40:43], v[96:111]
    buffer_load_dwordx4 a[196:199], v37, s[60:63], s79 offen
    v_exp_f32 v65, v65
    v_exp_f32 v66, v66
    v_mfma_f32_32x32x16_bf16 v[224:239], a[92:95], a[136:139], v[224:239]
    v_cvt_pk_bf16_f32 v88, v64, v65
    v_exp_f32 v67, v67
    v_exp_f32 v68, v68
    v_cvt_pk_bf16_f32 v89, v66, v67
    v_mfma_f32_32x32x16_bf16 v[48:63], a[68:71], a[44:47], v[48:63]
    buffer_load_dwordx4 a[200:203], v38, s[60:63], s79 offen
    v_exp_f32 v69, v69
    v_exp_f32 v70, v70
    v_mfma_f32_32x32x16_bf16 v[208:223], a[92:95], a[132:135], v[208:223]
    v_cvt_pk_bf16_f32 v90, v68, v69
    v_exp_f32 v71, v71
    v_exp_f32 v72, v72
    v_cvt_pk_bf16_f32 v91, v70, v71
    v_mfma_f32_32x32x16_bf16 a[0:15], a[72:75], v[80:83], a[0:15]
    buffer_load_dwordx4 a[204:207], v39, s[60:63], s79 offen
    s_add_u32 s79, s79, 4096
    v_exp_f32 v73, v73
    v_exp_f32 v74, v74
    v_mfma_f32_32x32x16_bf16 v[192:207], a[92:95], a[128:131], v[192:207]
    v_cvt_pk_bf16_f32 v92, v72, v73
    v_exp_f32 v75, v75
    v_exp_f32 v76, v76
    v_cvt_pk_bf16_f32 v93, v74, v75
    v_mfma_f32_32x32x16_bf16 a[0:15], a[76:79], v[84:87], a[0:15]
    v_exp_f32 v77, v77
    v_exp_f32 v78, v78
    v_cvt_pk_bf16_f32 v94, v76, v77
    v_exp_f32 v79, v79
    v_smfmac_f32_16x16x64_bf16 a[32:35], v[32:35], v[80:87], v11
    s_waitcnt lgkmcnt(0)
    v_mfma_f32_32x32x16_bf16 v[128:143], a[88:91], a[144:147], v[128:143]
    ds_read_b128 a[80:83], v6 offset:22528
    ds_read_b128 a[84:87], v6 offset:23552
    s_add_u32 m0, s81, 4096
    ds_read_b64_tr_b16 a[92:93], v21 offset:6144
    v_exp_f32 v48, v48
    v_cvt_pk_bf16_f32 v95, v78, v79
    v_mfma_f32_32x32x16_bf16 v[64:79], a[64:67], a[48:51], v[112:127]
    ds_read_b64_tr_b16 a[94:95], v21 offset:6656
    buffer_load_dwordx4 v16, s[64:67], s80 offen offset:0 lds
    v_exp_f32 v49, v49
    v_exp_f32 v50, v50
    v_mfma_f32_32x32x16_bf16 v[144:159], a[88:91], a[148:151], v[144:159]
    v_cvt_pk_bf16_f32 v80, v48, v49
    v_exp_f32 v51, v51
    v_exp_f32 v52, v52
    v_cvt_pk_bf16_f32 v81, v50, v51
    v_mfma_f32_32x32x16_bf16 v[64:79], a[68:71], a[52:55], v[64:79]
    buffer_load_dwordx4 v17, s[64:67], s80 offen offset:1024 lds
    s_add_u32 s80, s80, 32768
    v_exp_f32 v53, v53
    v_exp_f32 v54, v54
    v_mfma_f32_32x32x16_bf16 v[160:175], a[88:91], a[152:155], v[160:175]
    v_cvt_pk_bf16_f32 v82, v52, v53
    v_exp_f32 v55, v55
    v_exp_f32 v56, v56
    v_cvt_pk_bf16_f32 v83, v54, v55
    v_mfma_f32_32x32x16_bf16 a[16:31], a[72:75], v[88:91], a[16:31]
    buffer_load_dwordx4 a[208:211], v36, s[60:63], s79 offen
    v_exp_f32 v57, v57
    v_exp_f32 v58, v58
    v_mfma_f32_32x32x16_bf16 v[176:191], a[88:91], a[156:159], v[176:191]
    v_cvt_pk_bf16_f32 v84, v56, v57
    v_exp_f32 v59, v59
    v_exp_f32 v60, v60
    v_cvt_pk_bf16_f32 v85, v58, v59
    v_mfma_f32_32x32x16_bf16 a[16:31], a[76:79], v[92:95], a[16:31]
    v_exp_f32 v61, v61
    v_exp_f32 v62, v62
    v_cvt_pk_bf16_f32 v86, v60, v61
    v_exp_f32 v63, v63
    v_smfmac_f32_16x16x64_bf16 a[36:39], v[32:35], v[88:95], v11
    s_waitcnt vmcnt(21) lgkmcnt(0)
    v_mfma_f32_32x32x16_bf16 v[240:255], a[92:95], a[156:159], v[240:255]
    ds_read_b128 a[64:67], v6 offset:28672
    ds_read_b128 a[68:71], v6 offset:29696
    ds_read_b64_tr_b16 a[88:89], v20 offset:0
    ds_read_b64_tr_b16 a[90:91], v20 offset:512
    v_exp_f32 v64, v64
    v_cvt_pk_bf16_f32 v87, v62, v63
    v_mfma_f32_32x32x16_bf16 v[48:63], a[56:59], a[40:43], v[96:111]
    buffer_load_dwordx4 a[212:215], v37, s[60:63], s79 offen
    v_exp_f32 v65, v65
    v_exp_f32 v66, v66
    v_mfma_f32_32x32x16_bf16 v[224:239], a[92:95], a[152:155], v[224:239]
    v_cvt_pk_bf16_f32 v88, v64, v65
    v_exp_f32 v67, v67
    v_exp_f32 v68, v68
    v_cvt_pk_bf16_f32 v89, v66, v67
    v_mfma_f32_32x32x16_bf16 v[48:63], a[60:63], a[44:47], v[48:63]
    buffer_load_dwordx4 a[216:219], v38, s[60:63], s79 offen
    v_exp_f32 v69, v69
    v_exp_f32 v70, v70
    v_mfma_f32_32x32x16_bf16 v[208:223], a[92:95], a[148:151], v[208:223]
    v_cvt_pk_bf16_f32 v90, v68, v69
    v_exp_f32 v71, v71
    v_exp_f32 v72, v72
    v_cvt_pk_bf16_f32 v91, v70, v71
    v_mfma_f32_32x32x16_bf16 a[0:15], a[80:83], v[80:83], a[0:15]
    buffer_load_dwordx4 a[220:223], v39, s[60:63], s79 offen
    s_add_u32 s79, s79, 4096
    v_exp_f32 v73, v73
    v_exp_f32 v74, v74
    v_mfma_f32_32x32x16_bf16 v[192:207], a[92:95], a[144:147], v[192:207]
    v_cvt_pk_bf16_f32 v92, v72, v73
    v_exp_f32 v75, v75
    v_exp_f32 v76, v76
    v_cvt_pk_bf16_f32 v93, v74, v75
    v_mfma_f32_32x32x16_bf16 a[0:15], a[84:87], v[84:87], a[0:15]
    v_exp_f32 v77, v77
    v_exp_f32 v78, v78
    v_cvt_pk_bf16_f32 v94, v76, v77
    v_exp_f32 v79, v79
    v_smfmac_f32_16x16x64_bf16 a[32:35], v[32:35], v[80:87], v11
    s_waitcnt lgkmcnt(0)
    v_mfma_f32_32x32x16_bf16 v[128:143], a[88:91], a[160:163], v[128:143]
    ds_read_b128 a[72:75], v6 offset:26624
    ds_read_b128 a[76:79], v6 offset:27648
    s_add_u32 m0, s81, 6144
    ds_read_b64_tr_b16 a[92:93], v21 offset:0
    v_exp_f32 v48, v48
    v_cvt_pk_bf16_f32 v95, v78, v79
    v_mfma_f32_32x32x16_bf16 v[64:79], a[56:59], a[48:51], v[112:127]
    ds_read_b64_tr_b16 a[94:95], v21 offset:512
    buffer_load_dwordx4 v16, s[64:67], s80 offen offset:0 lds
    v_exp_f32 v49, v49
    v_exp_f32 v50, v50
    v_mfma_f32_32x32x16_bf16 v[144:159], a[88:91], a[164:167], v[144:159]
    v_cvt_pk_bf16_f32 v80, v48, v49
    v_exp_f32 v51, v51
    v_exp_f32 v52, v52
    v_cvt_pk_bf16_f32 v81, v50, v51
    v_mfma_f32_32x32x16_bf16 v[64:79], a[60:63], a[52:55], v[64:79]
    buffer_load_dwordx4 v17, s[64:67], s80 offen offset:1024 lds
    s_add_u32 s80, s80, 32768
    v_exp_f32 v53, v53
    v_exp_f32 v54, v54
    v_mfma_f32_32x32x16_bf16 v[160:175], a[88:91], a[168:171], v[160:175]
    v_cvt_pk_bf16_f32 v82, v52, v53
    v_exp_f32 v55, v55
    v_exp_f32 v56, v56
    v_cvt_pk_bf16_f32 v83, v54, v55
    v_mfma_f32_32x32x16_bf16 a[16:31], a[80:83], v[88:91], a[16:31]
    buffer_load_dwordx4 a[96:99], v36, s[60:63], s79 offen
    v_exp_f32 v57, v57
    v_exp_f32 v58, v58
    v_mfma_f32_32x32x16_bf16 v[176:191], a[88:91], a[172:175], v[176:191]
    v_cvt_pk_bf16_f32 v84, v56, v57
    v_exp_f32 v59, v59
    v_exp_f32 v60, v60
    v_cvt_pk_bf16_f32 v85, v58, v59
    v_mfma_f32_32x32x16_bf16 a[16:31], a[84:87], v[92:95], a[16:31]
    v_exp_f32 v61, v61
    v_exp_f32 v62, v62
    v_cvt_pk_bf16_f32 v86, v60, v61
    v_exp_f32 v63, v63
    v_smfmac_f32_16x16x64_bf16 a[36:39], v[32:35], v[88:95], v11
    s_waitcnt vmcnt(15) lgkmcnt(0)
    v_mfma_f32_32x32x16_bf16 v[240:255], a[92:95], a[172:175], v[240:255]
    s_barrier
    ds_read_b128 a[56:59], v6 offset:32768
    ds_read_b128 a[60:63], v6 offset:33792
    v_exp_f32 v64, v64
    v_cvt_pk_bf16_f32 v87, v62, v63
    v_mfma_f32_32x32x16_bf16 v[48:63], a[64:67], a[40:43], v[96:111]
    s_add_u32 m0, s78, 0
    ds_read_b64_tr_b16 a[88:89], v20 offset:2048
    ds_read_b64_tr_b16 a[90:91], v20 offset:2560
    buffer_load_dwordx4 a[100:103], v37, s[60:63], s79 offen
    v_exp_f32 v65, v65
    v_mfma_f32_32x32x16_bf16 v[224:239], a[92:95], a[168:171], v[224:239]
    v_exp_f32 v66, v66
    v_cvt_pk_bf16_f32 v88, v64, v65
    v_exp_f32 v67, v67
    v_exp_f32 v68, v68
    v_mfma_f32_32x32x16_bf16 v[48:63], a[68:71], a[44:47], v[48:63]
    buffer_load_dwordx4 a[104:107], v38, s[60:63], s79 offen
    v_cvt_pk_bf16_f32 v89, v66, v67
    v_exp_f32 v69, v69
    v_exp_f32 v70, v70
    v_mfma_f32_32x32x16_bf16 v[208:223], a[92:95], a[164:167], v[208:223]
    v_cvt_pk_bf16_f32 v90, v68, v69
    v_exp_f32 v71, v71
    v_exp_f32 v72, v72
    v_cvt_pk_bf16_f32 v91, v70, v71
    v_mfma_f32_32x32x16_bf16 a[0:15], a[72:75], v[80:83], a[0:15]
    buffer_load_dwordx4 a[108:111], v39, s[60:63], s79 offen
    s_add_u32 s79, s79, 4096
    v_exp_f32 v73, v73
    v_exp_f32 v74, v74
    v_mfma_f32_32x32x16_bf16 v[192:207], a[92:95], a[160:163], v[192:207]
    v_cvt_pk_bf16_f32 v92, v72, v73
    v_exp_f32 v75, v75
    v_exp_f32 v76, v76
    v_cvt_pk_bf16_f32 v93, v74, v75
    v_exp_f32 v77, v77
    v_mfma_f32_32x32x16_bf16 a[0:15], a[76:79], v[84:87], a[0:15]
    buffer_load_dwordx4 v9, s[56:59], s76 offen offset:0 lds
    v_exp_f32 v78, v78
    v_cvt_pk_bf16_f32 v94, v76, v77
    v_exp_f32 v79, v79
    v_smfmac_f32_16x16x64_bf16 a[32:35], v[32:35], v[80:87], v11
    s_waitcnt lgkmcnt(0)
    v_mfma_f32_32x32x16_bf16 v[128:143], a[88:91], a[176:179], v[128:143]
    ds_read_b128 a[80:83], v6 offset:30720
    ds_read_b128 a[84:87], v6 offset:31744
    s_add_u32 m0, s81, 0
    ds_read_b64_tr_b16 a[92:93], v21 offset:2048
    v_exp_f32 v48, v48
    v_cvt_pk_bf16_f32 v95, v78, v79
    v_mfma_f32_32x32x16_bf16 v[64:79], a[64:67], a[48:51], v[112:127]
    ds_read_b64_tr_b16 a[94:95], v21 offset:2560
    buffer_load_dwordx4 v16, s[64:67], s80 offen offset:0 lds
    v_exp_f32 v49, v49
    v_exp_f32 v50, v50
    v_mfma_f32_32x32x16_bf16 v[144:159], a[88:91], a[180:183], v[144:159]
    v_cvt_pk_bf16_f32 v80, v48, v49
    v_exp_f32 v51, v51
    v_exp_f32 v52, v52
    v_cvt_pk_bf16_f32 v81, v50, v51
    v_mfma_f32_32x32x16_bf16 v[64:79], a[68:71], a[52:55], v[64:79]
    buffer_load_dwordx4 v17, s[64:67], s80 offen offset:1024 lds
    s_add_u32 s80, s80, 32768
    v_exp_f32 v53, v53
    v_exp_f32 v54, v54
    v_mfma_f32_32x32x16_bf16 v[160:175], a[88:91], a[184:187], v[160:175]
    v_cvt_pk_bf16_f32 v82, v52, v53
    v_exp_f32 v55, v55
    v_exp_f32 v56, v56
    v_cvt_pk_bf16_f32 v83, v54, v55
    v_mfma_f32_32x32x16_bf16 a[16:31], a[72:75], v[88:91], a[16:31]
    buffer_load_dwordx4 a[112:115], v36, s[60:63], s79 offen
    v_exp_f32 v57, v57
    v_exp_f32 v58, v58
    v_mfma_f32_32x32x16_bf16 v[176:191], a[88:91], a[188:191], v[176:191]
    v_cvt_pk_bf16_f32 v84, v56, v57
    v_exp_f32 v59, v59
    v_exp_f32 v60, v60
    v_cvt_pk_bf16_f32 v85, v58, v59
    v_mfma_f32_32x32x16_bf16 a[16:31], a[76:79], v[92:95], a[16:31]
    v_exp_f32 v61, v61
    v_exp_f32 v62, v62
    v_cvt_pk_bf16_f32 v86, v60, v61
    v_exp_f32 v63, v63
    v_smfmac_f32_16x16x64_bf16 a[36:39], v[32:35], v[88:95], v11
    s_waitcnt vmcnt(14) lgkmcnt(0)
    v_mfma_f32_32x32x16_bf16 v[240:255], a[92:95], a[188:191], v[240:255]
    ds_read_b128 a[64:67], v6 offset:36864
    ds_read_b128 a[68:71], v6 offset:37888
    s_add_u32 m0, s78, 0
    ds_read_b64_tr_b16 a[88:89], v20 offset:4096
    v_exp_f32 v64, v64
    v_cvt_pk_bf16_f32 v87, v62, v63
    v_mfma_f32_32x32x16_bf16 v[48:63], a[56:59], a[40:43], v[96:111]
    ds_read_b64_tr_b16 a[90:91], v20 offset:4608
    buffer_load_dwordx4 a[116:119], v37, s[60:63], s79 offen
    v_exp_f32 v65, v65
    v_exp_f32 v66, v66
    v_mfma_f32_32x32x16_bf16 v[224:239], a[92:95], a[184:187], v[224:239]
    v_cvt_pk_bf16_f32 v88, v64, v65
    v_exp_f32 v67, v67
    v_exp_f32 v68, v68
    v_cvt_pk_bf16_f32 v89, v66, v67
    v_mfma_f32_32x32x16_bf16 v[48:63], a[60:63], a[44:47], v[48:63]
    buffer_load_dwordx4 a[120:123], v38, s[60:63], s79 offen
    v_exp_f32 v69, v69
    v_exp_f32 v70, v70
    v_cvt_pk_bf16_f32 v90, v68, v69
    v_mfma_f32_32x32x16_bf16 v[208:223], a[92:95], a[180:183], v[208:223]
    v_exp_f32 v71, v71
    v_exp_f32 v72, v72
    v_cvt_pk_bf16_f32 v91, v70, v71
    v_exp_f32 v73, v73
    v_mfma_f32_32x32x16_bf16 a[0:15], a[80:83], v[80:83], a[0:15]
    buffer_load_dwordx4 a[124:127], v39, s[60:63], s79 offen
    v_exp_f32 v74, v74
    v_cvt_pk_bf16_f32 v92, v72, v73
    v_exp_f32 v75, v75
    v_mfma_f32_32x32x16_bf16 v[192:207], a[92:95], a[176:179], v[192:207]
    v_exp_f32 v76, v76
    v_cvt_pk_bf16_f32 v93, v74, v75
    v_exp_f32 v77, v77
    v_exp_f32 v78, v78
    v_mfma_f32_32x32x16_bf16 a[0:15], a[84:87], v[84:87], a[0:15]
    s_add_u32 s79, s79, 4096
    buffer_load_dwordx4 v9, s[56:59], s76 offen offset:1024 lds
    s_xor_b32 s78, s78, 32768
    v_cvt_pk_bf16_f32 v94, v76, v77
    v_exp_f32 v79, v79
    v_smfmac_f32_16x16x64_bf16 a[32:35], v[32:35], v[80:87], v11
    s_mov_b32 s48, 5
gated_mix__softmax_full_mha__glu_gated_bilinear__prompt_kernel_loop:
    s_waitcnt lgkmcnt(0)
    v_mfma_f32_32x32x16_bf16 v[128:143], a[88:91], a[192:195], v[128:143]
    ds_read_b128 a[72:75], v7 offset:2048
    ds_read_b128 a[76:79], v7 offset:3072
    s_add_u32 m0, s81, 2048
    ds_read_b64_tr_b16 a[92:93], v21 offset:4096
    v_exp_f32 v48, v48
    v_cvt_pk_bf16_f32 v95, v78, v79
    v_mfma_f32_32x32x16_bf16 v[64:79], a[56:59], a[48:51], v[112:127]
    ds_read_b64_tr_b16 a[94:95], v21 offset:4608
    buffer_load_dwordx4 v16, s[64:67], s80 offen offset:0 lds
    v_exp_f32 v49, v49
    v_exp_f32 v50, v50
    v_mfma_f32_32x32x16_bf16 v[144:159], a[88:91], a[196:199], v[144:159]
    v_cvt_pk_bf16_f32 v80, v48, v49
    v_exp_f32 v51, v51
    v_exp_f32 v52, v52
    v_cvt_pk_bf16_f32 v81, v50, v51
    v_mfma_f32_32x32x16_bf16 v[64:79], a[60:63], a[52:55], v[64:79]
    buffer_load_dwordx4 v17, s[64:67], s80 offen offset:1024 lds
    s_add_u32 s80, s80, 32768
    v_exp_f32 v53, v53
    v_exp_f32 v54, v54
    v_mfma_f32_32x32x16_bf16 v[160:175], a[88:91], a[200:203], v[160:175]
    v_cvt_pk_bf16_f32 v82, v52, v53
    v_exp_f32 v55, v55
    v_exp_f32 v56, v56
    v_cvt_pk_bf16_f32 v83, v54, v55
    v_mfma_f32_32x32x16_bf16 a[16:31], a[80:83], v[88:91], a[16:31]
    buffer_load_dwordx4 a[128:131], v36, s[60:63], s79 offen
    v_exp_f32 v57, v57
    v_exp_f32 v58, v58
    v_mfma_f32_32x32x16_bf16 v[176:191], a[88:91], a[204:207], v[176:191]
    v_cvt_pk_bf16_f32 v84, v56, v57
    v_exp_f32 v59, v59
    v_exp_f32 v60, v60
    v_cvt_pk_bf16_f32 v85, v58, v59
    v_mfma_f32_32x32x16_bf16 a[16:31], a[84:87], v[92:95], a[16:31]
    v_exp_f32 v61, v61
    v_exp_f32 v62, v62
    v_cvt_pk_bf16_f32 v86, v60, v61
    v_exp_f32 v63, v63
    v_smfmac_f32_16x16x64_bf16 a[36:39], v[32:35], v[88:95], v11
    s_waitcnt vmcnt(15) lgkmcnt(0)
    v_mfma_f32_32x32x16_bf16 v[240:255], a[92:95], a[204:207], v[240:255]
    ds_read_b128 a[56:59], v7 offset:8192
    ds_read_b128 a[60:63], v7 offset:9216
    s_xor_b32 m0, s78, 32768
    ds_read_b64_tr_b16 a[88:89], v20 offset:6144
    v_exp_f32 v64, v64
    v_cvt_pk_bf16_f32 v87, v62, v63
    v_mfma_f32_32x32x16_bf16 v[48:63], a[64:67], a[40:43], v[96:111]
    ds_read_b64_tr_b16 a[90:91], v20 offset:6656
    buffer_load_dwordx4 a[132:135], v37, s[60:63], s79 offen
    v_exp_f32 v65, v65
    v_exp_f32 v66, v66
    v_mfma_f32_32x32x16_bf16 v[224:239], a[92:95], a[200:203], v[224:239]
    v_cvt_pk_bf16_f32 v88, v64, v65
    v_exp_f32 v67, v67
    v_exp_f32 v68, v68
    v_cvt_pk_bf16_f32 v89, v66, v67
    v_mfma_f32_32x32x16_bf16 v[48:63], a[68:71], a[44:47], v[48:63]
    buffer_load_dwordx4 a[136:139], v38, s[60:63], s79 offen
    v_exp_f32 v69, v69
    v_exp_f32 v70, v70
    v_cvt_pk_bf16_f32 v90, v68, v69
    v_mfma_f32_32x32x16_bf16 v[208:223], a[92:95], a[196:199], v[208:223]
    v_exp_f32 v71, v71
    v_exp_f32 v72, v72
    v_cvt_pk_bf16_f32 v91, v70, v71
    v_exp_f32 v73, v73
    v_mfma_f32_32x32x16_bf16 a[0:15], a[72:75], v[80:83], a[0:15]
    buffer_load_dwordx4 a[140:143], v39, s[60:63], s79 offen
    s_add_u32 s79, s79, 4096
    v_exp_f32 v74, v74
    v_cvt_pk_bf16_f32 v92, v72, v73
    v_mfma_f32_32x32x16_bf16 v[192:207], a[92:95], a[192:195], v[192:207]
    v_exp_f32 v75, v75
    v_exp_f32 v76, v76
    v_cvt_pk_bf16_f32 v93, v74, v75
    v_exp_f32 v77, v77
    v_mfma_f32_32x32x16_bf16 a[0:15], a[76:79], v[84:87], a[0:15]
    buffer_load_dwordx4 v9, s[56:59], s76 offen offset:2048 lds
    v_exp_f32 v78, v78
    v_cvt_pk_bf16_f32 v94, v76, v77
    v_exp_f32 v79, v79
    v_smfmac_f32_16x16x64_bf16 a[32:35], v[32:35], v[80:87], v11
    s_waitcnt lgkmcnt(0)
    v_mfma_f32_32x32x16_bf16 v[128:143], a[88:91], a[208:211], v[128:143]
    ds_read_b128 a[80:83], v7 offset:6144
    ds_read_b128 a[84:87], v7 offset:7168
    s_add_u32 m0, s81, 4096
    ds_read_b64_tr_b16 a[92:93], v21 offset:6144
    v_exp_f32 v48, v48
    v_cvt_pk_bf16_f32 v95, v78, v79
    v_mfma_f32_32x32x16_bf16 v[64:79], a[64:67], a[48:51], v[112:127]
    ds_read_b64_tr_b16 a[94:95], v21 offset:6656
    buffer_load_dwordx4 v16, s[64:67], s80 offen offset:0 lds
    v_exp_f32 v49, v49
    v_exp_f32 v50, v50
    v_mfma_f32_32x32x16_bf16 v[144:159], a[88:91], a[212:215], v[144:159]
    v_cvt_pk_bf16_f32 v80, v48, v49
    v_exp_f32 v51, v51
    v_exp_f32 v52, v52
    v_cvt_pk_bf16_f32 v81, v50, v51
    v_mfma_f32_32x32x16_bf16 v[64:79], a[68:71], a[52:55], v[64:79]
    buffer_load_dwordx4 v17, s[64:67], s80 offen offset:1024 lds
    s_add_u32 s80, s80, 32768
    v_exp_f32 v53, v53
    v_exp_f32 v54, v54
    v_mfma_f32_32x32x16_bf16 v[160:175], a[88:91], a[216:219], v[160:175]
    v_cvt_pk_bf16_f32 v82, v52, v53
    v_exp_f32 v55, v55
    v_exp_f32 v56, v56
    v_cvt_pk_bf16_f32 v83, v54, v55
    v_mfma_f32_32x32x16_bf16 a[16:31], a[72:75], v[88:91], a[16:31]
    buffer_load_dwordx4 a[144:147], v36, s[60:63], s79 offen
    v_exp_f32 v57, v57
    v_exp_f32 v58, v58
    v_mfma_f32_32x32x16_bf16 v[176:191], a[88:91], a[220:223], v[176:191]
    v_cvt_pk_bf16_f32 v84, v56, v57
    v_exp_f32 v59, v59
    v_exp_f32 v60, v60
    v_cvt_pk_bf16_f32 v85, v58, v59
    v_mfma_f32_32x32x16_bf16 a[16:31], a[76:79], v[92:95], a[16:31]
    v_exp_f32 v61, v61
    v_exp_f32 v62, v62
    v_cvt_pk_bf16_f32 v86, v60, v61
    v_exp_f32 v63, v63
    v_smfmac_f32_16x16x64_bf16 a[36:39], v[32:35], v[88:95], v11
    s_waitcnt vmcnt(15) lgkmcnt(0)
    v_mfma_f32_32x32x16_bf16 v[240:255], a[92:95], a[220:223], v[240:255]
    ds_read_b128 a[64:67], v7 offset:12288
    ds_read_b128 a[68:71], v7 offset:13312
    s_xor_b32 m0, s78, 32768
    ds_read_b64_tr_b16 a[88:89], v20 offset:0
    ds_read_b64_tr_b16 a[90:91], v20 offset:512
    v_exp_f32 v64, v64
    v_cvt_pk_bf16_f32 v87, v62, v63
    v_mfma_f32_32x32x16_bf16 v[48:63], a[56:59], a[40:43], v[96:111]
    buffer_load_dwordx4 a[148:151], v37, s[60:63], s79 offen
    v_exp_f32 v65, v65
    v_exp_f32 v66, v66
    v_cvt_pk_bf16_f32 v88, v64, v65
    v_mfma_f32_32x32x16_bf16 v[224:239], a[92:95], a[216:219], v[224:239]
    v_exp_f32 v67, v67
    v_exp_f32 v68, v68
    v_cvt_pk_bf16_f32 v89, v66, v67
    v_exp_f32 v69, v69
    v_mfma_f32_32x32x16_bf16 v[48:63], a[60:63], a[44:47], v[48:63]
    buffer_load_dwordx4 a[152:155], v38, s[60:63], s79 offen
    v_exp_f32 v70, v70
    v_cvt_pk_bf16_f32 v90, v68, v69
    v_exp_f32 v71, v71
    v_mfma_f32_32x32x16_bf16 v[208:223], a[92:95], a[212:215], v[208:223]
    v_exp_f32 v72, v72
    v_cvt_pk_bf16_f32 v91, v70, v71
    v_exp_f32 v73, v73
    v_exp_f32 v74, v74
    v_mfma_f32_32x32x16_bf16 a[0:15], a[80:83], v[80:83], a[0:15]
    buffer_load_dwordx4 a[156:159], v39, s[60:63], s79 offen
    v_cvt_pk_bf16_f32 v92, v72, v73
    v_exp_f32 v75, v75
    v_exp_f32 v76, v76
    v_mfma_f32_32x32x16_bf16 v[192:207], a[92:95], a[208:211], v[192:207]
    s_add_u32 s79, s79, 4096
    v_cvt_pk_bf16_f32 v93, v74, v75
    v_exp_f32 v77, v77
    v_exp_f32 v78, v78
    v_cvt_pk_bf16_f32 v94, v76, v77
    v_mfma_f32_32x32x16_bf16 a[0:15], a[84:87], v[84:87], a[0:15]
    buffer_load_dwordx4 v9, s[56:59], s76 offen offset:3072 lds
    s_add_u32 s76, s76, 16384
    s_and_b32 s76, s76, 0x3ffff
    s_sub_u32 s77, s77, 1
    s_cselect_b32 s58, 0, s58
    v_exp_f32 v79, v79
    v_smfmac_f32_16x16x64_bf16 a[32:35], v[32:35], v[80:87], v11
    s_waitcnt lgkmcnt(0)
    v_mfma_f32_32x32x16_bf16 v[128:143], a[88:91], a[96:99], v[128:143]
    ds_read_b128 a[72:75], v7 offset:10240
    ds_read_b128 a[76:79], v7 offset:11264
    s_add_u32 m0, s81, 6144
    ds_read_b64_tr_b16 a[92:93], v21 offset:0
    v_exp_f32 v48, v48
    v_cvt_pk_bf16_f32 v95, v78, v79
    v_mfma_f32_32x32x16_bf16 v[64:79], a[56:59], a[48:51], v[112:127]
    ds_read_b64_tr_b16 a[94:95], v21 offset:512
    buffer_load_dwordx4 v16, s[64:67], s80 offen offset:0 lds
    v_exp_f32 v49, v49
    v_exp_f32 v50, v50
    v_mfma_f32_32x32x16_bf16 v[144:159], a[88:91], a[100:103], v[144:159]
    v_cvt_pk_bf16_f32 v80, v48, v49
    v_exp_f32 v51, v51
    v_exp_f32 v52, v52
    v_cvt_pk_bf16_f32 v81, v50, v51
    v_mfma_f32_32x32x16_bf16 v[64:79], a[60:63], a[52:55], v[64:79]
    buffer_load_dwordx4 v17, s[64:67], s80 offen offset:1024 lds
    s_add_u32 s80, s80, 32768
    v_exp_f32 v53, v53
    v_exp_f32 v54, v54
    v_mfma_f32_32x32x16_bf16 v[160:175], a[88:91], a[104:107], v[160:175]
    v_cvt_pk_bf16_f32 v82, v52, v53
    v_exp_f32 v55, v55
    v_exp_f32 v56, v56
    v_cvt_pk_bf16_f32 v83, v54, v55
    v_mfma_f32_32x32x16_bf16 a[16:31], a[80:83], v[88:91], a[16:31]
    buffer_load_dwordx4 a[160:163], v36, s[60:63], s79 offen
    v_exp_f32 v57, v57
    v_exp_f32 v58, v58
    v_mfma_f32_32x32x16_bf16 v[176:191], a[88:91], a[108:111], v[176:191]
    v_cvt_pk_bf16_f32 v84, v56, v57
    v_exp_f32 v59, v59
    v_exp_f32 v60, v60
    v_cvt_pk_bf16_f32 v85, v58, v59
    v_mfma_f32_32x32x16_bf16 a[16:31], a[84:87], v[92:95], a[16:31]
    v_exp_f32 v61, v61
    v_exp_f32 v62, v62
    v_cvt_pk_bf16_f32 v86, v60, v61
    v_exp_f32 v63, v63
    v_smfmac_f32_16x16x64_bf16 a[36:39], v[32:35], v[88:95], v11
    s_waitcnt vmcnt(15) lgkmcnt(0)
    v_mfma_f32_32x32x16_bf16 v[240:255], a[92:95], a[108:111], v[240:255]
    s_barrier
    ds_read_b128 a[56:59], v7 offset:16384
    ds_read_b128 a[60:63], v7 offset:17408
    v_exp_f32 v64, v64
    v_cvt_pk_bf16_f32 v87, v62, v63
    v_mfma_f32_32x32x16_bf16 v[48:63], a[64:67], a[40:43], v[96:111]
    s_xor_b32 m0, s78, 49152
    ds_read_b64_tr_b16 a[88:89], v20 offset:2048
    ds_read_b64_tr_b16 a[90:91], v20 offset:2560
    buffer_load_dwordx4 a[164:167], v37, s[60:63], s79 offen
    v_exp_f32 v65, v65
    v_mfma_f32_32x32x16_bf16 v[224:239], a[92:95], a[104:107], v[224:239]
    v_exp_f32 v66, v66
    v_cvt_pk_bf16_f32 v88, v64, v65
    v_exp_f32 v67, v67
    v_exp_f32 v68, v68
    v_mfma_f32_32x32x16_bf16 v[48:63], a[68:71], a[44:47], v[48:63]
    buffer_load_dwordx4 a[168:171], v38, s[60:63], s79 offen
    v_cvt_pk_bf16_f32 v89, v66, v67
    v_exp_f32 v69, v69
    v_exp_f32 v70, v70
    v_mfma_f32_32x32x16_bf16 v[208:223], a[92:95], a[100:103], v[208:223]
    v_cvt_pk_bf16_f32 v90, v68, v69
    v_exp_f32 v71, v71
    v_exp_f32 v72, v72
    v_cvt_pk_bf16_f32 v91, v70, v71
    v_mfma_f32_32x32x16_bf16 a[0:15], a[72:75], v[80:83], a[0:15]
    buffer_load_dwordx4 a[172:175], v39, s[60:63], s79 offen
    s_add_u32 s79, s79, 4096
    v_exp_f32 v73, v73
    v_exp_f32 v74, v74
    v_mfma_f32_32x32x16_bf16 v[192:207], a[92:95], a[96:99], v[192:207]
    v_cvt_pk_bf16_f32 v92, v72, v73
    v_exp_f32 v75, v75
    v_exp_f32 v76, v76
    v_cvt_pk_bf16_f32 v93, v74, v75
    v_exp_f32 v77, v77
    v_mfma_f32_32x32x16_bf16 a[0:15], a[76:79], v[84:87], a[0:15]
    buffer_load_dwordx4 v9, s[56:59], s76 offen offset:0 lds
    v_exp_f32 v78, v78
    v_cvt_pk_bf16_f32 v94, v76, v77
    v_exp_f32 v79, v79
    v_smfmac_f32_16x16x64_bf16 a[32:35], v[32:35], v[80:87], v11
    s_waitcnt lgkmcnt(0)
    v_mfma_f32_32x32x16_bf16 v[128:143], a[88:91], a[112:115], v[128:143]
    ds_read_b128 a[80:83], v7 offset:14336
    ds_read_b128 a[84:87], v7 offset:15360
    s_add_u32 m0, s81, 0
    ds_read_b64_tr_b16 a[92:93], v21 offset:2048
    v_exp_f32 v48, v48
    v_cvt_pk_bf16_f32 v95, v78, v79
    v_mfma_f32_32x32x16_bf16 v[64:79], a[64:67], a[48:51], v[112:127]
    ds_read_b64_tr_b16 a[94:95], v21 offset:2560
    buffer_load_dwordx4 v16, s[64:67], s80 offen offset:0 lds
    v_exp_f32 v49, v49
    v_exp_f32 v50, v50
    v_mfma_f32_32x32x16_bf16 v[144:159], a[88:91], a[116:119], v[144:159]
    v_cvt_pk_bf16_f32 v80, v48, v49
    v_exp_f32 v51, v51
    v_exp_f32 v52, v52
    v_cvt_pk_bf16_f32 v81, v50, v51
    v_mfma_f32_32x32x16_bf16 v[64:79], a[68:71], a[52:55], v[64:79]
    buffer_load_dwordx4 v17, s[64:67], s80 offen offset:1024 lds
    s_add_u32 s80, s80, 32768
    v_exp_f32 v53, v53
    v_exp_f32 v54, v54
    v_mfma_f32_32x32x16_bf16 v[160:175], a[88:91], a[120:123], v[160:175]
    v_cvt_pk_bf16_f32 v82, v52, v53
    v_exp_f32 v55, v55
    v_exp_f32 v56, v56
    v_cvt_pk_bf16_f32 v83, v54, v55
    v_mfma_f32_32x32x16_bf16 a[16:31], a[72:75], v[88:91], a[16:31]
    buffer_load_dwordx4 a[176:179], v36, s[60:63], s79 offen
    v_exp_f32 v57, v57
    v_exp_f32 v58, v58
    v_mfma_f32_32x32x16_bf16 v[176:191], a[88:91], a[124:127], v[176:191]
    v_cvt_pk_bf16_f32 v84, v56, v57
    v_exp_f32 v59, v59
    v_exp_f32 v60, v60
    v_cvt_pk_bf16_f32 v85, v58, v59
    v_mfma_f32_32x32x16_bf16 a[16:31], a[76:79], v[92:95], a[16:31]
    v_exp_f32 v61, v61
    v_exp_f32 v62, v62
    v_cvt_pk_bf16_f32 v86, v60, v61
    v_exp_f32 v63, v63
    v_smfmac_f32_16x16x64_bf16 a[36:39], v[32:35], v[88:95], v11
    s_waitcnt vmcnt(15) lgkmcnt(0)
    v_mfma_f32_32x32x16_bf16 v[240:255], a[92:95], a[124:127], v[240:255]
    ds_read_b128 a[64:67], v7 offset:20480
    ds_read_b128 a[68:71], v7 offset:21504
    s_xor_b32 m0, s78, 49152
    ds_read_b64_tr_b16 a[88:89], v20 offset:4096
    v_exp_f32 v64, v64
    v_cvt_pk_bf16_f32 v87, v62, v63
    v_mfma_f32_32x32x16_bf16 v[48:63], a[56:59], a[40:43], v[96:111]
    ds_read_b64_tr_b16 a[90:91], v20 offset:4608
    buffer_load_dwordx4 a[180:183], v37, s[60:63], s79 offen
    v_exp_f32 v65, v65
    v_exp_f32 v66, v66
    v_mfma_f32_32x32x16_bf16 v[224:239], a[92:95], a[120:123], v[224:239]
    v_cvt_pk_bf16_f32 v88, v64, v65
    v_exp_f32 v67, v67
    v_exp_f32 v68, v68
    v_cvt_pk_bf16_f32 v89, v66, v67
    v_mfma_f32_32x32x16_bf16 v[48:63], a[60:63], a[44:47], v[48:63]
    buffer_load_dwordx4 a[184:187], v38, s[60:63], s79 offen
    v_exp_f32 v69, v69
    v_exp_f32 v70, v70
    v_cvt_pk_bf16_f32 v90, v68, v69
    v_mfma_f32_32x32x16_bf16 v[208:223], a[92:95], a[116:119], v[208:223]
    v_exp_f32 v71, v71
    v_exp_f32 v72, v72
    v_cvt_pk_bf16_f32 v91, v70, v71
    v_exp_f32 v73, v73
    v_mfma_f32_32x32x16_bf16 a[0:15], a[80:83], v[80:83], a[0:15]
    buffer_load_dwordx4 a[188:191], v39, s[60:63], s79 offen
    s_add_u32 s79, s79, 4096
    v_exp_f32 v74, v74
    v_cvt_pk_bf16_f32 v92, v72, v73
    v_mfma_f32_32x32x16_bf16 v[192:207], a[92:95], a[112:115], v[192:207]
    v_exp_f32 v75, v75
    v_exp_f32 v76, v76
    v_cvt_pk_bf16_f32 v93, v74, v75
    v_exp_f32 v77, v77
    v_mfma_f32_32x32x16_bf16 a[0:15], a[84:87], v[84:87], a[0:15]
    buffer_load_dwordx4 v9, s[56:59], s76 offen offset:1024 lds
    v_exp_f32 v78, v78
    v_cvt_pk_bf16_f32 v94, v76, v77
    v_exp_f32 v79, v79
    v_smfmac_f32_16x16x64_bf16 a[32:35], v[32:35], v[80:87], v11
    s_waitcnt lgkmcnt(0)
    v_mfma_f32_32x32x16_bf16 v[128:143], a[88:91], a[128:131], v[128:143]
    ds_read_b128 a[72:75], v7 offset:18432
    ds_read_b128 a[76:79], v7 offset:19456
    s_add_u32 m0, s81, 2048
    ds_read_b64_tr_b16 a[92:93], v21 offset:4096
    v_exp_f32 v48, v48
    v_cvt_pk_bf16_f32 v95, v78, v79
    v_mfma_f32_32x32x16_bf16 v[64:79], a[56:59], a[48:51], v[112:127]
    ds_read_b64_tr_b16 a[94:95], v21 offset:4608
    buffer_load_dwordx4 v16, s[64:67], s80 offen offset:0 lds
    v_exp_f32 v49, v49
    v_exp_f32 v50, v50
    v_mfma_f32_32x32x16_bf16 v[144:159], a[88:91], a[132:135], v[144:159]
    v_cvt_pk_bf16_f32 v80, v48, v49
    v_exp_f32 v51, v51
    v_exp_f32 v52, v52
    v_cvt_pk_bf16_f32 v81, v50, v51
    v_mfma_f32_32x32x16_bf16 v[64:79], a[60:63], a[52:55], v[64:79]
    buffer_load_dwordx4 v17, s[64:67], s80 offen offset:1024 lds
    s_add_u32 s80, s80, 32768
    v_exp_f32 v53, v53
    v_exp_f32 v54, v54
    v_mfma_f32_32x32x16_bf16 v[160:175], a[88:91], a[136:139], v[160:175]
    v_cvt_pk_bf16_f32 v82, v52, v53
    v_exp_f32 v55, v55
    v_exp_f32 v56, v56
    v_cvt_pk_bf16_f32 v83, v54, v55
    v_mfma_f32_32x32x16_bf16 a[16:31], a[80:83], v[88:91], a[16:31]
    buffer_load_dwordx4 a[192:195], v36, s[60:63], s79 offen
    v_exp_f32 v57, v57
    v_exp_f32 v58, v58
    v_mfma_f32_32x32x16_bf16 v[176:191], a[88:91], a[140:143], v[176:191]
    v_cvt_pk_bf16_f32 v84, v56, v57
    v_exp_f32 v59, v59
    v_exp_f32 v60, v60
    v_cvt_pk_bf16_f32 v85, v58, v59
    v_mfma_f32_32x32x16_bf16 a[16:31], a[84:87], v[92:95], a[16:31]
    v_exp_f32 v61, v61
    v_exp_f32 v62, v62
    v_cvt_pk_bf16_f32 v86, v60, v61
    v_exp_f32 v63, v63
    v_smfmac_f32_16x16x64_bf16 a[36:39], v[32:35], v[88:95], v11
    s_waitcnt vmcnt(15) lgkmcnt(0)
    v_mfma_f32_32x32x16_bf16 v[240:255], a[92:95], a[140:143], v[240:255]
    ds_read_b128 a[56:59], v7 offset:24576
    ds_read_b128 a[60:63], v7 offset:25600
    s_xor_b32 m0, s78, 49152
    ds_read_b64_tr_b16 a[88:89], v20 offset:6144
    v_exp_f32 v64, v64
    v_cvt_pk_bf16_f32 v87, v62, v63
    v_mfma_f32_32x32x16_bf16 v[48:63], a[64:67], a[40:43], v[96:111]
    ds_read_b64_tr_b16 a[90:91], v20 offset:6656
    buffer_load_dwordx4 a[196:199], v37, s[60:63], s79 offen
    v_exp_f32 v65, v65
    v_exp_f32 v66, v66
    v_mfma_f32_32x32x16_bf16 v[224:239], a[92:95], a[136:139], v[224:239]
    v_cvt_pk_bf16_f32 v88, v64, v65
    v_exp_f32 v67, v67
    v_exp_f32 v68, v68
    v_cvt_pk_bf16_f32 v89, v66, v67
    v_mfma_f32_32x32x16_bf16 v[48:63], a[68:71], a[44:47], v[48:63]
    buffer_load_dwordx4 a[200:203], v38, s[60:63], s79 offen
    v_exp_f32 v69, v69
    v_exp_f32 v70, v70
    v_cvt_pk_bf16_f32 v90, v68, v69
    v_mfma_f32_32x32x16_bf16 v[208:223], a[92:95], a[132:135], v[208:223]
    v_exp_f32 v71, v71
    v_exp_f32 v72, v72
    v_cvt_pk_bf16_f32 v91, v70, v71
    v_exp_f32 v73, v73
    v_mfma_f32_32x32x16_bf16 a[0:15], a[72:75], v[80:83], a[0:15]
    buffer_load_dwordx4 a[204:207], v39, s[60:63], s79 offen
    s_add_u32 s79, s79, 4096
    v_exp_f32 v74, v74
    v_cvt_pk_bf16_f32 v92, v72, v73
    v_mfma_f32_32x32x16_bf16 v[192:207], a[92:95], a[128:131], v[192:207]
    v_exp_f32 v75, v75
    v_exp_f32 v76, v76
    v_cvt_pk_bf16_f32 v93, v74, v75
    v_exp_f32 v77, v77
    v_mfma_f32_32x32x16_bf16 a[0:15], a[76:79], v[84:87], a[0:15]
    buffer_load_dwordx4 v9, s[56:59], s76 offen offset:2048 lds
    v_exp_f32 v78, v78
    v_cvt_pk_bf16_f32 v94, v76, v77
    v_exp_f32 v79, v79
    v_smfmac_f32_16x16x64_bf16 a[32:35], v[32:35], v[80:87], v11
    s_waitcnt lgkmcnt(0)
    v_mfma_f32_32x32x16_bf16 v[128:143], a[88:91], a[144:147], v[128:143]
    ds_read_b128 a[80:83], v7 offset:22528
    ds_read_b128 a[84:87], v7 offset:23552
    s_add_u32 m0, s81, 4096
    ds_read_b64_tr_b16 a[92:93], v21 offset:6144
    v_exp_f32 v48, v48
    v_cvt_pk_bf16_f32 v95, v78, v79
    v_mfma_f32_32x32x16_bf16 v[64:79], a[64:67], a[48:51], v[112:127]
    ds_read_b64_tr_b16 a[94:95], v21 offset:6656
    buffer_load_dwordx4 v16, s[64:67], s80 offen offset:0 lds
    v_exp_f32 v49, v49
    v_exp_f32 v50, v50
    v_mfma_f32_32x32x16_bf16 v[144:159], a[88:91], a[148:151], v[144:159]
    v_cvt_pk_bf16_f32 v80, v48, v49
    v_exp_f32 v51, v51
    v_exp_f32 v52, v52
    v_cvt_pk_bf16_f32 v81, v50, v51
    v_mfma_f32_32x32x16_bf16 v[64:79], a[68:71], a[52:55], v[64:79]
    buffer_load_dwordx4 v17, s[64:67], s80 offen offset:1024 lds
    s_add_u32 s80, s80, 32768
    v_exp_f32 v53, v53
    v_exp_f32 v54, v54
    v_mfma_f32_32x32x16_bf16 v[160:175], a[88:91], a[152:155], v[160:175]
    v_cvt_pk_bf16_f32 v82, v52, v53
    v_exp_f32 v55, v55
    v_exp_f32 v56, v56
    v_cvt_pk_bf16_f32 v83, v54, v55
    v_mfma_f32_32x32x16_bf16 a[16:31], a[72:75], v[88:91], a[16:31]
    buffer_load_dwordx4 a[208:211], v36, s[60:63], s79 offen
    v_exp_f32 v57, v57
    v_exp_f32 v58, v58
    v_mfma_f32_32x32x16_bf16 v[176:191], a[88:91], a[156:159], v[176:191]
    v_cvt_pk_bf16_f32 v84, v56, v57
    v_exp_f32 v59, v59
    v_exp_f32 v60, v60
    v_cvt_pk_bf16_f32 v85, v58, v59
    v_mfma_f32_32x32x16_bf16 a[16:31], a[76:79], v[92:95], a[16:31]
    v_exp_f32 v61, v61
    v_exp_f32 v62, v62
    v_cvt_pk_bf16_f32 v86, v60, v61
    v_exp_f32 v63, v63
    v_smfmac_f32_16x16x64_bf16 a[36:39], v[32:35], v[88:95], v11
    s_waitcnt vmcnt(15) lgkmcnt(0)
    v_mfma_f32_32x32x16_bf16 v[240:255], a[92:95], a[156:159], v[240:255]
    ds_read_b128 a[64:67], v7 offset:28672
    ds_read_b128 a[68:71], v7 offset:29696
    s_xor_b32 m0, s78, 49152
    ds_read_b64_tr_b16 a[88:89], v20 offset:0
    ds_read_b64_tr_b16 a[90:91], v20 offset:512
    v_exp_f32 v64, v64
    v_cvt_pk_bf16_f32 v87, v62, v63
    v_mfma_f32_32x32x16_bf16 v[48:63], a[56:59], a[40:43], v[96:111]
    buffer_load_dwordx4 a[212:215], v37, s[60:63], s79 offen
    v_exp_f32 v65, v65
    v_exp_f32 v66, v66
    v_cvt_pk_bf16_f32 v88, v64, v65
    v_mfma_f32_32x32x16_bf16 v[224:239], a[92:95], a[152:155], v[224:239]
    v_exp_f32 v67, v67
    v_exp_f32 v68, v68
    v_cvt_pk_bf16_f32 v89, v66, v67
    v_exp_f32 v69, v69
    v_mfma_f32_32x32x16_bf16 v[48:63], a[60:63], a[44:47], v[48:63]
    buffer_load_dwordx4 a[216:219], v38, s[60:63], s79 offen
    v_exp_f32 v70, v70
    v_cvt_pk_bf16_f32 v90, v68, v69
    v_exp_f32 v71, v71
    v_mfma_f32_32x32x16_bf16 v[208:223], a[92:95], a[148:151], v[208:223]
    v_exp_f32 v72, v72
    v_cvt_pk_bf16_f32 v91, v70, v71
    v_exp_f32 v73, v73
    v_exp_f32 v74, v74
    v_mfma_f32_32x32x16_bf16 a[0:15], a[80:83], v[80:83], a[0:15]
    buffer_load_dwordx4 a[220:223], v39, s[60:63], s79 offen
    v_cvt_pk_bf16_f32 v92, v72, v73
    v_exp_f32 v75, v75
    v_exp_f32 v76, v76
    v_mfma_f32_32x32x16_bf16 v[192:207], a[92:95], a[144:147], v[192:207]
    s_add_u32 s79, s79, 4096
    v_cvt_pk_bf16_f32 v93, v74, v75
    v_exp_f32 v77, v77
    v_exp_f32 v78, v78
    v_cvt_pk_bf16_f32 v94, v76, v77
    v_mfma_f32_32x32x16_bf16 a[0:15], a[84:87], v[84:87], a[0:15]
    buffer_load_dwordx4 v9, s[56:59], s76 offen offset:3072 lds
    s_add_u32 s76, s76, 16384
    s_and_b32 s76, s76, 0x3ffff
    s_sub_u32 s77, s77, 1
    s_cselect_b32 s58, 0, s58
    v_exp_f32 v79, v79
    v_smfmac_f32_16x16x64_bf16 a[32:35], v[32:35], v[80:87], v11
    s_waitcnt lgkmcnt(0)
    v_mfma_f32_32x32x16_bf16 v[128:143], a[88:91], a[160:163], v[128:143]
    ds_read_b128 a[72:75], v7 offset:26624
    ds_read_b128 a[76:79], v7 offset:27648
    s_add_u32 m0, s81, 6144
    ds_read_b64_tr_b16 a[92:93], v21 offset:0
    v_exp_f32 v48, v48
    v_cvt_pk_bf16_f32 v95, v78, v79
    v_mfma_f32_32x32x16_bf16 v[64:79], a[56:59], a[48:51], v[112:127]
    ds_read_b64_tr_b16 a[94:95], v21 offset:512
    buffer_load_dwordx4 v16, s[64:67], s80 offen offset:0 lds
    v_exp_f32 v49, v49
    v_exp_f32 v50, v50
    v_mfma_f32_32x32x16_bf16 v[144:159], a[88:91], a[164:167], v[144:159]
    v_cvt_pk_bf16_f32 v80, v48, v49
    v_exp_f32 v51, v51
    v_exp_f32 v52, v52
    v_cvt_pk_bf16_f32 v81, v50, v51
    v_mfma_f32_32x32x16_bf16 v[64:79], a[60:63], a[52:55], v[64:79]
    buffer_load_dwordx4 v17, s[64:67], s80 offen offset:1024 lds
    s_add_u32 s80, s80, 32768
    v_exp_f32 v53, v53
    v_exp_f32 v54, v54
    v_mfma_f32_32x32x16_bf16 v[160:175], a[88:91], a[168:171], v[160:175]
    v_cvt_pk_bf16_f32 v82, v52, v53
    v_exp_f32 v55, v55
    v_exp_f32 v56, v56
    v_cvt_pk_bf16_f32 v83, v54, v55
    v_mfma_f32_32x32x16_bf16 a[16:31], a[80:83], v[88:91], a[16:31]
    buffer_load_dwordx4 a[96:99], v36, s[60:63], s79 offen
    v_exp_f32 v57, v57
    v_exp_f32 v58, v58
    v_mfma_f32_32x32x16_bf16 v[176:191], a[88:91], a[172:175], v[176:191]
    v_cvt_pk_bf16_f32 v84, v56, v57
    v_exp_f32 v59, v59
    v_exp_f32 v60, v60
    v_cvt_pk_bf16_f32 v85, v58, v59
    v_mfma_f32_32x32x16_bf16 a[16:31], a[84:87], v[92:95], a[16:31]
    v_exp_f32 v61, v61
    v_exp_f32 v62, v62
    v_cvt_pk_bf16_f32 v86, v60, v61
    v_exp_f32 v63, v63
    v_smfmac_f32_16x16x64_bf16 a[36:39], v[32:35], v[88:95], v11
    s_waitcnt vmcnt(15) lgkmcnt(0)
    v_mfma_f32_32x32x16_bf16 v[240:255], a[92:95], a[172:175], v[240:255]
    s_barrier
    ds_read_b128 a[56:59], v8 offset:0
    ds_read_b128 a[60:63], v8 offset:1024
    v_exp_f32 v64, v64
    v_cvt_pk_bf16_f32 v87, v62, v63
    v_mfma_f32_32x32x16_bf16 v[48:63], a[64:67], a[40:43], v[96:111]
    s_mov_b32 m0, s78
    ds_read_b64_tr_b16 a[88:89], v20 offset:2048
    ds_read_b64_tr_b16 a[90:91], v20 offset:2560
    buffer_load_dwordx4 a[100:103], v37, s[60:63], s79 offen
    v_exp_f32 v65, v65
    v_mfma_f32_32x32x16_bf16 v[224:239], a[92:95], a[168:171], v[224:239]
    v_exp_f32 v66, v66
    v_cvt_pk_bf16_f32 v88, v64, v65
    v_exp_f32 v67, v67
    v_exp_f32 v68, v68
    v_mfma_f32_32x32x16_bf16 v[48:63], a[68:71], a[44:47], v[48:63]
    buffer_load_dwordx4 a[104:107], v38, s[60:63], s79 offen
    v_cvt_pk_bf16_f32 v89, v66, v67
    v_exp_f32 v69, v69
    v_exp_f32 v70, v70
    v_mfma_f32_32x32x16_bf16 v[208:223], a[92:95], a[164:167], v[208:223]
    v_cvt_pk_bf16_f32 v90, v68, v69
    v_exp_f32 v71, v71
    v_exp_f32 v72, v72
    v_cvt_pk_bf16_f32 v91, v70, v71
    v_mfma_f32_32x32x16_bf16 a[0:15], a[72:75], v[80:83], a[0:15]
    buffer_load_dwordx4 a[108:111], v39, s[60:63], s79 offen
    s_add_u32 s79, s79, 4096
    v_exp_f32 v73, v73
    v_exp_f32 v74, v74
    v_mfma_f32_32x32x16_bf16 v[192:207], a[92:95], a[160:163], v[192:207]
    v_cvt_pk_bf16_f32 v92, v72, v73
    v_exp_f32 v75, v75
    v_exp_f32 v76, v76
    v_cvt_pk_bf16_f32 v93, v74, v75
    v_exp_f32 v77, v77
    v_mfma_f32_32x32x16_bf16 a[0:15], a[76:79], v[84:87], a[0:15]
    buffer_load_dwordx4 v9, s[56:59], s76 offen offset:0 lds
    v_exp_f32 v78, v78
    v_cvt_pk_bf16_f32 v94, v76, v77
    v_exp_f32 v79, v79
    v_smfmac_f32_16x16x64_bf16 a[32:35], v[32:35], v[80:87], v11
    s_waitcnt lgkmcnt(0)
    v_mfma_f32_32x32x16_bf16 v[128:143], a[88:91], a[176:179], v[128:143]
    ds_read_b128 a[80:83], v7 offset:30720
    ds_read_b128 a[84:87], v7 offset:31744
    s_add_u32 m0, s81, 0
    ds_read_b64_tr_b16 a[92:93], v21 offset:2048
    v_exp_f32 v48, v48
    v_cvt_pk_bf16_f32 v95, v78, v79
    v_mfma_f32_32x32x16_bf16 v[64:79], a[64:67], a[48:51], v[112:127]
    ds_read_b64_tr_b16 a[94:95], v21 offset:2560
    buffer_load_dwordx4 v16, s[64:67], s80 offen offset:0 lds
    v_exp_f32 v49, v49
    v_exp_f32 v50, v50
    v_mfma_f32_32x32x16_bf16 v[144:159], a[88:91], a[180:183], v[144:159]
    v_cvt_pk_bf16_f32 v80, v48, v49
    v_exp_f32 v51, v51
    v_exp_f32 v52, v52
    v_cvt_pk_bf16_f32 v81, v50, v51
    v_mfma_f32_32x32x16_bf16 v[64:79], a[68:71], a[52:55], v[64:79]
    buffer_load_dwordx4 v17, s[64:67], s80 offen offset:1024 lds
    s_add_u32 s80, s80, 32768
    v_exp_f32 v53, v53
    v_exp_f32 v54, v54
    v_mfma_f32_32x32x16_bf16 v[160:175], a[88:91], a[184:187], v[160:175]
    v_cvt_pk_bf16_f32 v82, v52, v53
    v_exp_f32 v55, v55
    v_exp_f32 v56, v56
    v_cvt_pk_bf16_f32 v83, v54, v55
    v_mfma_f32_32x32x16_bf16 a[16:31], a[72:75], v[88:91], a[16:31]
    buffer_load_dwordx4 a[112:115], v36, s[60:63], s79 offen
    v_exp_f32 v57, v57
    v_exp_f32 v58, v58
    v_mfma_f32_32x32x16_bf16 v[176:191], a[88:91], a[188:191], v[176:191]
    v_cvt_pk_bf16_f32 v84, v56, v57
    v_exp_f32 v59, v59
    v_exp_f32 v60, v60
    v_cvt_pk_bf16_f32 v85, v58, v59
    v_mfma_f32_32x32x16_bf16 a[16:31], a[76:79], v[92:95], a[16:31]
    v_exp_f32 v61, v61
    v_exp_f32 v62, v62
    v_cvt_pk_bf16_f32 v86, v60, v61
    v_exp_f32 v63, v63
    v_smfmac_f32_16x16x64_bf16 a[36:39], v[32:35], v[88:95], v11
    s_waitcnt vmcnt(15) lgkmcnt(0)
    v_mfma_f32_32x32x16_bf16 v[240:255], a[92:95], a[188:191], v[240:255]
    ds_read_b128 a[64:67], v8 offset:4096
    ds_read_b128 a[68:71], v8 offset:5120
    s_mov_b32 m0, s78
    ds_read_b64_tr_b16 a[88:89], v20 offset:4096
    ds_read_b64_tr_b16 a[90:91], v20 offset:4608
    v_exp_f32 v64, v64
    v_cvt_pk_bf16_f32 v87, v62, v63
    v_mfma_f32_32x32x16_bf16 v[48:63], a[56:59], a[40:43], v[96:111]
    buffer_load_dwordx4 a[116:119], v37, s[60:63], s79 offen
    v_exp_f32 v65, v65
    v_exp_f32 v66, v66
    v_cvt_pk_bf16_f32 v88, v64, v65
    v_mfma_f32_32x32x16_bf16 v[224:239], a[92:95], a[184:187], v[224:239]
    v_exp_f32 v67, v67
    v_exp_f32 v68, v68
    v_cvt_pk_bf16_f32 v89, v66, v67
    v_exp_f32 v69, v69
    v_mfma_f32_32x32x16_bf16 v[48:63], a[60:63], a[44:47], v[48:63]
    buffer_load_dwordx4 a[120:123], v38, s[60:63], s79 offen
    v_exp_f32 v70, v70
    v_cvt_pk_bf16_f32 v90, v68, v69
    v_exp_f32 v71, v71
    v_mfma_f32_32x32x16_bf16 v[208:223], a[92:95], a[180:183], v[208:223]
    v_exp_f32 v72, v72
    v_cvt_pk_bf16_f32 v91, v70, v71
    v_exp_f32 v73, v73
    v_exp_f32 v74, v74
    v_mfma_f32_32x32x16_bf16 a[0:15], a[80:83], v[80:83], a[0:15]
    buffer_load_dwordx4 a[124:127], v39, s[60:63], s79 offen
    v_cvt_pk_bf16_f32 v92, v72, v73
    v_exp_f32 v75, v75
    v_exp_f32 v76, v76
    v_mfma_f32_32x32x16_bf16 v[192:207], a[92:95], a[176:179], v[192:207]
    s_add_u32 s79, s79, 4096
    v_cvt_pk_bf16_f32 v93, v74, v75
    v_exp_f32 v77, v77
    v_exp_f32 v78, v78
    v_cvt_pk_bf16_f32 v94, v76, v77
    v_mfma_f32_32x32x16_bf16 a[0:15], a[84:87], v[84:87], a[0:15]
    buffer_load_dwordx4 v9, s[56:59], s76 offen offset:1024 lds
    s_xor_b32 s78, s78, 32768
    v_xor_b32 v7, 0x8000, v7
    v_xor_b32 v8, 0x8000, v8
    v_exp_f32 v79, v79
    v_smfmac_f32_16x16x64_bf16 a[32:35], v[32:35], v[80:87], v11
    s_sub_u32 s48, s48, 1
    s_cmp_lg_u32 s48, 0
    s_cbranch_scc1 gated_mix__softmax_full_mha__glu_gated_bilinear__prompt_kernel_loop
gated_mix__softmax_full_mha__glu_gated_bilinear__prompt_kernel_tail:
    v_cvt_pk_bf16_f32 v95, v78, v79
    v_mfma_f32_32x32x16_bf16 a[16:31], a[80:83], v[88:91], a[16:31]
    s_nop 0
    v_mfma_f32_32x32x16_bf16 a[16:31], a[84:87], v[92:95], a[16:31]
    v_smfmac_f32_16x16x64_bf16 a[36:39], v[32:35], v[88:95], v11
    v_accvgpr_read_b32 v30, a32
    v_accvgpr_read_b32 v12, a33
    s_nop 5
    v_accvgpr_read_b32 v31, a36
    v_accvgpr_read_b32 v13, a37
    v_add_f32 v30, v30, v12
    v_add_f32 v31, v31, v13
    v_cmp_nle_f32 vcc, v30, s84
    v_cmp_nle_f32 s[26:27], v31, s84
    s_nop 1
    s_or_b64 vcc, vcc, s[26:27]
    s_cbranch_vccnz gated_mix__softmax_full_mha__glu_gated_bilinear__prompt_kernel_slow
gated_mix__softmax_full_mha__glu_gated_bilinear__prompt_kernel_epi:
    v_rcp_f32 v30, v30
    v_rcp_f32 v31, v31
    s_mul_i32 s78, s43, 49152
    s_lshl_b32 s45, s44, 13
    s_add_u32 s78, s78, s45
    s_barrier
    v_mul_f32 v88, v30, v22
    v_mul_f32 v90, v31, v23
    v_mov_b32 v89, v88
    v_mov_b32 v91, v90
    s_add_u32 m0, s81, 2048
    s_nop 0
    buffer_load_dwordx4 v16, s[64:67], s80 offen offset:0 lds
    v_accvgpr_read_b32 v48, a0
    v_accvgpr_read_b32 v49, a1
    v_accvgpr_read_b32 v50, a2
    v_accvgpr_read_b32 v51, a3
    v_accvgpr_read_b32 v52, a4
    v_accvgpr_read_b32 v53, a5
    v_accvgpr_read_b32 v54, a6
    v_accvgpr_read_b32 v55, a7
    v_pk_mul_f32 v[48:49], v[48:49], v[88:89]
    v_pk_mul_f32 v[50:51], v[50:51], v[88:89]
    v_pk_mul_f32 v[52:53], v[52:53], v[88:89]
    v_pk_mul_f32 v[54:55], v[54:55], v[88:89]
    v_cvt_pk_bf16_f32 v48, v48, v49
    v_cvt_pk_bf16_f32 v49, v50, v51
    v_cvt_pk_bf16_f32 v50, v52, v53
    v_cvt_pk_bf16_f32 v51, v54, v55
    buffer_store_dwordx4 v[48:51], v10, s[28:31], s82 offen offset:0 sc1
    buffer_load_dwordx4 v17, s[64:67], s80 offen offset:1024 lds
    s_add_u32 s80, s80, 32768
    v_accvgpr_read_b32 v56, a8
    v_accvgpr_read_b32 v57, a9
    v_accvgpr_read_b32 v58, a10
    v_accvgpr_read_b32 v59, a11
    v_accvgpr_read_b32 v60, a12
    v_accvgpr_read_b32 v61, a13
    v_accvgpr_read_b32 v62, a14
    v_accvgpr_read_b32 v63, a15
    v_pk_mul_f32 v[56:57], v[56:57], v[88:89]
    v_pk_mul_f32 v[58:59], v[58:59], v[88:89]
    v_pk_mul_f32 v[60:61], v[60:61], v[88:89]
    v_pk_mul_f32 v[62:63], v[62:63], v[88:89]
    v_cvt_pk_bf16_f32 v56, v56, v57
    v_cvt_pk_bf16_f32 v57, v58, v59
    v_cvt_pk_bf16_f32 v58, v60, v61
    v_cvt_pk_bf16_f32 v59, v62, v63
    buffer_store_dwordx4 v[56:59], v10, s[28:31], s83 offen offset:0 sc1
    buffer_load_dwordx4 a[128:131], v36, s[60:63], s79 offen
    v_accvgpr_read_b32 v64, a16
    v_accvgpr_read_b32 v65, a17
    v_accvgpr_read_b32 v66, a18
    v_accvgpr_read_b32 v67, a19
    v_accvgpr_read_b32 v68, a20
    v_accvgpr_read_b32 v69, a21
    v_accvgpr_read_b32 v70, a22
    v_accvgpr_read_b32 v71, a23
    v_pk_mul_f32 v[64:65], v[64:65], v[90:91]
    v_pk_mul_f32 v[66:67], v[66:67], v[90:91]
    v_pk_mul_f32 v[68:69], v[68:69], v[90:91]
    v_pk_mul_f32 v[70:71], v[70:71], v[90:91]
    v_cvt_pk_bf16_f32 v64, v64, v65
    v_cvt_pk_bf16_f32 v65, v66, v67
    v_cvt_pk_bf16_f32 v66, v68, v69
    v_cvt_pk_bf16_f32 v67, v70, v71
    buffer_store_dwordx4 v[64:67], v10, s[28:31], s82 offen offset:1024 sc1
    buffer_load_dwordx4 a[132:135], v37, s[60:63], s79 offen
    v_accvgpr_read_b32 v72, a24
    v_accvgpr_read_b32 v73, a25
    v_accvgpr_read_b32 v74, a26
    v_accvgpr_read_b32 v75, a27
    v_accvgpr_read_b32 v76, a28
    v_accvgpr_read_b32 v77, a29
    v_accvgpr_read_b32 v78, a30
    v_accvgpr_read_b32 v79, a31
    v_pk_mul_f32 v[72:73], v[72:73], v[90:91]
    v_pk_mul_f32 v[74:75], v[74:75], v[90:91]
    v_pk_mul_f32 v[76:77], v[76:77], v[90:91]
    v_pk_mul_f32 v[78:79], v[78:79], v[90:91]
    v_cvt_pk_bf16_f32 v72, v72, v73
    v_cvt_pk_bf16_f32 v73, v74, v75
    v_cvt_pk_bf16_f32 v74, v76, v77
    v_cvt_pk_bf16_f32 v75, v78, v79
    buffer_store_dwordx4 v[72:75], v10, s[28:31], s83 offen offset:1024 sc1
    s_waitcnt lgkmcnt(0)
    v_mfma_f32_32x32x16_bf16 v[128:143], a[88:91], a[192:195], v[128:143]
    ds_read_b64_tr_b16 a[92:93], v21 offset:4096
    ds_read_b64_tr_b16 a[94:95], v21 offset:4608
    buffer_load_dwordx4 a[136:139], v38, s[60:63], s79 offen
    s_sub_u32 s45, s78, s81
    v_add_u32 v96, s45, v20
    v_add_u32 v97, s45, v21
    v_mfma_f32_32x32x16_bf16 v[144:159], a[88:91], a[196:199], v[144:159]
    buffer_load_dwordx4 a[140:143], v39, s[60:63], s79 offen
    s_add_u32 s79, s79, 4096
    s_lshl_b32 s45, s85, 18
    s_lshl_b32 s46, s86, 7
    s_add_u32 s45, s45, s46
    v_mfma_f32_32x32x16_bf16 v[160:175], a[88:91], a[200:203], v[160:175]
    s_add_u32 m0, s78, 0
    s_nop 0
    buffer_load_dwordx4 v18, s[68:71], s87 offen offset:0 lds
    s_add_u32 s72, s20, s45
    s_addc_u32 s73, s21, 0
    s_sub_u32 s74, 4194304, s45
    s_mov_b32 s75, 0x00020000
    v_mfma_f32_32x32x16_bf16 v[176:191], a[88:91], a[204:207], v[176:191]
    buffer_load_dwordx4 v19, s[68:71], s87 offen offset:1024 lds
    s_add_u32 s87, s87, 32768
    v_and_b32 v13, 31, v1
    s_lshl_b32 s45, s42, 16
    v_lshl_add_u32 v100, v13, 11, s45
    s_waitcnt lgkmcnt(0)
    v_mfma_f32_32x32x16_bf16 v[240:255], a[92:95], a[204:207], v[240:255]
    s_waitcnt vmcnt(24)
    ds_read_b64_tr_b16 a[88:89], v20 offset:6144
    ds_read_b64_tr_b16 a[90:91], v20 offset:6656
    v_lshrrev_b32 v13, 5, v1
    v_lshl_add_u32 v100, v13, 4, v100
    v_bfe_u32 v13, v1, 1, 3
    v_mfma_f32_32x32x16_bf16 v[224:239], a[92:95], a[200:203], v[224:239]
    v_and_b32 v14, 1, v1
    v_lshlrev_b32 v14, 2, v14
    v_lshl_add_u32 v15, v13, 4, v14
    v_mfma_f32_32x32x16_bf16 v[208:223], a[92:95], a[196:199], v[208:223]
    s_lshr_b32 s47, s85, 1
    s_lshl_b32 s47, s47, 9
    s_lshl_b32 s45, s42, 7
    v_mfma_f32_32x32x16_bf16 v[192:207], a[92:95], a[192:195], v[192:207]
    s_add_u32 s47, s47, s45
    s_and_b32 s45, s85, 1
    s_lshl_b32 s45, s45, 3
    s_waitcnt lgkmcnt(0)
    v_mfma_f32_32x32x16_bf16 v[128:143], a[88:91], a[208:211], v[128:143]
    ds_read_b64_tr_b16 a[92:93], v21 offset:6144
    ds_read_b64_tr_b16 a[94:95], v21 offset:6656
    s_add_u32 m0, s81, 4096
    s_nop 0
    buffer_load_dwordx4 v16, s[64:67], s80 offen offset:0 lds
    v_mov_b32 v12, 3
    s_waitcnt vmcnt(5)
    buffer_store_dword v12, v3, s[32:35], 0 offen sc1
    s_add_u32 s47, s47, s45
    s_mul_i32 s45, s42, 24576
    v_mfma_f32_32x32x16_bf16 v[144:159], a[88:91], a[212:215], v[144:159]
    buffer_load_dwordx4 v17, s[64:67], s80 offen offset:1024 lds
    s_add_u32 s80, s80, 32768
    v_add_u32 v104, s45, v6
    s_lshl_b32 s46, s42, 16
    s_add_u32 s46, s46, 917504
    v_mfma_f32_32x32x16_bf16 v[160:175], a[88:91], a[216:219], v[160:175]
    buffer_load_dwordx4 a[144:147], v36, s[60:63], s79 offen
    v_lshrrev_b32 v13, 10, v36
    v_mul_u32_u24 v13, 24576, v13
    v_add_u32 v13, 16384, v13
    v_mfma_f32_32x32x16_bf16 v[176:191], a[88:91], a[220:223], v[176:191]
    buffer_load_dwordx4 a[148:151], v37, s[60:63], s79 offen
    v_add_u32 v101, v13, v6
    v_lshrrev_b32 v13, 10, v37
    v_mul_u32_u24 v13, 24576, v13
    s_waitcnt lgkmcnt(0)
    v_mfma_f32_32x32x16_bf16 v[240:255], a[92:95], a[220:223], v[240:255]
    ds_read_b64_tr_b16 a[88:89], v20 offset:0
    ds_read_b64_tr_b16 a[90:91], v20 offset:512
    buffer_load_dwordx4 a[152:155], v38, s[60:63], s79 offen
    v_add_u32 v13, 8192, v13
    v_add_u32 v102, v13, v6
    v_lshrrev_b32 v13, 10, v38
    v_mfma_f32_32x32x16_bf16 v[224:239], a[92:95], a[216:219], v[224:239]
    buffer_load_dwordx4 a[156:159], v39, s[60:63], s79 offen
    s_add_u32 s79, s79, 4096
    v_mul_u32_u24 v13, 24576, v13
    v_add_u32 v13, 0, v13
    v_add_u32 v103, v13, v6
    v_mfma_f32_32x32x16_bf16 v[208:223], a[92:95], a[212:215], v[208:223]
    s_add_u32 m0, s78, 2048
    s_nop 0
    buffer_load_dwordx4 v18, s[68:71], s87 offen offset:0 lds
    s_add_u32 s89, s46, 0
    s_add_u32 s90, s46, 16384
    s_add_u32 s50, s46, 32768
    v_mfma_f32_32x32x16_bf16 v[192:207], a[92:95], a[208:211], v[192:207]
    buffer_load_dwordx4 v19, s[68:71], s87 offen offset:1024 lds
    s_add_u32 s87, s87, 32768
    s_add_u32 s77, s46, 49152
    v_add_u32 v64, 4096, v36
    v_add_u32 v65, 8192, v36
    s_waitcnt lgkmcnt(0)
    v_mfma_f32_32x32x16_bf16 v[128:143], a[88:91], a[96:99], v[128:143]
    ds_read_b64_tr_b16 a[92:93], v21 offset:0
    ds_read_b64_tr_b16 a[94:95], v21 offset:512
    s_add_u32 m0, s81, 6144
    s_nop 0
    buffer_load_dwordx4 v16, s[64:67], s80 offen offset:0 lds
    v_add_u32 v66, 12288, v36
    v_add_u32 v67, 4096, v37
    v_mfma_f32_32x32x16_bf16 v[144:159], a[88:91], a[100:103], v[144:159]
    buffer_load_dwordx4 v17, s[64:67], s80 offen offset:1024 lds
    s_add_u32 s80, s80, 32768
    v_add_u32 v68, 8192, v37
    v_add_u32 v69, 12288, v37
    v_mfma_f32_32x32x16_bf16 v[160:175], a[88:91], a[104:107], v[160:175]
    buffer_load_dwordx4 a[160:163], v36, s[60:63], s79 offen
    v_add_u32 v70, 4096, v38
    v_add_u32 v71, 8192, v38
    v_mfma_f32_32x32x16_bf16 v[176:191], a[88:91], a[108:111], v[176:191]
    buffer_load_dwordx4 a[164:167], v37, s[60:63], s79 offen
    v_add_u32 v72, 12288, v38
    v_add_u32 v73, 4096, v39
    s_waitcnt lgkmcnt(0)
    v_mfma_f32_32x32x16_bf16 v[240:255], a[92:95], a[108:111], v[240:255]
    ds_read_b64_tr_b16 a[88:89], v20 offset:2048
    ds_read_b64_tr_b16 a[90:91], v20 offset:2560
    buffer_load_dwordx4 a[168:171], v38, s[60:63], s79 offen
    v_add_u32 v74, 8192, v39
    v_add_u32 v75, 12288, v39
    v_mfma_f32_32x32x16_bf16 v[224:239], a[92:95], a[104:107], v[224:239]
    buffer_load_dwordx4 a[172:175], v39, s[60:63], s79 offen
    s_add_u32 s79, s79, 4096
    ds_read_b64_tr_b16 a[0:1], v20 offset:8192
    ds_read_b64_tr_b16 a[2:3], v20 offset:8704
    v_mfma_f32_32x32x16_bf16 v[208:223], a[92:95], a[100:103], v[208:223]
    s_add_u32 m0, s78, 4096
    s_nop 0
    buffer_load_dwordx4 v18, s[68:71], s87 offen offset:0 lds
    ds_read_b64_tr_b16 a[4:5], v21 offset:8192
    ds_read_b64_tr_b16 a[6:7], v21 offset:8704
    v_mfma_f32_32x32x16_bf16 v[192:207], a[92:95], a[96:99], v[192:207]
    buffer_load_dwordx4 v19, s[68:71], s87 offen offset:1024 lds
    s_add_u32 s87, s87, 32768
    ds_read_b64_tr_b16 a[8:9], v20 offset:10240
    ds_read_b64_tr_b16 a[10:11], v20 offset:10752
    s_waitcnt lgkmcnt(6)
    v_mfma_f32_32x32x16_bf16 v[128:143], a[88:91], a[112:115], v[128:143]
    ds_read_b64_tr_b16 a[92:93], v21 offset:2048
    ds_read_b64_tr_b16 a[94:95], v21 offset:2560
    s_add_u32 m0, s81, 0
    s_nop 0
    buffer_load_dwordx4 v16, s[64:67], s80 offen offset:0 lds
    ds_read_b64_tr_b16 a[12:13], v21 offset:10240
    ds_read_b64_tr_b16 a[14:15], v21 offset:10752
    v_mfma_f32_32x32x16_bf16 v[144:159], a[88:91], a[116:119], v[144:159]
    buffer_load_dwordx4 v17, s[64:67], s80 offen offset:1024 lds
    s_add_u32 s80, s80, 32768
    ds_read_b64_tr_b16 a[16:17], v20 offset:12288
    ds_read_b64_tr_b16 a[18:19], v20 offset:12800
    v_mfma_f32_32x32x16_bf16 v[160:175], a[88:91], a[120:123], v[160:175]
    buffer_load_dwordx4 a[176:179], v36, s[60:63], s79 offen
    ds_read_b64_tr_b16 a[20:21], v21 offset:12288
    ds_read_b64_tr_b16 a[22:23], v21 offset:12800
    v_mfma_f32_32x32x16_bf16 v[176:191], a[88:91], a[124:127], v[176:191]
    buffer_load_dwordx4 a[180:183], v37, s[60:63], s79 offen
    ds_read_b64_tr_b16 a[24:25], v20 offset:14336
    ds_read_b64_tr_b16 a[26:27], v20 offset:14848
    s_waitcnt lgkmcnt(8)
    v_mfma_f32_32x32x16_bf16 v[240:255], a[92:95], a[124:127], v[240:255]
    s_waitcnt vmcnt(18)
    ds_read_b64_tr_b16 a[88:89], v20 offset:4096
    ds_read_b64_tr_b16 a[90:91], v20 offset:4608
    buffer_load_dwordx4 a[184:187], v38, s[60:63], s79 offen
    ds_read_b64_tr_b16 a[28:29], v21 offset:14336
    ds_read_b64_tr_b16 a[30:31], v21 offset:14848
    v_mfma_f32_32x32x16_bf16 v[224:239], a[92:95], a[120:123], v[224:239]
    buffer_load_dwordx4 a[188:191], v39, s[60:63], s79 offen
    s_add_u32 s79, s79, 4096
    ds_read_b64_tr_b16 a[32:33], v20 offset:16384
    ds_read_b64_tr_b16 a[34:35], v20 offset:16896
    v_mfma_f32_32x32x16_bf16 v[208:223], a[92:95], a[116:119], v[208:223]
    s_add_u32 m0, s78, 6144
    s_nop 0
    buffer_load_dwordx4 v18, s[68:71], s87 offen offset:0 lds
    ds_read_b64_tr_b16 a[36:37], v21 offset:16384
    ds_read_b64_tr_b16 a[38:39], v21 offset:16896
    v_mfma_f32_32x32x16_bf16 v[192:207], a[92:95], a[112:115], v[192:207]
    buffer_load_dwordx4 v19, s[68:71], s87 offen offset:1024 lds
    s_add_u32 s87, s87, 32768
    ds_read_b64_tr_b16 a[40:41], v20 offset:18432
    ds_read_b64_tr_b16 a[42:43], v20 offset:18944
    s_waitcnt lgkmcnt(8)
    v_mfma_f32_32x32x16_bf16 v[128:143], a[88:91], a[128:131], v[128:143]
    ds_read_b64_tr_b16 a[92:93], v21 offset:4096
    ds_read_b64_tr_b16 a[94:95], v21 offset:4608
    s_add_u32 m0, s81, 2048
    s_nop 0
    buffer_load_dwordx4 v16, s[64:67], s80 offen offset:0 lds
    ds_read_b64_tr_b16 a[44:45], v21 offset:18432
    ds_read_b64_tr_b16 a[46:47], v21 offset:18944
    v_mfma_f32_32x32x16_bf16 v[144:159], a[88:91], a[132:135], v[144:159]
    buffer_load_dwordx4 v17, s[64:67], s80 offen offset:1024 lds
    s_add_u32 s80, s80, 32768
    ds_read_b64_tr_b16 a[48:49], v40 offset:0
    ds_read_b64_tr_b16 a[50:51], v40 offset:512
    v_mfma_f32_32x32x16_bf16 v[160:175], a[88:91], a[136:139], v[160:175]
    buffer_load_dwordx4 a[192:195], v36, s[60:63], s79 offen
    ds_read_b64_tr_b16 a[52:53], v41 offset:0
    ds_read_b64_tr_b16 a[54:55], v41 offset:512
    v_mfma_f32_32x32x16_bf16 v[176:191], a[88:91], a[140:143], v[176:191]
    buffer_load_dwordx4 a[196:199], v37, s[60:63], s79 offen
    ds_read_b64_tr_b16 a[56:57], v40 offset:2048
    ds_read_b64_tr_b16 a[58:59], v40 offset:2560
    s_waitcnt lgkmcnt(8)
    v_mfma_f32_32x32x16_bf16 v[240:255], a[92:95], a[140:143], v[240:255]
    s_waitcnt vmcnt(18)
    ds_read_b64_tr_b16 a[88:89], v20 offset:6144
    ds_read_b64_tr_b16 a[90:91], v20 offset:6656
    buffer_load_dwordx4 a[200:203], v38, s[60:63], s79 offen
    ds_read_b64_tr_b16 a[60:61], v41 offset:2048
    ds_read_b64_tr_b16 a[62:63], v41 offset:2560
    v_mfma_f32_32x32x16_bf16 v[224:239], a[92:95], a[136:139], v[224:239]
    buffer_load_dwordx4 a[204:207], v39, s[60:63], s79 offen
    s_add_u32 s79, s79, 4096
    v_mfma_f32_32x32x16_bf16 v[208:223], a[92:95], a[132:135], v[208:223]
    v_mfma_f32_32x32x16_bf16 v[192:207], a[92:95], a[128:131], v[192:207]
    s_waitcnt lgkmcnt(2)
    v_mfma_f32_32x32x16_bf16 v[128:143], a[88:91], a[144:147], v[128:143]
    ds_read_b64_tr_b16 a[92:93], v21 offset:6144
    ds_read_b64_tr_b16 a[94:95], v21 offset:6656
    s_add_u32 m0, s81, 4096
    s_nop 0
    buffer_load_dwordx4 v16, s[64:67], s80 offen offset:0 lds
    v_mfma_f32_32x32x16_bf16 v[144:159], a[88:91], a[148:151], v[144:159]
    buffer_load_dword v28, v15, s[32:35], s47 offen sc1
    buffer_load_dwordx4 v17, s[64:67], s80 offen offset:1024 lds
    s_add_u32 s80, s80, 32768
    v_mfma_f32_32x32x16_bf16 v[160:175], a[88:91], a[152:155], v[160:175]
    buffer_load_dwordx4 a[208:211], v36, s[60:63], s79 offen
    v_mfma_f32_32x32x16_bf16 v[176:191], a[88:91], a[156:159], v[176:191]
    buffer_load_dwordx4 a[212:215], v37, s[60:63], s79 offen
    s_waitcnt lgkmcnt(0)
    v_mfma_f32_32x32x16_bf16 v[240:255], a[92:95], a[156:159], v[240:255]
    s_waitcnt vmcnt(17)
    ds_read_b64_tr_b16 a[88:89], v20 offset:0
    ds_read_b64_tr_b16 a[90:91], v20 offset:512
    buffer_load_dwordx4 a[216:219], v38, s[60:63], s79 offen
    v_mfma_f32_32x32x16_bf16 v[224:239], a[92:95], a[152:155], v[224:239]
    buffer_load_dwordx4 a[220:223], v39, s[60:63], s79 offen
    s_add_u32 s79, s79, 4096
    v_mfma_f32_32x32x16_bf16 v[208:223], a[92:95], a[148:151], v[208:223]
    v_mfma_f32_32x32x16_bf16 v[192:207], a[92:95], a[144:147], v[192:207]
    s_waitcnt lgkmcnt(0)
    v_mfma_f32_32x32x16_bf16 v[128:143], a[88:91], a[160:163], v[128:143]
    ds_read_b64_tr_b16 a[92:93], v21 offset:0
    ds_read_b64_tr_b16 a[94:95], v21 offset:512
    s_add_u32 m0, s81, 6144
    s_nop 0
    buffer_load_dwordx4 v16, s[64:67], s80 offen offset:0 lds
    v_mfma_f32_32x32x16_bf16 v[144:159], a[88:91], a[164:167], v[144:159]
    buffer_load_dwordx4 v17, s[64:67], s80 offen offset:1024 lds
    s_add_u32 s80, s80, 32768
    v_mfma_f32_32x32x16_bf16 v[160:175], a[88:91], a[168:171], v[160:175]
    v_mfma_f32_32x32x16_bf16 v[176:191], a[88:91], a[172:175], v[176:191]
    s_waitcnt lgkmcnt(0)
    v_mfma_f32_32x32x16_bf16 v[240:255], a[92:95], a[172:175], v[240:255]
    s_waitcnt vmcnt(13)
    ds_read_b64_tr_b16 a[88:89], v20 offset:2048
    ds_read_b64_tr_b16 a[90:91], v20 offset:2560
    v_mfma_f32_32x32x16_bf16 v[224:239], a[92:95], a[168:171], v[224:239]
    v_mfma_f32_32x32x16_bf16 v[208:223], a[92:95], a[164:167], v[208:223]
    v_mfma_f32_32x32x16_bf16 v[192:207], a[92:95], a[160:163], v[192:207]
    s_waitcnt lgkmcnt(0)
    v_mfma_f32_32x32x16_bf16 v[128:143], a[88:91], a[176:179], v[128:143]
    ds_read_b64_tr_b16 a[92:93], v21 offset:2048
    ds_read_b64_tr_b16 a[94:95], v21 offset:2560
    v_mfma_f32_32x32x16_bf16 v[144:159], a[88:91], a[180:183], v[144:159]
    v_mfma_f32_32x32x16_bf16 v[160:175], a[88:91], a[184:187], v[160:175]
    v_mfma_f32_32x32x16_bf16 v[176:191], a[88:91], a[188:191], v[176:191]
    s_waitcnt lgkmcnt(0)
    v_mfma_f32_32x32x16_bf16 v[240:255], a[92:95], a[188:191], v[240:255]
    s_waitcnt vmcnt(6)
    ds_read_b64_tr_b16 a[88:89], v20 offset:4096
    ds_read_b64_tr_b16 a[90:91], v20 offset:4608
    v_mfma_f32_32x32x16_bf16 v[224:239], a[92:95], a[184:187], v[224:239]
    v_mfma_f32_32x32x16_bf16 v[208:223], a[92:95], a[180:183], v[208:223]
    v_mfma_f32_32x32x16_bf16 v[192:207], a[92:95], a[176:179], v[192:207]
    s_waitcnt lgkmcnt(0)
    v_mfma_f32_32x32x16_bf16 v[128:143], a[88:91], a[192:195], v[128:143]
    ds_read_b64_tr_b16 a[92:93], v21 offset:4096
    ds_read_b64_tr_b16 a[94:95], v21 offset:4608
    v_mfma_f32_32x32x16_bf16 v[144:159], a[88:91], a[196:199], v[144:159]
    v_cmp_gt_u32 vcc, 3, v28
    s_nop 1
    s_cbranch_vccnz gated_mix__softmax_full_mha__glu_gated_bilinear__prompt_kernel_o_spin
gated_mix__softmax_full_mha__glu_gated_bilinear__prompt_kernel_o_ok:
    buffer_load_dwordx4 a[96:99], v36, s[60:63], s89 offen
    v_mfma_f32_32x32x16_bf16 v[160:175], a[88:91], a[200:203], v[160:175]
    buffer_load_dwordx4 a[100:103], v64, s[60:63], s89 offen
    v_mfma_f32_32x32x16_bf16 v[176:191], a[88:91], a[204:207], v[176:191]
    buffer_load_dwordx4 a[104:107], v65, s[60:63], s89 offen
    s_waitcnt lgkmcnt(0)
    v_mfma_f32_32x32x16_bf16 v[240:255], a[92:95], a[204:207], v[240:255]
    s_waitcnt vmcnt(3)
    ds_read_b64_tr_b16 a[88:89], v20 offset:6144
    ds_read_b64_tr_b16 a[90:91], v20 offset:6656
    buffer_load_dwordx4 a[108:111], v66, s[60:63], s89 offen
    v_mfma_f32_32x32x16_bf16 v[224:239], a[92:95], a[200:203], v[224:239]
    buffer_load_dwordx4 a[112:115], v36, s[60:63], s90 offen
    v_mfma_f32_32x32x16_bf16 v[208:223], a[92:95], a[196:199], v[208:223]
    buffer_load_dwordx4 a[116:119], v64, s[60:63], s90 offen
    v_mfma_f32_32x32x16_bf16 v[192:207], a[92:95], a[192:195], v[192:207]
    buffer_load_dwordx4 a[120:123], v65, s[60:63], s90 offen
    s_waitcnt lgkmcnt(0)
    v_mfma_f32_32x32x16_bf16 v[128:143], a[88:91], a[208:211], v[128:143]
    ds_read_b64_tr_b16 a[92:93], v21 offset:6144
    ds_read_b64_tr_b16 a[94:95], v21 offset:6656
    buffer_load_dwordx4 a[124:127], v66, s[60:63], s90 offen
    v_mfma_f32_32x32x16_bf16 v[144:159], a[88:91], a[212:215], v[144:159]
    buffer_load_dwordx4 a[128:131], v36, s[60:63], s50 offen
    v_mfma_f32_32x32x16_bf16 v[160:175], a[88:91], a[216:219], v[160:175]
    buffer_load_dwordx4 a[132:135], v64, s[60:63], s50 offen
    v_mfma_f32_32x32x16_bf16 v[176:191], a[88:91], a[220:223], v[176:191]
    buffer_load_dwordx4 a[136:139], v65, s[60:63], s50 offen
    s_waitcnt lgkmcnt(0)
    v_mfma_f32_32x32x16_bf16 v[240:255], a[92:95], a[220:223], v[240:255]
    buffer_load_dwordx4 a[140:143], v66, s[60:63], s50 offen
    v_mfma_f32_32x32x16_bf16 v[224:239], a[92:95], a[216:219], v[224:239]
    buffer_load_dwordx4 a[144:147], v36, s[60:63], s77 offen
    v_mfma_f32_32x32x16_bf16 v[208:223], a[92:95], a[212:215], v[208:223]
    buffer_load_dwordx4 a[148:151], v64, s[60:63], s77 offen
    v_mfma_f32_32x32x16_bf16 v[192:207], a[92:95], a[208:211], v[192:207]
    buffer_load_dwordx4 a[152:155], v65, s[60:63], s77 offen
    v_mul_f32 v128, v128, v24
    v_mul_f32 v129, v129, v24
    ds_read_b64_tr_b16 a[64:65], v96 offset:0
    v_mul_f32 v130, v130, v24
    v_mul_f32 v131, v131, v24
    buffer_load_dwordx4 a[156:159], v66, s[60:63], s77 offen
    v_mul_f32 v132, v132, v24
    v_mul_f32 v133, v133, v24
    ds_read_b64_tr_b16 a[66:67], v96 offset:512
    v_mul_f32 v134, v134, v24
    v_mul_f32 v135, v135, v24
    v_mul_f32 v136, v136, v24
    v_mul_f32 v137, v137, v24
    ds_read_b64_tr_b16 a[68:69], v97 offset:0
    v_mul_f32 v138, v138, v24
    v_mul_f32 v139, v139, v24
    buffer_load_dwordx4 a[160:163], v37, s[60:63], s89 offen
    v_mul_f32 v140, v140, v24
    v_mul_f32 v141, v141, v24
    ds_read_b64_tr_b16 a[70:71], v97 offset:512
    v_mul_f32 v142, v142, v24
    v_mul_f32 v143, v143, v24
    v_mul_f32 v192, v192, v24
    v_mul_f32 v193, v193, v24
    ds_read_b64_tr_b16 a[72:73], v96 offset:2048
    v_mul_f32 v194, v194, v24
    v_mul_f32 v195, v195, v24
    buffer_load_dwordx4 a[164:167], v67, s[60:63], s89 offen
    v_mul_f32 v196, v196, v24
    v_mul_f32 v197, v197, v24
    ds_read_b64_tr_b16 a[74:75], v96 offset:2560
    v_mul_f32 v198, v198, v24
    v_mul_f32 v199, v199, v24
    v_mul_f32 v200, v200, v24
    v_mul_f32 v201, v201, v24
    ds_read_b64_tr_b16 a[76:77], v97 offset:2048
    v_mul_f32 v202, v202, v24
    v_mul_f32 v203, v203, v24
    buffer_load_dwordx4 a[168:171], v68, s[60:63], s89 offen
    v_mul_f32 v204, v204, v24
    v_mul_f32 v205, v205, v24
    ds_read_b64_tr_b16 a[78:79], v97 offset:2560
    v_mul_f32 v206, v206, v24
    v_mul_f32 v207, v207, v24
    s_waitcnt vmcnt(18)
    v_mfma_f32_32x32x16_bf16 v[128:143], a[224:227], a[96:99], v[128:143]
    buffer_load_dwordx4 a[172:175], v69, s[60:63], s89 offen
    v_mul_f32 v144, v144, v25
    ds_read_b64_tr_b16 a[80:81], v96 offset:4096
    v_mfma_f32_32x32x16_bf16 v[192:207], a[228:231], a[96:99], v[192:207]
    v_mul_f32 v145, v145, v25
    ds_read_b64_tr_b16 a[82:83], v96 offset:4608
    s_waitcnt vmcnt(18)
    v_mfma_f32_32x32x16_bf16 v[128:143], a[232:235], a[100:103], v[128:143]
    buffer_load_dwordx4 a[176:179], v37, s[60:63], s90 offen
    v_mul_f32 v146, v146, v25
    ds_read_b64_tr_b16 a[84:85], v97 offset:4096
    v_mfma_f32_32x32x16_bf16 v[192:207], a[236:239], a[100:103], v[192:207]
    v_mul_f32 v147, v147, v25
    ds_read_b64_tr_b16 a[86:87], v97 offset:4608
    s_waitcnt vmcnt(18)
    v_mfma_f32_32x32x16_bf16 v[128:143], a[240:243], a[104:107], v[128:143]
    buffer_load_dwordx4 a[180:183], v67, s[60:63], s90 offen
    v_mul_f32 v148, v148, v25
    ds_read_b64_tr_b16 v[48:49], v96 offset:6144
    v_mfma_f32_32x32x16_bf16 v[192:207], a[244:247], a[104:107], v[192:207]
    v_mul_f32 v149, v149, v25
    ds_read_b64_tr_b16 v[50:51], v96 offset:6656
    s_waitcnt vmcnt(18)
    v_mfma_f32_32x32x16_bf16 v[128:143], a[248:251], a[108:111], v[128:143]
    buffer_load_dwordx4 a[184:187], v68, s[60:63], s90 offen
    v_mul_f32 v150, v150, v25
    ds_read_b64_tr_b16 v[52:53], v97 offset:6144
    v_mfma_f32_32x32x16_bf16 v[192:207], a[252:255], a[108:111], v[192:207]
    v_mul_f32 v151, v151, v25
    ds_read_b64_tr_b16 v[54:55], v97 offset:6656
    s_waitcnt vmcnt(18)
    v_mfma_f32_32x32x16_bf16 v[128:143], a[0:3], a[112:115], v[128:143]
    buffer_load_dwordx4 a[188:191], v69, s[60:63], s90 offen
    v_mul_f32 v152, v152, v25
    v_mul_f32 v153, v153, v25
    v_mfma_f32_32x32x16_bf16 v[192:207], a[4:7], a[112:115], v[192:207]
    v_mul_f32 v154, v154, v25
    v_mul_f32 v155, v155, v25
    s_waitcnt vmcnt(18)
    v_mfma_f32_32x32x16_bf16 v[128:143], a[8:11], a[116:119], v[128:143]
    buffer_load_dwordx4 a[192:195], v37, s[60:63], s50 offen
    v_mul_f32 v156, v156, v25
    v_mul_f32 v157, v157, v25
    v_mfma_f32_32x32x16_bf16 v[192:207], a[12:15], a[116:119], v[192:207]
    v_mul_f32 v158, v158, v25
    v_mul_f32 v159, v159, v25
    s_waitcnt vmcnt(18)
    v_mfma_f32_32x32x16_bf16 v[128:143], a[16:19], a[120:123], v[128:143]
    buffer_load_dwordx4 a[196:199], v67, s[60:63], s50 offen
    v_mul_f32 v208, v208, v25
    v_mul_f32 v209, v209, v25
    v_mfma_f32_32x32x16_bf16 v[192:207], a[20:23], a[120:123], v[192:207]
    v_mul_f32 v210, v210, v25
    v_mul_f32 v211, v211, v25
    s_waitcnt vmcnt(18)
    v_mfma_f32_32x32x16_bf16 v[128:143], a[24:27], a[124:127], v[128:143]
    buffer_load_dwordx4 a[200:203], v68, s[60:63], s50 offen
    v_mul_f32 v212, v212, v25
    v_mul_f32 v213, v213, v25
    v_mfma_f32_32x32x16_bf16 v[192:207], a[28:31], a[124:127], v[192:207]
    v_mul_f32 v214, v214, v25
    v_mul_f32 v215, v215, v25
    s_waitcnt vmcnt(18)
    v_mfma_f32_32x32x16_bf16 v[128:143], a[32:35], a[128:131], v[128:143]
    buffer_load_dwordx4 a[204:207], v69, s[60:63], s50 offen
    v_mul_f32 v216, v216, v25
    v_mul_f32 v217, v217, v25
    v_mfma_f32_32x32x16_bf16 v[192:207], a[36:39], a[128:131], v[192:207]
    v_mul_f32 v218, v218, v25
    v_mul_f32 v219, v219, v25
    s_waitcnt vmcnt(18)
    v_mfma_f32_32x32x16_bf16 v[128:143], a[40:43], a[132:135], v[128:143]
    buffer_load_dwordx4 a[208:211], v37, s[60:63], s77 offen
    v_mul_f32 v220, v220, v25
    v_mul_f32 v221, v221, v25
    v_mfma_f32_32x32x16_bf16 v[192:207], a[44:47], a[132:135], v[192:207]
    v_mul_f32 v222, v222, v25
    v_mul_f32 v223, v223, v25
    s_waitcnt vmcnt(18)
    v_mfma_f32_32x32x16_bf16 v[128:143], a[48:51], a[136:139], v[128:143]
    buffer_load_dwordx4 a[212:215], v67, s[60:63], s77 offen
    v_mfma_f32_32x32x16_bf16 v[192:207], a[52:55], a[136:139], v[192:207]
    s_waitcnt vmcnt(18)
    v_mfma_f32_32x32x16_bf16 v[128:143], a[56:59], a[140:143], v[128:143]
    buffer_load_dwordx4 a[216:219], v68, s[60:63], s77 offen
    v_mfma_f32_32x32x16_bf16 v[192:207], a[60:63], a[140:143], v[192:207]
    s_waitcnt vmcnt(18) lgkmcnt(14)
    v_mfma_f32_32x32x16_bf16 v[128:143], a[64:67], a[144:147], v[128:143]
    buffer_load_dwordx4 a[220:223], v69, s[60:63], s77 offen
    s_waitcnt lgkmcnt(12)
    v_mfma_f32_32x32x16_bf16 v[192:207], a[68:71], a[144:147], v[192:207]
    s_waitcnt vmcnt(18) lgkmcnt(10)
    v_mfma_f32_32x32x16_bf16 v[128:143], a[72:75], a[148:151], v[128:143]
    buffer_load_dwordx4 a[96:99], v38, s[60:63], s89 offen
    s_waitcnt lgkmcnt(8)
    v_mfma_f32_32x32x16_bf16 v[192:207], a[76:79], a[148:151], v[192:207]
    s_waitcnt vmcnt(18) lgkmcnt(6)
    v_mfma_f32_32x32x16_bf16 v[128:143], a[80:83], a[152:155], v[128:143]
    buffer_load_dwordx4 a[100:103], v70, s[60:63], s89 offen
    s_waitcnt lgkmcnt(4)
    v_mfma_f32_32x32x16_bf16 v[192:207], a[84:87], a[152:155], v[192:207]
    s_waitcnt vmcnt(18) lgkmcnt(2)
    v_mfma_f32_32x32x16_bf16 v[128:143], v[48:51], a[156:159], v[128:143]
    buffer_load_dwordx4 a[104:107], v71, s[60:63], s89 offen
    s_waitcnt lgkmcnt(0)
    v_mfma_f32_32x32x16_bf16 v[192:207], v[52:55], a[156:159], v[192:207]
    s_waitcnt vmcnt(18)
    v_mfma_f32_32x32x16_bf16 v[144:159], a[224:227], a[160:163], v[144:159]
    buffer_load_dwordx4 a[108:111], v72, s[60:63], s89 offen
    v_mul_f32 v160, v160, v26
    v_mul_f32 v161, v161, v26
    v_mfma_f32_32x32x16_bf16 v[208:223], a[228:231], a[160:163], v[208:223]
    v_mul_f32 v162, v162, v26
    v_mul_f32 v163, v163, v26
    s_waitcnt vmcnt(18)
    v_mfma_f32_32x32x16_bf16 v[144:159], a[232:235], a[164:167], v[144:159]
    buffer_load_dwordx4 a[112:115], v38, s[60:63], s90 offen
    v_mul_f32 v164, v164, v26
    v_mul_f32 v165, v165, v26
    v_mfma_f32_32x32x16_bf16 v[208:223], a[236:239], a[164:167], v[208:223]
    v_mul_f32 v166, v166, v26
    v_mul_f32 v167, v167, v26
    s_waitcnt lgkmcnt(0)
    s_barrier
    s_waitcnt vmcnt(18)
    v_mfma_f32_32x32x16_bf16 v[144:159], a[240:243], a[168:171], v[144:159]
    buffer_load_dwordx4 a[116:119], v70, s[60:63], s90 offen
    v_mul_f32 v168, v168, v26
    v_mul_f32 v169, v169, v26
    v_mfma_f32_32x32x16_bf16 v[208:223], a[244:247], a[168:171], v[208:223]
    ds_write_b128 v101, v[128:131] offset:0
    v_mul_f32 v170, v170, v26
    v_mul_f32 v171, v171, v26
    s_waitcnt vmcnt(18)
    v_mfma_f32_32x32x16_bf16 v[144:159], a[248:251], a[172:175], v[144:159]
    buffer_load_dwordx4 a[120:123], v71, s[60:63], s90 offen
    v_mul_f32 v172, v172, v26
    v_mul_f32 v173, v173, v26
    v_mfma_f32_32x32x16_bf16 v[208:223], a[252:255], a[172:175], v[208:223]
    ds_write_b128 v101, v[132:135] offset:1024
    v_mul_f32 v174, v174, v26
    v_mul_f32 v175, v175, v26
    s_waitcnt vmcnt(18)
    v_mfma_f32_32x32x16_bf16 v[144:159], a[0:3], a[176:179], v[144:159]
    buffer_load_dwordx4 a[124:127], v72, s[60:63], s90 offen
    v_mul_f32 v224, v224, v26
    v_mul_f32 v225, v225, v26
    v_mfma_f32_32x32x16_bf16 v[208:223], a[4:7], a[176:179], v[208:223]
    ds_write_b128 v101, v[136:139] offset:2048
    v_mul_f32 v226, v226, v26
    v_mul_f32 v227, v227, v26
    s_waitcnt vmcnt(18)
    v_mfma_f32_32x32x16_bf16 v[144:159], a[8:11], a[180:183], v[144:159]
    buffer_load_dwordx4 a[128:131], v38, s[60:63], s50 offen
    v_mul_f32 v228, v228, v26
    v_mul_f32 v229, v229, v26
    v_mfma_f32_32x32x16_bf16 v[208:223], a[12:15], a[180:183], v[208:223]
    ds_write_b128 v101, v[140:143] offset:3072
    v_mul_f32 v230, v230, v26
    v_mul_f32 v231, v231, v26
    s_waitcnt vmcnt(18)
    v_mfma_f32_32x32x16_bf16 v[144:159], a[16:19], a[184:187], v[144:159]
    buffer_load_dwordx4 a[132:135], v70, s[60:63], s50 offen
    v_mul_f32 v232, v232, v26
    v_mul_f32 v233, v233, v26
    v_mfma_f32_32x32x16_bf16 v[208:223], a[20:23], a[184:187], v[208:223]
    ds_write_b128 v101, v[192:195] offset:4096
    v_mul_f32 v234, v234, v26
    v_mul_f32 v235, v235, v26
    s_waitcnt vmcnt(18)
    v_mfma_f32_32x32x16_bf16 v[144:159], a[24:27], a[188:191], v[144:159]
    buffer_load_dwordx4 a[136:139], v71, s[60:63], s50 offen
    v_mul_f32 v236, v236, v26
    v_mul_f32 v237, v237, v26
    v_mfma_f32_32x32x16_bf16 v[208:223], a[28:31], a[188:191], v[208:223]
    ds_write_b128 v101, v[196:199] offset:5120
    v_mul_f32 v238, v238, v26
    v_mul_f32 v239, v239, v26
    s_waitcnt vmcnt(18)
    v_mfma_f32_32x32x16_bf16 v[144:159], a[32:35], a[192:195], v[144:159]
    buffer_load_dwordx4 a[140:143], v72, s[60:63], s50 offen
    v_mfma_f32_32x32x16_bf16 v[208:223], a[36:39], a[192:195], v[208:223]
    ds_write_b128 v101, v[200:203] offset:6144
    s_waitcnt vmcnt(18)
    v_mfma_f32_32x32x16_bf16 v[144:159], a[40:43], a[196:199], v[144:159]
    buffer_load_dwordx4 a[144:147], v38, s[60:63], s77 offen
    v_mfma_f32_32x32x16_bf16 v[208:223], a[44:47], a[196:199], v[208:223]
    ds_write_b128 v101, v[204:207] offset:7168
    s_waitcnt vmcnt(18)
    v_mfma_f32_32x32x16_bf16 v[144:159], a[48:51], a[200:203], v[144:159]
    buffer_load_dwordx4 a[148:151], v70, s[60:63], s77 offen
    v_mfma_f32_32x32x16_bf16 v[208:223], a[52:55], a[200:203], v[208:223]
    s_waitcnt vmcnt(18)
    v_mfma_f32_32x32x16_bf16 v[144:159], a[56:59], a[204:207], v[144:159]
    buffer_load_dwordx4 a[152:155], v71, s[60:63], s77 offen
    v_mfma_f32_32x32x16_bf16 v[208:223], a[60:63], a[204:207], v[208:223]
    s_waitcnt vmcnt(18)
    v_mfma_f32_32x32x16_bf16 v[144:159], a[64:67], a[208:211], v[144:159]
    buffer_load_dwordx4 a[156:159], v72, s[60:63], s77 offen
    v_mfma_f32_32x32x16_bf16 v[208:223], a[68:71], a[208:211], v[208:223]
    s_waitcnt vmcnt(18)
    v_mfma_f32_32x32x16_bf16 v[144:159], a[72:75], a[212:215], v[144:159]
    buffer_load_dwordx4 a[160:163], v39, s[60:63], s89 offen
    v_mfma_f32_32x32x16_bf16 v[208:223], a[76:79], a[212:215], v[208:223]
    s_waitcnt vmcnt(18)
    v_mfma_f32_32x32x16_bf16 v[144:159], a[80:83], a[216:219], v[144:159]
    buffer_load_dwordx4 a[164:167], v73, s[60:63], s89 offen
    v_mfma_f32_32x32x16_bf16 v[208:223], a[84:87], a[216:219], v[208:223]
    s_waitcnt vmcnt(18)
    v_mfma_f32_32x32x16_bf16 v[144:159], v[48:51], a[220:223], v[144:159]
    buffer_load_dwordx4 a[168:171], v74, s[60:63], s89 offen
    v_mfma_f32_32x32x16_bf16 v[208:223], v[52:55], a[220:223], v[208:223]
    s_waitcnt vmcnt(18)
    v_mfma_f32_32x32x16_bf16 v[160:175], a[224:227], a[96:99], v[160:175]
    buffer_load_dwordx4 a[172:175], v75, s[60:63], s89 offen
    v_mul_f32 v176, v176, v27
    v_mul_f32 v177, v177, v27
    v_mul_f32 v178, v178, v27
    v_mfma_f32_32x32x16_bf16 v[224:239], a[228:231], a[96:99], v[224:239]
    v_mul_f32 v179, v179, v27
    v_mul_f32 v180, v180, v27
    v_mul_f32 v181, v181, v27
    s_waitcnt vmcnt(18)
    v_mfma_f32_32x32x16_bf16 v[160:175], a[232:235], a[100:103], v[160:175]
    buffer_load_dwordx4 a[176:179], v39, s[60:63], s90 offen
    v_mul_f32 v182, v182, v27
    v_mul_f32 v183, v183, v27
    v_mul_f32 v184, v184, v27
    v_mfma_f32_32x32x16_bf16 v[224:239], a[236:239], a[100:103], v[224:239]
    v_mul_f32 v185, v185, v27
    v_mul_f32 v186, v186, v27
    v_mul_f32 v187, v187, v27
    s_waitcnt vmcnt(18)
    v_mfma_f32_32x32x16_bf16 v[160:175], a[240:243], a[104:107], v[160:175]
    buffer_load_dwordx4 a[180:183], v73, s[60:63], s90 offen
    v_mul_f32 v188, v188, v27
    v_mul_f32 v189, v189, v27
    v_mul_f32 v190, v190, v27
    v_mfma_f32_32x32x16_bf16 v[224:239], a[244:247], a[104:107], v[224:239]
    ds_write_b128 v102, v[144:147] offset:0
    v_mul_f32 v191, v191, v27
    v_mul_f32 v240, v240, v27
    v_mul_f32 v241, v241, v27
    s_waitcnt vmcnt(18)
    v_mfma_f32_32x32x16_bf16 v[160:175], a[248:251], a[108:111], v[160:175]
    buffer_load_dwordx4 a[184:187], v74, s[60:63], s90 offen
    v_mul_f32 v242, v242, v27
    v_mul_f32 v243, v243, v27
    v_mul_f32 v244, v244, v27
    v_mfma_f32_32x32x16_bf16 v[224:239], a[252:255], a[108:111], v[224:239]
    ds_write_b128 v102, v[148:151] offset:1024
    v_mul_f32 v245, v245, v27
    v_mul_f32 v246, v246, v27
    v_mul_f32 v247, v247, v27
    s_waitcnt vmcnt(18)
    v_mfma_f32_32x32x16_bf16 v[160:175], a[0:3], a[112:115], v[160:175]
    buffer_load_dwordx4 a[188:191], v75, s[60:63], s90 offen
    v_mul_f32 v248, v248, v27
    v_mul_f32 v249, v249, v27
    v_mul_f32 v250, v250, v27
    v_mfma_f32_32x32x16_bf16 v[224:239], a[4:7], a[112:115], v[224:239]
    ds_write_b128 v102, v[152:155] offset:2048
    v_mul_f32 v251, v251, v27
    v_mul_f32 v252, v252, v27
    v_mul_f32 v253, v253, v27
    s_waitcnt vmcnt(18)
    v_mfma_f32_32x32x16_bf16 v[160:175], a[8:11], a[116:119], v[160:175]
    buffer_load_dwordx4 a[192:195], v39, s[60:63], s50 offen
    v_mul_f32 v254, v254, v27
    v_mul_f32 v255, v255, v27
    s_lshl_b32 s45, s42, 12
    v_mfma_f32_32x32x16_bf16 v[224:239], a[12:15], a[116:119], v[224:239]
    ds_write_b128 v102, v[156:159] offset:3072
    s_add_u32 s45, s45, 147456
    v_and_b32 v13, 31, v1
    v_lshl_add_u32 v112, v13, 7, s45
    s_waitcnt vmcnt(18)
    v_mfma_f32_32x32x16_bf16 v[160:175], a[16:19], a[120:123], v[160:175]
    buffer_load_dwordx4 a[196:199], v73, s[60:63], s50 offen
    v_lshrrev_b32 v14, 5, v1
    v_xor_b32 v14, v14, v1
    v_and_b32 v14, 7, v14
    v_mfma_f32_32x32x16_bf16 v[224:239], a[20:23], a[120:123], v[224:239]
    ds_write_b128 v102, v[208:211] offset:4096
    v_lshl_add_u32 v112, v14, 4, v112
    v_xor_b32 v113, 32, v112
    v_xor_b32 v114, 64, v112
    s_waitcnt vmcnt(18)
    v_mfma_f32_32x32x16_bf16 v[160:175], a[24:27], a[124:127], v[160:175]
    buffer_load_dwordx4 a[200:203], v74, s[60:63], s50 offen
    v_xor_b32 v115, 0x60, v112
    v_lshrrev_b32 v13, 3, v1
    v_xor_b32 v14, v13, v1
    v_mfma_f32_32x32x16_bf16 v[224:239], a[28:31], a[124:127], v[224:239]
    ds_write_b128 v102, v[212:215] offset:5120
    v_and_b32 v14, 7, v14
    v_lshl_add_u32 v116, v13, 7, s45
    v_lshl_add_u32 v116, v14, 4, v116
    s_waitcnt vmcnt(18)
    v_mfma_f32_32x32x16_bf16 v[160:175], a[32:35], a[128:131], v[160:175]
    buffer_load_dwordx4 a[204:207], v75, s[60:63], s50 offen
    v_and_b32 v14, 7, v1
    v_lshlrev_b32 v14, 4, v14
    s_lshl_b32 s45, s42, 16
    v_mfma_f32_32x32x16_bf16 v[224:239], a[36:39], a[128:131], v[224:239]
    ds_write_b128 v102, v[216:219] offset:6144
    v_lshl_add_u32 v100, v13, 11, s45
    v_add_u32 v100, v100, v14
    s_mov_b32 s80, 16384
    s_waitcnt vmcnt(18)
    v_mfma_f32_32x32x16_bf16 v[160:175], a[40:43], a[132:135], v[160:175]
    buffer_load_dwordx4 a[208:211], v39, s[60:63], s77 offen
    s_mov_b32 s87, 32768
    s_mov_b32 s82, 49152
    v_mfma_f32_32x32x16_bf16 v[224:239], a[44:47], a[132:135], v[224:239]
    ds_write_b128 v102, v[220:223] offset:7168
    s_waitcnt vmcnt(18)
    v_mfma_f32_32x32x16_bf16 v[160:175], a[48:51], a[136:139], v[160:175]
    buffer_load_dwordx4 a[212:215], v73, s[60:63], s77 offen
    v_mfma_f32_32x32x16_bf16 v[224:239], a[52:55], a[136:139], v[224:239]
    s_waitcnt lgkmcnt(0)
    s_barrier
    s_waitcnt vmcnt(18)
    v_mfma_f32_32x32x16_bf16 v[160:175], a[56:59], a[140:143], v[160:175]
    buffer_load_dwordx4 a[216:219], v74, s[60:63], s77 offen
    ds_read_b128 v[128:131], v104 offset:16384
    ds_read_b128 v[132:135], v104 offset:17408
    ds_read_b128 v[136:139], v104 offset:18432
    v_mfma_f32_32x32x16_bf16 v[224:239], a[60:63], a[140:143], v[224:239]
    ds_read_b128 v[140:143], v104 offset:19456
    ds_read_b128 v[192:195], v104 offset:20480
    ds_read_b128 v[196:199], v104 offset:21504
    s_waitcnt vmcnt(18)
    v_mfma_f32_32x32x16_bf16 v[160:175], a[64:67], a[144:147], v[160:175]
    buffer_load_dwordx4 a[220:223], v75, s[60:63], s77 offen
    ds_read_b128 v[200:203], v104 offset:22528
    ds_read_b128 v[204:207], v104 offset:23552
    ds_read_b128 v[144:147], v104 offset:8192
    v_mfma_f32_32x32x16_bf16 v[224:239], a[68:71], a[144:147], v[224:239]
    ds_read_b128 v[148:151], v104 offset:9216
    ds_read_b128 v[152:155], v104 offset:10240
    ds_read_b128 v[156:159], v104 offset:11264
    s_waitcnt vmcnt(18)
    v_mfma_f32_32x32x16_bf16 v[160:175], a[72:75], a[148:151], v[160:175]
    ds_read_b128 v[208:211], v104 offset:12288
    ds_read_b128 v[212:215], v104 offset:13312
    ds_read_b128 v[216:219], v104 offset:14336
    v_mfma_f32_32x32x16_bf16 v[224:239], a[76:79], a[148:151], v[224:239]
    ds_read_b128 v[220:223], v104 offset:15360
    s_waitcnt vmcnt(17)
    v_mfma_f32_32x32x16_bf16 v[160:175], a[80:83], a[152:155], v[160:175]
    s_waitcnt lgkmcnt(7)
    v_add_f32 v128, v128, v144
    v_mfma_f32_32x32x16_bf16 v[224:239], a[84:87], a[152:155], v[224:239]
    v_add_f32 v129, v129, v145
    v_add_f32 v130, v130, v146
    v_add_f32 v131, v131, v147
    s_waitcnt vmcnt(16)
    v_mfma_f32_32x32x16_bf16 v[160:175], v[48:51], a[156:159], v[160:175]
    s_waitcnt lgkmcnt(6)
    v_add_f32 v132, v132, v148
    v_add_f32 v133, v133, v149
    v_add_f32 v134, v134, v150
    v_mfma_f32_32x32x16_bf16 v[224:239], v[52:55], a[156:159], v[224:239]
    v_add_f32 v135, v135, v151
    s_waitcnt lgkmcnt(5)
    v_add_f32 v136, v136, v152
    v_add_f32 v137, v137, v153
    s_waitcnt vmcnt(15)
    v_mfma_f32_32x32x16_bf16 v[176:191], a[224:227], a[160:163], v[176:191]
    v_add_f32 v138, v138, v154
    v_add_f32 v139, v139, v155
    s_waitcnt lgkmcnt(4)
    v_add_f32 v140, v140, v156
    v_mfma_f32_32x32x16_bf16 v[240:255], a[228:231], a[160:163], v[240:255]
    v_add_f32 v141, v141, v157
    v_add_f32 v142, v142, v158
    v_add_f32 v143, v143, v159
    s_waitcnt vmcnt(14)
    v_mfma_f32_32x32x16_bf16 v[176:191], a[232:235], a[164:167], v[176:191]
    s_waitcnt lgkmcnt(3)
    v_add_f32 v192, v192, v208
    v_add_f32 v193, v193, v209
    v_add_f32 v194, v194, v210
    v_mfma_f32_32x32x16_bf16 v[240:255], a[236:239], a[164:167], v[240:255]
    v_add_f32 v195, v195, v211
    s_waitcnt lgkmcnt(2)
    v_add_f32 v196, v196, v212
    v_add_f32 v197, v197, v213
    s_waitcnt vmcnt(13)
    v_mfma_f32_32x32x16_bf16 v[176:191], a[240:243], a[168:171], v[176:191]
    ds_write_b128 v103, v[160:163] offset:0
    v_add_f32 v198, v198, v214
    v_add_f32 v199, v199, v215
    s_waitcnt lgkmcnt(2)
    v_add_f32 v200, v200, v216
    v_mfma_f32_32x32x16_bf16 v[240:255], a[244:247], a[168:171], v[240:255]
    ds_write_b128 v103, v[164:167] offset:1024
    v_add_f32 v201, v201, v217
    v_add_f32 v202, v202, v218
    v_add_f32 v203, v203, v219
    s_waitcnt vmcnt(12)
    v_mfma_f32_32x32x16_bf16 v[176:191], a[248:251], a[172:175], v[176:191]
    ds_write_b128 v103, v[168:171] offset:2048
    s_waitcnt lgkmcnt(3)
    v_add_f32 v204, v204, v220
    v_add_f32 v205, v205, v221
    v_add_f32 v206, v206, v222
    v_mfma_f32_32x32x16_bf16 v[240:255], a[252:255], a[172:175], v[240:255]
    ds_write_b128 v103, v[172:175] offset:3072
    v_add_f32 v207, v207, v223
    s_waitcnt vmcnt(11)
    v_mfma_f32_32x32x16_bf16 v[176:191], a[0:3], a[176:179], v[176:191]
    ds_write_b128 v103, v[224:227] offset:4096
    v_mfma_f32_32x32x16_bf16 v[240:255], a[4:7], a[176:179], v[240:255]
    ds_write_b128 v103, v[228:231] offset:5120
    s_waitcnt vmcnt(10)
    v_mfma_f32_32x32x16_bf16 v[176:191], a[8:11], a[180:183], v[176:191]
    ds_write_b128 v103, v[232:235] offset:6144
    v_mfma_f32_32x32x16_bf16 v[240:255], a[12:15], a[180:183], v[240:255]
    ds_write_b128 v103, v[236:239] offset:7168
    s_waitcnt vmcnt(9)
    v_mfma_f32_32x32x16_bf16 v[176:191], a[16:19], a[184:187], v[176:191]
    v_mfma_f32_32x32x16_bf16 v[240:255], a[20:23], a[184:187], v[240:255]
    s_waitcnt lgkmcnt(0)
    s_barrier
    s_waitcnt vmcnt(8)
    v_mfma_f32_32x32x16_bf16 v[176:191], a[24:27], a[188:191], v[176:191]
    ds_read_b128 v[160:163], v104 offset:0
    ds_read_b128 v[164:167], v104 offset:1024
    ds_read_b128 v[168:171], v104 offset:2048
    v_mfma_f32_32x32x16_bf16 v[240:255], a[28:31], a[188:191], v[240:255]
    ds_read_b128 v[172:175], v104 offset:3072
    ds_read_b128 v[224:227], v104 offset:4096
    ds_read_b128 v[228:231], v104 offset:5120
    s_waitcnt vmcnt(7)
    v_mfma_f32_32x32x16_bf16 v[176:191], a[32:35], a[192:195], v[176:191]
    ds_read_b128 v[232:235], v104 offset:6144
    ds_read_b128 v[236:239], v104 offset:7168
    v_mfma_f32_32x32x16_bf16 v[240:255], a[36:39], a[192:195], v[240:255]
    s_waitcnt vmcnt(6)
    v_mfma_f32_32x32x16_bf16 v[176:191], a[40:43], a[196:199], v[176:191]
    s_waitcnt lgkmcnt(7)
    v_add_f32 v128, v128, v160
    v_mfma_f32_32x32x16_bf16 v[240:255], a[44:47], a[196:199], v[240:255]
    v_add_f32 v129, v129, v161
    v_add_f32 v130, v130, v162
    v_add_f32 v131, v131, v163
    s_waitcnt vmcnt(5)
    v_mfma_f32_32x32x16_bf16 v[176:191], a[48:51], a[200:203], v[176:191]
    s_waitcnt lgkmcnt(6)
    v_add_f32 v132, v132, v164
    v_add_f32 v133, v133, v165
    v_add_f32 v134, v134, v166
    v_mfma_f32_32x32x16_bf16 v[240:255], a[52:55], a[200:203], v[240:255]
    v_add_f32 v135, v135, v167
    s_waitcnt lgkmcnt(5)
    v_add_f32 v136, v136, v168
    v_add_f32 v137, v137, v169
    s_waitcnt vmcnt(4)
    v_mfma_f32_32x32x16_bf16 v[176:191], a[56:59], a[204:207], v[176:191]
    v_add_f32 v138, v138, v170
    v_add_f32 v139, v139, v171
    s_waitcnt lgkmcnt(4)
    v_add_f32 v140, v140, v172
    v_mfma_f32_32x32x16_bf16 v[240:255], a[60:63], a[204:207], v[240:255]
    v_add_f32 v141, v141, v173
    v_add_f32 v142, v142, v174
    v_add_f32 v143, v143, v175
    s_waitcnt vmcnt(3)
    v_mfma_f32_32x32x16_bf16 v[176:191], a[64:67], a[208:211], v[176:191]
    s_waitcnt lgkmcnt(3)
    v_add_f32 v192, v192, v224
    v_add_f32 v193, v193, v225
    v_add_f32 v194, v194, v226
    v_mfma_f32_32x32x16_bf16 v[240:255], a[68:71], a[208:211], v[240:255]
    v_add_f32 v195, v195, v227
    s_waitcnt lgkmcnt(2)
    v_add_f32 v196, v196, v228
    v_add_f32 v197, v197, v229
    s_waitcnt vmcnt(2)
    v_mfma_f32_32x32x16_bf16 v[176:191], a[72:75], a[212:215], v[176:191]
    v_add_f32 v198, v198, v230
    v_add_f32 v199, v199, v231
    s_waitcnt lgkmcnt(1)
    v_add_f32 v200, v200, v232
    v_mfma_f32_32x32x16_bf16 v[240:255], a[76:79], a[212:215], v[240:255]
    v_add_f32 v201, v201, v233
    v_add_f32 v202, v202, v234
    v_add_f32 v203, v203, v235
    s_waitcnt vmcnt(1)
    v_mfma_f32_32x32x16_bf16 v[176:191], a[80:83], a[216:219], v[176:191]
    s_waitcnt lgkmcnt(0)
    v_add_f32 v204, v204, v236
    v_add_f32 v205, v205, v237
    v_add_f32 v206, v206, v238
    v_mfma_f32_32x32x16_bf16 v[240:255], a[84:87], a[216:219], v[240:255]
    v_add_f32 v207, v207, v239
    s_waitcnt vmcnt(0)
    v_mfma_f32_32x32x16_bf16 v[176:191], v[48:51], a[220:223], v[176:191]
    v_mfma_f32_32x32x16_bf16 v[240:255], v[52:55], a[220:223], v[240:255]
    s_nop 10
    v_pk_add_f32 v[176:177], v[176:177], v[128:129]
    v_pk_add_f32 v[178:179], v[178:179], v[130:131]
    v_pk_add_f32 v[180:181], v[180:181], v[132:133]
    v_pk_add_f32 v[182:183], v[182:183], v[134:135]
    v_cvt_pk_bf16_f32 v56, v176, v177
    v_cvt_pk_bf16_f32 v57, v178, v179
    v_cvt_pk_bf16_f32 v58, v180, v181
    v_cvt_pk_bf16_f32 v59, v182, v183
    s_nop 0
    v_permlane32_swap_b32 v56, v58
    v_permlane32_swap_b32 v57, v59
    ds_write_b128 v112, v[56:59]
    v_pk_add_f32 v[184:185], v[184:185], v[136:137]
    v_pk_add_f32 v[186:187], v[186:187], v[138:139]
    v_pk_add_f32 v[188:189], v[188:189], v[140:141]
    v_pk_add_f32 v[190:191], v[190:191], v[142:143]
    v_cvt_pk_bf16_f32 v60, v184, v185
    v_cvt_pk_bf16_f32 v61, v186, v187
    v_cvt_pk_bf16_f32 v62, v188, v189
    v_cvt_pk_bf16_f32 v63, v190, v191
    s_nop 0
    v_permlane32_swap_b32 v60, v62
    v_permlane32_swap_b32 v61, v63
    ds_write_b128 v113, v[60:63]
    v_pk_add_f32 v[240:241], v[240:241], v[192:193]
    v_pk_add_f32 v[242:243], v[242:243], v[194:195]
    v_pk_add_f32 v[244:245], v[244:245], v[196:197]
    v_pk_add_f32 v[246:247], v[246:247], v[198:199]
    v_cvt_pk_bf16_f32 v80, v240, v241
    v_cvt_pk_bf16_f32 v81, v242, v243
    v_cvt_pk_bf16_f32 v82, v244, v245
    v_cvt_pk_bf16_f32 v83, v246, v247
    s_nop 0
    v_permlane32_swap_b32 v80, v82
    v_permlane32_swap_b32 v81, v83
    ds_write_b128 v114, v[80:83]
    v_pk_add_f32 v[248:249], v[248:249], v[200:201]
    v_pk_add_f32 v[250:251], v[250:251], v[202:203]
    v_pk_add_f32 v[252:253], v[252:253], v[204:205]
    v_pk_add_f32 v[254:255], v[254:255], v[206:207]
    v_cvt_pk_bf16_f32 v84, v248, v249
    v_cvt_pk_bf16_f32 v85, v250, v251
    v_cvt_pk_bf16_f32 v86, v252, v253
    v_cvt_pk_bf16_f32 v87, v254, v255
    s_nop 0
    v_permlane32_swap_b32 v84, v86
    v_permlane32_swap_b32 v85, v87
    ds_write_b128 v115, v[84:87]
    s_waitcnt lgkmcnt(0)
    ds_read_b128 v[144:147], v116 offset:0
    ds_read_b128 v[148:151], v116 offset:1024
    ds_read_b128 v[152:155], v116 offset:2048
    ds_read_b128 v[156:159], v116 offset:3072
    s_waitcnt lgkmcnt(3)
    buffer_store_dwordx4 v[144:147], v100, s[72:75], 0 offen sc1
    s_waitcnt lgkmcnt(2)
    buffer_store_dwordx4 v[148:151], v100, s[72:75], s80 offen sc1
    s_waitcnt lgkmcnt(1)
    buffer_store_dwordx4 v[152:155], v100, s[72:75], s87 offen sc1
    s_waitcnt lgkmcnt(0)
    buffer_store_dwordx4 v[156:159], v100, s[72:75], s82 offen sc1
    s_endpgm
gated_mix__softmax_full_mha__glu_gated_bilinear__prompt_kernel_slow:
    s_waitcnt vmcnt(0) lgkmcnt(0)
    v_mov_b32 v12, 0xff800000
    v_mov_b32 v13, 0xff800000
    s_mov_b32 s76, 0
    s_mov_b32 s58, 262144
gated_mix__softmax_full_mha__glu_gated_bilinear__prompt_kernel_slow1:
    buffer_load_dwordx4 a[56:59], v6, s[56:59], s76 offen offset:0
    buffer_load_dwordx4 a[60:63], v6, s[56:59], s76 offen offset:1024
    s_waitcnt vmcnt(1)
    v_mfma_f32_32x32x16_bf16 v[48:63], a[56:59], a[40:43], 0
    s_waitcnt vmcnt(0)
    v_mfma_f32_32x32x16_bf16 v[48:63], a[60:63], a[44:47], v[48:63]
    v_mfma_f32_32x32x16_bf16 v[64:79], a[56:59], a[48:51], 0
    v_mfma_f32_32x32x16_bf16 v[64:79], a[60:63], a[52:55], v[64:79]
    s_nop 9
    v_max3_f32 v12, v12, v48, v49
    v_max3_f32 v12, v12, v50, v51
    v_max3_f32 v12, v12, v52, v53
    v_max3_f32 v12, v12, v54, v55
    v_max3_f32 v12, v12, v56, v57
    v_max3_f32 v12, v12, v58, v59
    v_max3_f32 v12, v12, v60, v61
    v_max3_f32 v12, v12, v62, v63
    v_max3_f32 v13, v13, v64, v65
    v_max3_f32 v13, v13, v66, v67
    v_max3_f32 v13, v13, v68, v69
    v_max3_f32 v13, v13, v70, v71
    v_max3_f32 v13, v13, v72, v73
    v_max3_f32 v13, v13, v74, v75
    v_max3_f32 v13, v13, v76, v77
    v_max3_f32 v13, v13, v78, v79
    s_add_u32 s76, s76, 4096
    s_cmp_lt_u32 s76, 262144
    s_cbranch_scc1 gated_mix__softmax_full_mha__glu_gated_bilinear__prompt_kernel_slow1
    v_mov_b32 v14, v12
    s_nop 1
    v_permlane32_swap_b32 v14, v12
    v_max_f32 v12, v12, v14
    v_sub_f32 v96, 0, v12
    v_sub_f32 v97, 0, v12
    v_sub_f32 v98, 0, v12
    v_sub_f32 v99, 0, v12
    v_sub_f32 v100, 0, v12
    v_sub_f32 v101, 0, v12
    v_sub_f32 v102, 0, v12
    v_sub_f32 v103, 0, v12
    v_sub_f32 v104, 0, v12
    v_sub_f32 v105, 0, v12
    v_sub_f32 v106, 0, v12
    v_sub_f32 v107, 0, v12
    v_sub_f32 v108, 0, v12
    v_sub_f32 v109, 0, v12
    v_sub_f32 v110, 0, v12
    v_sub_f32 v111, 0, v12
    v_mov_b32 v14, v13
    s_nop 1
    v_permlane32_swap_b32 v14, v13
    v_max_f32 v13, v13, v14
    v_sub_f32 v112, 0, v13
    v_sub_f32 v113, 0, v13
    v_sub_f32 v114, 0, v13
    v_sub_f32 v115, 0, v13
    v_sub_f32 v116, 0, v13
    v_sub_f32 v117, 0, v13
    v_sub_f32 v118, 0, v13
    v_sub_f32 v119, 0, v13
    v_sub_f32 v120, 0, v13
    v_sub_f32 v121, 0, v13
    v_sub_f32 v122, 0, v13
    v_sub_f32 v123, 0, v13
    v_sub_f32 v124, 0, v13
    v_sub_f32 v125, 0, v13
    v_sub_f32 v126, 0, v13
    v_sub_f32 v127, 0, v13
    v_accvgpr_write_b32 a0, 0
    v_accvgpr_write_b32 a1, 0
    v_accvgpr_write_b32 a2, 0
    v_accvgpr_write_b32 a3, 0
    v_accvgpr_write_b32 a4, 0
    v_accvgpr_write_b32 a5, 0
    v_accvgpr_write_b32 a6, 0
    v_accvgpr_write_b32 a7, 0
    v_accvgpr_write_b32 a8, 0
    v_accvgpr_write_b32 a9, 0
    v_accvgpr_write_b32 a10, 0
    v_accvgpr_write_b32 a11, 0
    v_accvgpr_write_b32 a12, 0
    v_accvgpr_write_b32 a13, 0
    v_accvgpr_write_b32 a14, 0
    v_accvgpr_write_b32 a15, 0
    v_accvgpr_write_b32 a32, 0
    v_accvgpr_write_b32 a33, 0
    v_accvgpr_write_b32 a34, 0
    v_accvgpr_write_b32 a35, 0
    v_accvgpr_write_b32 a16, 0
    v_accvgpr_write_b32 a17, 0
    v_accvgpr_write_b32 a18, 0
    v_accvgpr_write_b32 a19, 0
    v_accvgpr_write_b32 a20, 0
    v_accvgpr_write_b32 a21, 0
    v_accvgpr_write_b32 a22, 0
    v_accvgpr_write_b32 a23, 0
    v_accvgpr_write_b32 a24, 0
    v_accvgpr_write_b32 a25, 0
    v_accvgpr_write_b32 a26, 0
    v_accvgpr_write_b32 a27, 0
    v_accvgpr_write_b32 a28, 0
    v_accvgpr_write_b32 a29, 0
    v_accvgpr_write_b32 a30, 0
    v_accvgpr_write_b32 a31, 0
    v_accvgpr_write_b32 a36, 0
    v_accvgpr_write_b32 a37, 0
    v_accvgpr_write_b32 a38, 0
    v_accvgpr_write_b32 a39, 0
    s_mov_b32 s76, 0
gated_mix__softmax_full_mha__glu_gated_bilinear__prompt_kernel_slow3:
    buffer_load_dwordx4 a[56:59], v6, s[56:59], s76 offen offset:0
    buffer_load_dwordx4 a[60:63], v6, s[56:59], s76 offen offset:1024
    buffer_load_dwordx4 a[72:75], v6, s[56:59], s76 offen offset:2048
    buffer_load_dwordx4 a[76:79], v6, s[56:59], s76 offen offset:3072
    s_waitcnt vmcnt(3)
    v_mfma_f32_32x32x16_bf16 v[48:63], a[56:59], a[40:43], v[96:111]
    s_waitcnt vmcnt(2)
    v_mfma_f32_32x32x16_bf16 v[48:63], a[60:63], a[44:47], v[48:63]
    v_mfma_f32_32x32x16_bf16 v[64:79], a[56:59], a[48:51], v[112:127]
    v_mfma_f32_32x32x16_bf16 v[64:79], a[60:63], a[52:55], v[64:79]
    s_nop 9
    v_exp_f32 v48, v48
    v_exp_f32 v49, v49
    v_exp_f32 v50, v50
    v_exp_f32 v51, v51
    v_exp_f32 v52, v52
    v_exp_f32 v53, v53
    v_exp_f32 v54, v54
    v_exp_f32 v55, v55
    v_exp_f32 v56, v56
    v_exp_f32 v57, v57
    v_exp_f32 v58, v58
    v_exp_f32 v59, v59
    v_exp_f32 v60, v60
    v_exp_f32 v61, v61
    v_exp_f32 v62, v62
    v_exp_f32 v63, v63
    v_cvt_pk_bf16_f32 v80, v48, v49
    v_cvt_pk_bf16_f32 v81, v50, v51
    v_cvt_pk_bf16_f32 v82, v52, v53
    v_cvt_pk_bf16_f32 v83, v54, v55
    v_cvt_pk_bf16_f32 v84, v56, v57
    v_cvt_pk_bf16_f32 v85, v58, v59
    v_cvt_pk_bf16_f32 v86, v60, v61
    v_cvt_pk_bf16_f32 v87, v62, v63
    s_waitcnt vmcnt(1)
    v_mfma_f32_32x32x16_bf16 a[0:15], a[72:75], v[80:83], a[0:15]
    s_waitcnt vmcnt(0)
    v_mfma_f32_32x32x16_bf16 a[0:15], a[76:79], v[84:87], a[0:15]
    v_smfmac_f32_16x16x64_bf16 a[32:35], v[32:35], v[80:87], v11
    v_exp_f32 v64, v64
    v_exp_f32 v65, v65
    v_exp_f32 v66, v66
    v_exp_f32 v67, v67
    v_exp_f32 v68, v68
    v_exp_f32 v69, v69
    v_exp_f32 v70, v70
    v_exp_f32 v71, v71
    v_exp_f32 v72, v72
    v_exp_f32 v73, v73
    v_exp_f32 v74, v74
    v_exp_f32 v75, v75
    v_exp_f32 v76, v76
    v_exp_f32 v77, v77
    v_exp_f32 v78, v78
    v_exp_f32 v79, v79
    v_cvt_pk_bf16_f32 v88, v64, v65
    v_cvt_pk_bf16_f32 v89, v66, v67
    v_cvt_pk_bf16_f32 v90, v68, v69
    v_cvt_pk_bf16_f32 v91, v70, v71
    v_cvt_pk_bf16_f32 v92, v72, v73
    v_cvt_pk_bf16_f32 v93, v74, v75
    v_cvt_pk_bf16_f32 v94, v76, v77
    v_cvt_pk_bf16_f32 v95, v78, v79
    v_mfma_f32_32x32x16_bf16 a[16:31], a[72:75], v[88:91], a[16:31]
    s_nop 0
    v_mfma_f32_32x32x16_bf16 a[16:31], a[76:79], v[92:95], a[16:31]
    v_smfmac_f32_16x16x64_bf16 a[36:39], v[32:35], v[88:95], v11
    s_add_u32 s76, s76, 4096
    s_cmp_lt_u32 s76, 262144
    s_cbranch_scc1 gated_mix__softmax_full_mha__glu_gated_bilinear__prompt_kernel_slow3
    v_accvgpr_read_b32 v30, a32
    v_accvgpr_read_b32 v12, a33
    s_nop 2
    v_accvgpr_read_b32 v31, a36
    v_accvgpr_read_b32 v13, a37
    v_add_f32 v30, v30, v12
    v_add_f32 v31, v31, v13
    s_branch gated_mix__softmax_full_mha__glu_gated_bilinear__prompt_kernel_epi
gated_mix__softmax_full_mha__glu_gated_bilinear__prompt_kernel_cnt_spin:
    s_mov_b32 s48, 40000
gated_mix__softmax_full_mha__glu_gated_bilinear__prompt_kernel_cnt_again:
    s_sleep 2
    buffer_load_dword v34, v33, s[36:39], 0 offen offset:64 sc1
    s_waitcnt vmcnt(0)
    s_nop 1
    v_cmp_gt_u32 vcc, 32, v34
    s_nop 4
    s_cbranch_vccz gated_mix__softmax_full_mha__glu_gated_bilinear__prompt_kernel_cnt_ok
    s_sub_u32 s48, s48, 1
    s_cmp_lg_u32 s48, 0
    s_cbranch_scc1 gated_mix__softmax_full_mha__glu_gated_bilinear__prompt_kernel_cnt_again
    s_branch gated_mix__softmax_full_mha__glu_gated_bilinear__prompt_kernel_cnt_ok
gated_mix__softmax_full_mha__glu_gated_bilinear__prompt_kernel_kv_spin:
    s_mov_b32 s88, 40000
gated_mix__softmax_full_mha__glu_gated_bilinear__prompt_kernel_kv_again:
    s_sleep 2
    buffer_load_dword v28, v15, s[32:35], s47 offen sc1
    s_waitcnt vmcnt(0)
    s_nop 1
    v_cmp_gt_u32 vcc, 1, v28
    s_nop 4
    s_cbranch_vccz gated_mix__softmax_full_mha__glu_gated_bilinear__prompt_kernel_kv_ok
    s_sub_u32 s88, s88, 1
    s_cmp_lg_u32 s88, 0
    s_cbranch_scc1 gated_mix__softmax_full_mha__glu_gated_bilinear__prompt_kernel_kv_again
    s_branch gated_mix__softmax_full_mha__glu_gated_bilinear__prompt_kernel_kv_ok
gated_mix__softmax_full_mha__glu_gated_bilinear__prompt_kernel_h_spin:
    s_mov_b32 s88, 40000
gated_mix__softmax_full_mha__glu_gated_bilinear__prompt_kernel_h_again:
    s_sleep 2
    buffer_load_dwordx2 v[28:29], v15, s[32:35], s47 offen sc1
    s_waitcnt vmcnt(0)
    s_nop 1
    v_min_u32 v13, v28, v29
    v_cmp_gt_u32 vcc, 2, v13
    s_nop 4
    s_cbranch_vccz gated_mix__softmax_full_mha__glu_gated_bilinear__prompt_kernel_h_ok
    s_sub_u32 s88, s88, 1
    s_cmp_lg_u32 s88, 0
    s_cbranch_scc1 gated_mix__softmax_full_mha__glu_gated_bilinear__prompt_kernel_h_again
    s_branch gated_mix__softmax_full_mha__glu_gated_bilinear__prompt_kernel_h_ok
gated_mix__softmax_full_mha__glu_gated_bilinear__prompt_kernel_g_spin:
    s_mov_b32 s88, 40000
gated_mix__softmax_full_mha__glu_gated_bilinear__prompt_kernel_g_again:
    s_sleep 2
    buffer_load_dwordx2 v[28:29], v15, s[32:35], s47 offen sc1
    s_waitcnt vmcnt(0)
    s_nop 1
    v_min_u32 v13, v28, v29
    v_cmp_gt_u32 vcc, 2, v13
    s_nop 4
    s_cbranch_vccz gated_mix__softmax_full_mha__glu_gated_bilinear__prompt_kernel_g_ok
    s_sub_u32 s88, s88, 1
    s_cmp_lg_u32 s88, 0
    s_cbranch_scc1 gated_mix__softmax_full_mha__glu_gated_bilinear__prompt_kernel_g_again
    s_branch gated_mix__softmax_full_mha__glu_gated_bilinear__prompt_kernel_g_ok
gated_mix__softmax_full_mha__glu_gated_bilinear__prompt_kernel_o_spin:
    s_mov_b32 s88, 40000
gated_mix__softmax_full_mha__glu_gated_bilinear__prompt_kernel_o_again:
    s_sleep 2
    buffer_load_dword v28, v15, s[32:35], s47 offen sc1
    s_waitcnt vmcnt(0)
    s_nop 1
    v_cmp_gt_u32 vcc, 3, v28
    s_nop 4
    s_cbranch_vccz gated_mix__softmax_full_mha__glu_gated_bilinear__prompt_kernel_o_ok
    s_sub_u32 s88, s88, 1
    s_cmp_lg_u32 s88, 0
    s_cbranch_scc1 gated_mix__softmax_full_mha__glu_gated_bilinear__prompt_kernel_o_again
    s_branch gated_mix__softmax_full_mha__glu_gated_bilinear__prompt_kernel_o_ok
gated_mix__softmax_full_mha__glu_gated_bilinear__prompt_kernel_end:
    s_endpgm
.section .rodata,"a"
.p2align 6
.amdhsa_kernel gated_mix__softmax_full_mha__glu_gated_bilinear__prompt_kernel
  .amdhsa_next_free_vgpr 512
  .amdhsa_next_free_sgpr 102
  .amdhsa_accum_offset 256
  .amdhsa_group_segment_fixed_size 0
  .amdhsa_kernarg_size 88
  .amdhsa_user_sgpr_count 2
  .amdhsa_user_sgpr_kernarg_segment_ptr 1
  .amdhsa_system_sgpr_workgroup_id_x 1
  .amdhsa_float_denorm_mode_32 3
.end_amdhsa_kernel
```
